```python
import torch

def _softmax(x, axis=-1):
    return torch.softmax(x, dim=axis)

def _gelu(x):
    return torch.nn.functional.gelu(x, approximate='tanh')

def _silu(x):
    return torch.nn.functional.silu(x)

def _sigmoid(x):
    return torch.sigmoid(x)

def _layernorm(x, axis=-1, eps=1e-05):
    m = x.mean(dim=axis, keepdim=True)
    v = x.var(dim=axis, keepdim=True, unbiased=False)
    return (x - m) / torch.sqrt(v + eps)

def _scatter_add(tgt, idx, src, axis=0):
    return tgt.clone().index_add_(axis, idx, src)

def _segment_sum(src, seg, n):
    out = torch.zeros((n,) + src.shape[1:], dtype=src.dtype)
    return out.index_add_(0, seg, src)

def _pad(x, pw):
    flat = tuple((v for pair in reversed(pw) for v in pair))
    return torch.nn.functional.pad(x, flat)
kernel_name = 'parallel_sum__memory_aug_recurrent_mem_tr__geglu_ffn__prompt'

def setup_inputs():

    _w = lambda a: (lambda t: t.to(torch.bfloat16) if t.is_floating_point() else t)(torch.as_tensor(a))

    def _A_setup():
        B, S, Dm = (1, 2048, 576)
        H, Dh = (32, 128)
        M, seg = (8, 32)
        seg = min(seg, S)
        S = S // seg * seg
        return {'x': _w((lambda *s: torch.randn(*s, dtype=torch.bfloat16) * 0.05)(B, S, Dm)), 'mem0': _w((lambda *s: torch.randn(*s, dtype=torch.bfloat16) * 1.6)(B, M, Dm)), 'Wq': _w((lambda *s: torch.randn(*s, dtype=torch.bfloat16) * 0.8)(Dm, H, Dh) * Dm ** (-0.5)), 'Wk': _w((lambda *s: torch.randn(*s, dtype=torch.bfloat16) * 0.8)(Dm, H, Dh) * Dm ** (-0.5)), 'Wv': _w((lambda *s: torch.randn(*s, dtype=torch.bfloat16) * 1.6)(Dm, H, Dh) * Dm ** (-0.5)), 'Wo': _w((lambda *s: torch.randn(*s, dtype=torch.bfloat16) * 1.6)(H, Dh, Dm) * (H * Dh) ** (-0.5)), 'seg_len': seg}
    _A_in = _A_setup()

    def _B_setup():
        B, S, D, F = (1, 2048, 576, 4608)
        return {'x': _w((lambda *s: torch.randn(*s, dtype=torch.bfloat16) * 0.05)(B, S, D)), 'w_gate': _w((lambda *s: torch.randn(*s, dtype=torch.bfloat16) * 0.05)(D, F)), 'w_up': _w((lambda *s: torch.randn(*s, dtype=torch.bfloat16) * 0.05)(D, F)), 'w_down': _w((lambda *s: torch.randn(*s, dtype=torch.bfloat16) * 0.05)(F, D))}
    _B_in = _B_setup()
    return {'A_x': _A_in['x'], 'A_mem0': _A_in['mem0'], 'A_Wq': _A_in['Wq'], 'A_Wk': _A_in['Wk'], 'A_Wv': _A_in['Wv'], 'A_Wo': _A_in['Wo'], 'A_seg_len': _A_in['seg_len'], 'B_x': _B_in['x'], 'B_w_gate': _B_in['w_gate'], 'B_w_up': _B_in['w_up'], 'B_w_down': _B_in['w_down']}

def reference(A_x, A_mem0, A_Wq, A_Wk, A_Wv, A_Wo, A_seg_len, B_x, B_w_gate, B_w_up, B_w_down):

    def _A_ref(x, mem0, Wq, Wk, Wv, Wo, seg_len):
        B, S, Dm = x.shape
        H, Dh = (Wq.shape[1], Wq.shape[2])
        M = mem0.shape[1]
        scale = Dh ** (-0.5)
        n_seg = S // seg_len
        L = M + seg_len
        idx = torch.arange(L)
        mask = (idx[:, None] < M) | (idx[:, None] >= idx[None, :])
        mem = mem0
        outs = []
        for s in range(n_seg):
            xs = x[:, s * seg_len:(s + 1) * seg_len, :].clone()
            h = torch.concatenate([mem, xs], axis=1)
            q = torch.einsum('btd,dhe->bhte', h, Wq)
            k = torch.einsum('btd,dhe->bhte', h, Wk)
            v = torch.einsum('btd,dhe->bhte', h, Wv)
            scores = torch.einsum('bhqe,bhke->bhqk', q, k) * scale
            scores = torch.where(mask[None, None], scores, -1000000000.0)
            p = _softmax(scores, axis=-1)
            o = torch.einsum('bhqk,bhke->bhqe', p, v)
            o = torch.einsum('bhte,hed->btd', o, Wo)
            mem = o[:, :M, :].clone()
            outs.append(o[:, M:, :])
        return torch.concatenate(outs, axis=1)

    def _B_ref(x, w_gate, w_up, w_down):
        return _gelu(x @ w_gate) * (x @ w_up) @ w_down
    x = A_x
    xn = _layernorm(x, axis=-1)
    return x + _A_ref(xn, A_mem0, A_Wq, A_Wk, A_Wv, A_Wo, A_seg_len) + _B_ref(xn, B_w_gate, B_w_up, B_w_down)
```

```asm
; @launch grid=(256,1,1) block=(256,1,1) lds=163840
.amdgcn_target "amdgcn-amd-amdhsa--gfx950"
.text
.globl parallel_sum__memory_aug_recurrent_mem_tr__geglu_ffn__prompt_kernel
.p2align 8
.type parallel_sum__memory_aug_recurrent_mem_tr__geglu_ffn__prompt_kernel,@function
parallel_sum__memory_aug_recurrent_mem_tr__geglu_ffn__prompt_kernel:
    s_load_dwordx2 s[8:9], s[0:1], 104
    s_load_dwordx2 s[72:73], s[0:1], 96
    s_cmp_ge_u32 s2, 256
    s_cbranch_scc1 Lexit
    s_getreg_b32 s57, hwreg(HW_REG_XCC_ID)
    s_and_b32 s57, s57, 7
    s_waitcnt lgkmcnt(0)
    s_mov_b32 s10, 0x10000000
    s_mov_b32 s11, 0x20000
    v_mov_b32 v4, 0
    v_cmp_eq_u32 vcc, 0, v0
    s_nop 0
    s_and_saveexec_b64 s[74:75], vcc
    s_cbranch_execz Lcl_skip_1001
    s_add_u32 s70, s57, 7
    s_and_b32 s70, s70, 7
    s_mov_b32 s76, 0
    v_mov_b32 v2, 1
Lcl_try_1002:
    s_lshl_b32 s77, s70, 2
    s_cmp_eq_u32 s70, 7
    s_cselect_b32 s77, 252, s77
    v_mov_b32 v1, s77
    global_atomic_add v3, v1, v2, s[72:73] sc0 sc1
    s_waitcnt vmcnt(0)
    v_readfirstlane_b32 s71, v3
    s_nop 0
    s_cmp_lt_u32 s71, 32
    s_cbranch_scc1 Lcl_got_1003
    s_add_u32 s70, s70, 1
    s_and_b32 s70, s70, 7
    s_add_u32 s76, s76, 1
    s_cmp_lt_u32 s76, 8
    s_cbranch_scc1 Lcl_try_1002
    s_mov_b32 s70, 8
Lcl_got_1003:
    s_lshl_b32 s77, s70, 8
    s_or_b32 s77, s77, s71
    v_mov_b32 v3, s77
    ds_write_b32 v4, v3
Lcl_skip_1001:
    s_mov_b64 exec, -1
    s_waitcnt lgkmcnt(0)
    s_barrier
    ds_read_b32 v3, v4
    s_waitcnt lgkmcnt(0)
    v_readfirstlane_b32 s77, v3
    s_barrier
    s_lshr_b32 s70, s77, 8
    s_and_b32 s71, s77, 0xff
    s_cmp_gt_u32 s70, 7
    s_cbranch_scc1 Lexit
    s_lshl_b32 s97, s70, 5
    s_add_u32 s97, s97, s71
    s_cmp_eq_u32 s70, 7
    s_cbranch_scc1 Lrec
    s_and_b32 s3, s71, 15
    s_lshr_b32 s5, s71, 4
    s_lshl_b32 s77, s70, 1
    s_add_u32 s5, s5, s77
    s_mov_b32 s30, s72
    s_mov_b32 s31, s73
    v_lshrrev_b32 v9, 6, v0
    v_and_b32 v0, 63, v0
    v_readfirstlane_b32 s4, v9
    v_lshrrev_b32 v10, 4, v0
    v_bfe_u32 v11, v0, 2, 2
    v_and_b32 v12, 3, v0
    v_lshrrev_b32 v13, 2, v0
    s_lshl_b32 s40, s4, 10
    v_lshrrev_b32 v14, 1, v10
    v_lshlrev_b32 v14, 9, v14
    v_lshl_add_u32 v14, v11, 6, v14
    v_and_b32 v15, 1, v10
    v_lshl_add_u32 v14, v15, 5, v14
    v_lshl_add_u32 v1, v12, 3, v14
    v_add_u32 v2, 0x10000, v1
    v_add_u32 v3, 0x20000, v1
    s_lshr_b32 s37, s4, 1
    s_and_b32 s38, s4, 1
    s_lshl_b32 s39, s4, 16
    v_and_b32 v14, 7, v13
    v_lshlrev_b32 v14, 13, v14
    v_lshl_add_u32 v14, v12, 4, v14
    v_lshrrev_b32 v15, 5, v0
    v_lshl_add_u32 v14, v15, 6, v14
    v_add_u32 v4, s39, v14
    s_mul_i32 s39, s4, 147456
    v_mul_u32_u24 v14, 9216, v13
    v_lshl_add_u32 v14, v12, 4, v14
    v_add_u32 v5, s39, v14
    s_mul_i32 s39, s38, 18432
    s_lshl_b32 s34, s37, 6
    s_add_u32 s39, s39, s34
    v_bfe_u32 v14, v13, 2, 1
    v_lshlrev_b32 v14, 3, v14
    v_lshrrev_b32 v15, 3, v13
    v_lshl_add_u32 v14, v15, 2, v14
    v_and_b32 v15, 3, v13
    v_add_u32 v14, v14, v15
    v_mul_u32_u24 v14, 1152, v14
    v_lshl_add_u32 v14, v12, 4, v14
    v_add_u32 v6, s39, v14
    v_lshrrev_b32 v15, 5, v0
    v_lshl_add_u32 v10, v15, 9, v1
    v_add_u32 v11, 0x10000, v10
    s_mov_b32 s6, s3
    s_cmp_lt_u32 s3, 2
    s_cselect_b32 s2, 1, 0
    s_cmp_lt_u32 s3, 8
    s_cbranch_scc1 Lpass_1004
    s_and_b32 s2, s3, 3
    s_add_u32 s2, s2, 2
    s_bfe_u32 s3, s3, 0x10002
Lpass_1004:
    s_mul_i32 s60, s3, 4128768
    s_sub_u32 s37, s3, 12
    s_max_i32 s37, s37, 0
    s_mul_i32 s37, s37, 4718592
    s_add_u32 s60, s60, s37
    s_sub_u32 s37, s3, 14
    s_max_i32 s37, s37, 0
    s_mul_i32 s37, s37, 4718592
    s_add_u32 s60, s60, s37
    s_add_u32 s60, s60, 67108864
    s_lshl_b32 s57, s3, 2
    s_add_u32 s57, s57, s4
    s_lshl_b32 s37, s57, 13
    v_and_b32 v12, 31, v0
    v_lshrrev_b32 v13, 5, v0
    v_lshlrev_b32 v7, 5, v12
    v_lshl_add_u32 v7, v13, 4, v7
    v_add_u32 v7, s37, v7
    s_load_dwordx2 s[24:25], s[0:1], 0
    s_lshl_b32 s37, s3, 2
    s_add_u32 s37, s37, s4
    s_mul_i32 s37, s37, 36864
    v_and_b32 v14, 31, v0
    v_mul_u32_u24 v14, 1152, v14
    v_lshrrev_b32 v15, 5, v0
    v_lshl_add_u32 v14, v15, 4, v14
    s_waitcnt lgkmcnt(0)
    s_mov_b32 s12, s24
    s_mov_b32 s13, s25
    s_mov_b32 s14, 2359296
    s_mov_b32 s15, 0x20000
    buffer_load_dwordx4 v[112:115], v14, s[12:15], s37 offen offset:0
    buffer_load_dwordx4 v[116:119], v14, s[12:15], s37 offen offset:32
    buffer_load_dwordx4 v[120:123], v14, s[12:15], s37 offen offset:64
    buffer_load_dwordx4 v[124:127], v14, s[12:15], s37 offen offset:96
    buffer_load_dwordx4 v[128:131], v14, s[12:15], s37 offen offset:128
    buffer_load_dwordx4 v[132:135], v14, s[12:15], s37 offen offset:160
    buffer_load_dwordx4 v[136:139], v14, s[12:15], s37 offen offset:192
    buffer_load_dwordx4 v[140:143], v14, s[12:15], s37 offen offset:224
    buffer_load_dwordx4 v[144:147], v14, s[12:15], s37 offen offset:256
    buffer_load_dwordx4 v[148:151], v14, s[12:15], s37 offen offset:288
    buffer_load_dwordx4 v[152:155], v14, s[12:15], s37 offen offset:320
    buffer_load_dwordx4 v[156:159], v14, s[12:15], s37 offen offset:352
    buffer_load_dwordx4 v[160:163], v14, s[12:15], s37 offen offset:384
    buffer_load_dwordx4 v[164:167], v14, s[12:15], s37 offen offset:416
    buffer_load_dwordx4 v[168:171], v14, s[12:15], s37 offen offset:448
    buffer_load_dwordx4 v[172:175], v14, s[12:15], s37 offen offset:480
    buffer_load_dwordx4 v[176:179], v14, s[12:15], s37 offen offset:512
    buffer_load_dwordx4 v[180:183], v14, s[12:15], s37 offen offset:544
    buffer_load_dwordx4 v[184:187], v14, s[12:15], s37 offen offset:576
    buffer_load_dwordx4 v[188:191], v14, s[12:15], s37 offen offset:608
    buffer_load_dwordx4 v[192:195], v14, s[12:15], s37 offen offset:640
    buffer_load_dwordx4 v[196:199], v14, s[12:15], s37 offen offset:672
    buffer_load_dwordx4 v[200:203], v14, s[12:15], s37 offen offset:704
    buffer_load_dwordx4 v[204:207], v14, s[12:15], s37 offen offset:736
    buffer_load_dwordx4 v[208:211], v14, s[12:15], s37 offen offset:768
    buffer_load_dwordx4 v[212:215], v14, s[12:15], s37 offen offset:800
    buffer_load_dwordx4 v[216:219], v14, s[12:15], s37 offen offset:832
    buffer_load_dwordx4 v[220:223], v14, s[12:15], s37 offen offset:864
    buffer_load_dwordx4 v[224:227], v14, s[12:15], s37 offen offset:896
    buffer_load_dwordx4 v[228:231], v14, s[12:15], s37 offen offset:928
    buffer_load_dwordx4 v[232:235], v14, s[12:15], s37 offen offset:960
    buffer_load_dwordx4 v[236:239], v14, s[12:15], s37 offen offset:992
    buffer_load_dwordx4 v[240:243], v14, s[12:15], s37 offen offset:1024
    buffer_load_dwordx4 v[244:247], v14, s[12:15], s37 offen offset:1056
    buffer_load_dwordx4 v[248:251], v14, s[12:15], s37 offen offset:1088
    buffer_load_dwordx4 v[252:255], v14, s[12:15], s37 offen offset:1120
    v_mov_b32 v16, 0x3f803f80
    v_mov_b32 v20, 0
    v_mov_b32 v21, 0
    v_mov_b32 v22, 0
    v_mov_b32 v23, 0
    s_waitcnt vmcnt(35)
    v_dot2c_f32_bf16 v20, v112, v16
    v_dot2c_f32_bf16 v21, v113, v16
    v_dot2c_f32_bf16 v22, v114, v16
    v_dot2c_f32_bf16 v23, v115, v16
    s_waitcnt vmcnt(34)
    v_dot2c_f32_bf16 v20, v116, v16
    v_dot2c_f32_bf16 v21, v117, v16
    v_dot2c_f32_bf16 v22, v118, v16
    v_dot2c_f32_bf16 v23, v119, v16
    s_waitcnt vmcnt(33)
    v_dot2c_f32_bf16 v20, v120, v16
    v_dot2c_f32_bf16 v21, v121, v16
    v_dot2c_f32_bf16 v22, v122, v16
    v_dot2c_f32_bf16 v23, v123, v16
    s_waitcnt vmcnt(32)
    v_dot2c_f32_bf16 v20, v124, v16
    v_dot2c_f32_bf16 v21, v125, v16
    v_dot2c_f32_bf16 v22, v126, v16
    v_dot2c_f32_bf16 v23, v127, v16
    s_waitcnt vmcnt(31)
    v_dot2c_f32_bf16 v20, v128, v16
    v_dot2c_f32_bf16 v21, v129, v16
    v_dot2c_f32_bf16 v22, v130, v16
    v_dot2c_f32_bf16 v23, v131, v16
    s_waitcnt vmcnt(30)
    v_dot2c_f32_bf16 v20, v132, v16
    v_dot2c_f32_bf16 v21, v133, v16
    v_dot2c_f32_bf16 v22, v134, v16
    v_dot2c_f32_bf16 v23, v135, v16
    s_waitcnt vmcnt(29)
    v_dot2c_f32_bf16 v20, v136, v16
    v_dot2c_f32_bf16 v21, v137, v16
    v_dot2c_f32_bf16 v22, v138, v16
    v_dot2c_f32_bf16 v23, v139, v16
    s_waitcnt vmcnt(28)
    v_dot2c_f32_bf16 v20, v140, v16
    v_dot2c_f32_bf16 v21, v141, v16
    v_dot2c_f32_bf16 v22, v142, v16
    v_dot2c_f32_bf16 v23, v143, v16
    s_waitcnt vmcnt(27)
    v_dot2c_f32_bf16 v20, v144, v16
    v_dot2c_f32_bf16 v21, v145, v16
    v_dot2c_f32_bf16 v22, v146, v16
    v_dot2c_f32_bf16 v23, v147, v16
    s_waitcnt vmcnt(26)
    v_dot2c_f32_bf16 v20, v148, v16
    v_dot2c_f32_bf16 v21, v149, v16
    v_dot2c_f32_bf16 v22, v150, v16
    v_dot2c_f32_bf16 v23, v151, v16
    s_waitcnt vmcnt(25)
    v_dot2c_f32_bf16 v20, v152, v16
    v_dot2c_f32_bf16 v21, v153, v16
    v_dot2c_f32_bf16 v22, v154, v16
    v_dot2c_f32_bf16 v23, v155, v16
    s_waitcnt vmcnt(24)
    v_dot2c_f32_bf16 v20, v156, v16
    v_dot2c_f32_bf16 v21, v157, v16
    v_dot2c_f32_bf16 v22, v158, v16
    v_dot2c_f32_bf16 v23, v159, v16
    s_waitcnt vmcnt(23)
    v_dot2c_f32_bf16 v20, v160, v16
    v_dot2c_f32_bf16 v21, v161, v16
    v_dot2c_f32_bf16 v22, v162, v16
    v_dot2c_f32_bf16 v23, v163, v16
    s_waitcnt vmcnt(22)
    v_dot2c_f32_bf16 v20, v164, v16
    v_dot2c_f32_bf16 v21, v165, v16
    v_dot2c_f32_bf16 v22, v166, v16
    v_dot2c_f32_bf16 v23, v167, v16
    s_waitcnt vmcnt(21)
    v_dot2c_f32_bf16 v20, v168, v16
    v_dot2c_f32_bf16 v21, v169, v16
    v_dot2c_f32_bf16 v22, v170, v16
    v_dot2c_f32_bf16 v23, v171, v16
    s_waitcnt vmcnt(20)
    v_dot2c_f32_bf16 v20, v172, v16
    v_dot2c_f32_bf16 v21, v173, v16
    v_dot2c_f32_bf16 v22, v174, v16
    v_dot2c_f32_bf16 v23, v175, v16
    s_waitcnt vmcnt(19)
    v_dot2c_f32_bf16 v20, v176, v16
    v_dot2c_f32_bf16 v21, v177, v16
    v_dot2c_f32_bf16 v22, v178, v16
    v_dot2c_f32_bf16 v23, v179, v16
    s_waitcnt vmcnt(18)
    v_dot2c_f32_bf16 v20, v180, v16
    v_dot2c_f32_bf16 v21, v181, v16
    v_dot2c_f32_bf16 v22, v182, v16
    v_dot2c_f32_bf16 v23, v183, v16
    s_waitcnt vmcnt(17)
    v_dot2c_f32_bf16 v20, v184, v16
    v_dot2c_f32_bf16 v21, v185, v16
    v_dot2c_f32_bf16 v22, v186, v16
    v_dot2c_f32_bf16 v23, v187, v16
    s_waitcnt vmcnt(16)
    v_dot2c_f32_bf16 v20, v188, v16
    v_dot2c_f32_bf16 v21, v189, v16
    v_dot2c_f32_bf16 v22, v190, v16
    v_dot2c_f32_bf16 v23, v191, v16
    s_waitcnt vmcnt(15)
    v_dot2c_f32_bf16 v20, v192, v16
    v_dot2c_f32_bf16 v21, v193, v16
    v_dot2c_f32_bf16 v22, v194, v16
    v_dot2c_f32_bf16 v23, v195, v16
    s_waitcnt vmcnt(14)
    v_dot2c_f32_bf16 v20, v196, v16
    v_dot2c_f32_bf16 v21, v197, v16
    v_dot2c_f32_bf16 v22, v198, v16
    v_dot2c_f32_bf16 v23, v199, v16
    s_waitcnt vmcnt(13)
    v_dot2c_f32_bf16 v20, v200, v16
    v_dot2c_f32_bf16 v21, v201, v16
    v_dot2c_f32_bf16 v22, v202, v16
    v_dot2c_f32_bf16 v23, v203, v16
    s_waitcnt vmcnt(12)
    v_dot2c_f32_bf16 v20, v204, v16
    v_dot2c_f32_bf16 v21, v205, v16
    v_dot2c_f32_bf16 v22, v206, v16
    v_dot2c_f32_bf16 v23, v207, v16
    s_waitcnt vmcnt(11)
    v_dot2c_f32_bf16 v20, v208, v16
    v_dot2c_f32_bf16 v21, v209, v16
    v_dot2c_f32_bf16 v22, v210, v16
    v_dot2c_f32_bf16 v23, v211, v16
    s_waitcnt vmcnt(10)
    v_dot2c_f32_bf16 v20, v212, v16
    v_dot2c_f32_bf16 v21, v213, v16
    v_dot2c_f32_bf16 v22, v214, v16
    v_dot2c_f32_bf16 v23, v215, v16
    s_waitcnt vmcnt(9)
    v_dot2c_f32_bf16 v20, v216, v16
    v_dot2c_f32_bf16 v21, v217, v16
    v_dot2c_f32_bf16 v22, v218, v16
    v_dot2c_f32_bf16 v23, v219, v16
    s_waitcnt vmcnt(8)
    v_dot2c_f32_bf16 v20, v220, v16
    v_dot2c_f32_bf16 v21, v221, v16
    v_dot2c_f32_bf16 v22, v222, v16
    v_dot2c_f32_bf16 v23, v223, v16
    s_waitcnt vmcnt(7)
    v_dot2c_f32_bf16 v20, v224, v16
    v_dot2c_f32_bf16 v21, v225, v16
    v_dot2c_f32_bf16 v22, v226, v16
    v_dot2c_f32_bf16 v23, v227, v16
    s_waitcnt vmcnt(6)
    v_dot2c_f32_bf16 v20, v228, v16
    v_dot2c_f32_bf16 v21, v229, v16
    v_dot2c_f32_bf16 v22, v230, v16
    v_dot2c_f32_bf16 v23, v231, v16
    s_waitcnt vmcnt(5)
    v_dot2c_f32_bf16 v20, v232, v16
    v_dot2c_f32_bf16 v21, v233, v16
    v_dot2c_f32_bf16 v22, v234, v16
    v_dot2c_f32_bf16 v23, v235, v16
    s_waitcnt vmcnt(4)
    v_dot2c_f32_bf16 v20, v236, v16
    v_dot2c_f32_bf16 v21, v237, v16
    v_dot2c_f32_bf16 v22, v238, v16
    v_dot2c_f32_bf16 v23, v239, v16
    s_waitcnt vmcnt(3)
    v_dot2c_f32_bf16 v20, v240, v16
    v_dot2c_f32_bf16 v21, v241, v16
    v_dot2c_f32_bf16 v22, v242, v16
    v_dot2c_f32_bf16 v23, v243, v16
    s_waitcnt vmcnt(2)
    v_dot2c_f32_bf16 v20, v244, v16
    v_dot2c_f32_bf16 v21, v245, v16
    v_dot2c_f32_bf16 v22, v246, v16
    v_dot2c_f32_bf16 v23, v247, v16
    s_waitcnt vmcnt(1)
    v_dot2c_f32_bf16 v20, v248, v16
    v_dot2c_f32_bf16 v21, v249, v16
    v_dot2c_f32_bf16 v22, v250, v16
    v_dot2c_f32_bf16 v23, v251, v16
    s_waitcnt vmcnt(0)
    v_dot2c_f32_bf16 v20, v252, v16
    v_dot2c_f32_bf16 v21, v253, v16
    v_dot2c_f32_bf16 v22, v254, v16
    v_dot2c_f32_bf16 v23, v255, v16
    s_nop 2
    v_add_f32 v20, v20, v21
    v_add_f32 v22, v22, v23
    v_add_f32 v20, v20, v22
    v_mov_b32 v21, v20
    s_nop 1
    v_permlane32_swap_b32 v20, v21
    v_add_f32 v20, v20, v21
    v_mul_f32 v20, 0x3ae38e39, v20
    v_cvt_pk_bf16_f32 v21, v20, v20
    v_lshlrev_b32 v22, 16, v21
    v_mov_b32 v23, v22
    v_sub_f32 v24, v20, v22
    v_mov_b64 v[26:27], 0
    v_mov_b64 v[28:29], 0
    v_lshlrev_b32 v32, 16, v112
    v_and_b32 v33, 0xffff0000, v112
    v_pk_add_f32 v[32:33], v[32:33], v[22:23] neg_lo:[0,1] neg_hi:[0,1]
    v_pk_fma_f32 v[26:27], v[32:33], v[32:33], v[26:27]
    v_cvt_pk_bf16_f32 v112, v32, v33
    v_lshlrev_b32 v34, 16, v113
    v_and_b32 v35, 0xffff0000, v113
    v_pk_add_f32 v[34:35], v[34:35], v[22:23] neg_lo:[0,1] neg_hi:[0,1]
    v_pk_fma_f32 v[28:29], v[34:35], v[34:35], v[28:29]
    v_cvt_pk_bf16_f32 v113, v34, v35
    v_lshlrev_b32 v36, 16, v114
    v_and_b32 v37, 0xffff0000, v114
    v_pk_add_f32 v[36:37], v[36:37], v[22:23] neg_lo:[0,1] neg_hi:[0,1]
    v_pk_fma_f32 v[26:27], v[36:37], v[36:37], v[26:27]
    v_cvt_pk_bf16_f32 v114, v36, v37
    v_lshlrev_b32 v38, 16, v115
    v_and_b32 v39, 0xffff0000, v115
    v_pk_add_f32 v[38:39], v[38:39], v[22:23] neg_lo:[0,1] neg_hi:[0,1]
    v_pk_fma_f32 v[28:29], v[38:39], v[38:39], v[28:29]
    v_cvt_pk_bf16_f32 v115, v38, v39
    v_lshlrev_b32 v32, 16, v116
    v_and_b32 v33, 0xffff0000, v116
    v_pk_add_f32 v[32:33], v[32:33], v[22:23] neg_lo:[0,1] neg_hi:[0,1]
    v_pk_fma_f32 v[26:27], v[32:33], v[32:33], v[26:27]
    v_cvt_pk_bf16_f32 v116, v32, v33
    v_lshlrev_b32 v34, 16, v117
    v_and_b32 v35, 0xffff0000, v117
    v_pk_add_f32 v[34:35], v[34:35], v[22:23] neg_lo:[0,1] neg_hi:[0,1]
    v_pk_fma_f32 v[28:29], v[34:35], v[34:35], v[28:29]
    v_cvt_pk_bf16_f32 v117, v34, v35
    v_lshlrev_b32 v36, 16, v118
    v_and_b32 v37, 0xffff0000, v118
    v_pk_add_f32 v[36:37], v[36:37], v[22:23] neg_lo:[0,1] neg_hi:[0,1]
    v_pk_fma_f32 v[26:27], v[36:37], v[36:37], v[26:27]
    v_cvt_pk_bf16_f32 v118, v36, v37
    v_lshlrev_b32 v38, 16, v119
    v_and_b32 v39, 0xffff0000, v119
    v_pk_add_f32 v[38:39], v[38:39], v[22:23] neg_lo:[0,1] neg_hi:[0,1]
    v_pk_fma_f32 v[28:29], v[38:39], v[38:39], v[28:29]
    v_cvt_pk_bf16_f32 v119, v38, v39
    v_lshlrev_b32 v32, 16, v120
    v_and_b32 v33, 0xffff0000, v120
    v_pk_add_f32 v[32:33], v[32:33], v[22:23] neg_lo:[0,1] neg_hi:[0,1]
    v_pk_fma_f32 v[26:27], v[32:33], v[32:33], v[26:27]
    v_cvt_pk_bf16_f32 v120, v32, v33
    v_lshlrev_b32 v34, 16, v121
    v_and_b32 v35, 0xffff0000, v121
    v_pk_add_f32 v[34:35], v[34:35], v[22:23] neg_lo:[0,1] neg_hi:[0,1]
    v_pk_fma_f32 v[28:29], v[34:35], v[34:35], v[28:29]
    v_cvt_pk_bf16_f32 v121, v34, v35
    v_lshlrev_b32 v36, 16, v122
    v_and_b32 v37, 0xffff0000, v122
    v_pk_add_f32 v[36:37], v[36:37], v[22:23] neg_lo:[0,1] neg_hi:[0,1]
    v_pk_fma_f32 v[26:27], v[36:37], v[36:37], v[26:27]
    v_cvt_pk_bf16_f32 v122, v36, v37
    v_lshlrev_b32 v38, 16, v123
    v_and_b32 v39, 0xffff0000, v123
    v_pk_add_f32 v[38:39], v[38:39], v[22:23] neg_lo:[0,1] neg_hi:[0,1]
    v_pk_fma_f32 v[28:29], v[38:39], v[38:39], v[28:29]
    v_cvt_pk_bf16_f32 v123, v38, v39
    v_lshlrev_b32 v32, 16, v124
    v_and_b32 v33, 0xffff0000, v124
    v_pk_add_f32 v[32:33], v[32:33], v[22:23] neg_lo:[0,1] neg_hi:[0,1]
    v_pk_fma_f32 v[26:27], v[32:33], v[32:33], v[26:27]
    v_cvt_pk_bf16_f32 v124, v32, v33
    v_lshlrev_b32 v34, 16, v125
    v_and_b32 v35, 0xffff0000, v125
    v_pk_add_f32 v[34:35], v[34:35], v[22:23] neg_lo:[0,1] neg_hi:[0,1]
    v_pk_fma_f32 v[28:29], v[34:35], v[34:35], v[28:29]
    v_cvt_pk_bf16_f32 v125, v34, v35
    v_lshlrev_b32 v36, 16, v126
    v_and_b32 v37, 0xffff0000, v126
    v_pk_add_f32 v[36:37], v[36:37], v[22:23] neg_lo:[0,1] neg_hi:[0,1]
    v_pk_fma_f32 v[26:27], v[36:37], v[36:37], v[26:27]
    v_cvt_pk_bf16_f32 v126, v36, v37
    v_lshlrev_b32 v38, 16, v127
    v_and_b32 v39, 0xffff0000, v127
    v_pk_add_f32 v[38:39], v[38:39], v[22:23] neg_lo:[0,1] neg_hi:[0,1]
    v_pk_fma_f32 v[28:29], v[38:39], v[38:39], v[28:29]
    v_cvt_pk_bf16_f32 v127, v38, v39
    v_lshlrev_b32 v32, 16, v128
    v_and_b32 v33, 0xffff0000, v128
    v_pk_add_f32 v[32:33], v[32:33], v[22:23] neg_lo:[0,1] neg_hi:[0,1]
    v_pk_fma_f32 v[26:27], v[32:33], v[32:33], v[26:27]
    v_cvt_pk_bf16_f32 v128, v32, v33
    v_lshlrev_b32 v34, 16, v129
    v_and_b32 v35, 0xffff0000, v129
    v_pk_add_f32 v[34:35], v[34:35], v[22:23] neg_lo:[0,1] neg_hi:[0,1]
    v_pk_fma_f32 v[28:29], v[34:35], v[34:35], v[28:29]
    v_cvt_pk_bf16_f32 v129, v34, v35
    v_lshlrev_b32 v36, 16, v130
    v_and_b32 v37, 0xffff0000, v130
    v_pk_add_f32 v[36:37], v[36:37], v[22:23] neg_lo:[0,1] neg_hi:[0,1]
    v_pk_fma_f32 v[26:27], v[36:37], v[36:37], v[26:27]
    v_cvt_pk_bf16_f32 v130, v36, v37
    v_lshlrev_b32 v38, 16, v131
    v_and_b32 v39, 0xffff0000, v131
    v_pk_add_f32 v[38:39], v[38:39], v[22:23] neg_lo:[0,1] neg_hi:[0,1]
    v_pk_fma_f32 v[28:29], v[38:39], v[38:39], v[28:29]
    v_cvt_pk_bf16_f32 v131, v38, v39
    v_lshlrev_b32 v32, 16, v132
    v_and_b32 v33, 0xffff0000, v132
    v_pk_add_f32 v[32:33], v[32:33], v[22:23] neg_lo:[0,1] neg_hi:[0,1]
    v_pk_fma_f32 v[26:27], v[32:33], v[32:33], v[26:27]
    v_cvt_pk_bf16_f32 v132, v32, v33
    v_lshlrev_b32 v34, 16, v133
    v_and_b32 v35, 0xffff0000, v133
    v_pk_add_f32 v[34:35], v[34:35], v[22:23] neg_lo:[0,1] neg_hi:[0,1]
    v_pk_fma_f32 v[28:29], v[34:35], v[34:35], v[28:29]
    v_cvt_pk_bf16_f32 v133, v34, v35
    v_lshlrev_b32 v36, 16, v134
    v_and_b32 v37, 0xffff0000, v134
    v_pk_add_f32 v[36:37], v[36:37], v[22:23] neg_lo:[0,1] neg_hi:[0,1]
    v_pk_fma_f32 v[26:27], v[36:37], v[36:37], v[26:27]
    v_cvt_pk_bf16_f32 v134, v36, v37
    v_lshlrev_b32 v38, 16, v135
    v_and_b32 v39, 0xffff0000, v135
    v_pk_add_f32 v[38:39], v[38:39], v[22:23] neg_lo:[0,1] neg_hi:[0,1]
    v_pk_fma_f32 v[28:29], v[38:39], v[38:39], v[28:29]
    v_cvt_pk_bf16_f32 v135, v38, v39
    v_lshlrev_b32 v32, 16, v136
    v_and_b32 v33, 0xffff0000, v136
    v_pk_add_f32 v[32:33], v[32:33], v[22:23] neg_lo:[0,1] neg_hi:[0,1]
    v_pk_fma_f32 v[26:27], v[32:33], v[32:33], v[26:27]
    v_cvt_pk_bf16_f32 v136, v32, v33
    v_lshlrev_b32 v34, 16, v137
    v_and_b32 v35, 0xffff0000, v137
    v_pk_add_f32 v[34:35], v[34:35], v[22:23] neg_lo:[0,1] neg_hi:[0,1]
    v_pk_fma_f32 v[28:29], v[34:35], v[34:35], v[28:29]
    v_cvt_pk_bf16_f32 v137, v34, v35
    v_lshlrev_b32 v36, 16, v138
    v_and_b32 v37, 0xffff0000, v138
    v_pk_add_f32 v[36:37], v[36:37], v[22:23] neg_lo:[0,1] neg_hi:[0,1]
    v_pk_fma_f32 v[26:27], v[36:37], v[36:37], v[26:27]
    v_cvt_pk_bf16_f32 v138, v36, v37
    v_lshlrev_b32 v38, 16, v139
    v_and_b32 v39, 0xffff0000, v139
    v_pk_add_f32 v[38:39], v[38:39], v[22:23] neg_lo:[0,1] neg_hi:[0,1]
    v_pk_fma_f32 v[28:29], v[38:39], v[38:39], v[28:29]
    v_cvt_pk_bf16_f32 v139, v38, v39
    v_lshlrev_b32 v32, 16, v140
    v_and_b32 v33, 0xffff0000, v140
    v_pk_add_f32 v[32:33], v[32:33], v[22:23] neg_lo:[0,1] neg_hi:[0,1]
    v_pk_fma_f32 v[26:27], v[32:33], v[32:33], v[26:27]
    v_cvt_pk_bf16_f32 v140, v32, v33
    v_lshlrev_b32 v34, 16, v141
    v_and_b32 v35, 0xffff0000, v141
    v_pk_add_f32 v[34:35], v[34:35], v[22:23] neg_lo:[0,1] neg_hi:[0,1]
    v_pk_fma_f32 v[28:29], v[34:35], v[34:35], v[28:29]
    v_cvt_pk_bf16_f32 v141, v34, v35
    v_lshlrev_b32 v36, 16, v142
    v_and_b32 v37, 0xffff0000, v142
    v_pk_add_f32 v[36:37], v[36:37], v[22:23] neg_lo:[0,1] neg_hi:[0,1]
    v_pk_fma_f32 v[26:27], v[36:37], v[36:37], v[26:27]
    v_cvt_pk_bf16_f32 v142, v36, v37
    v_lshlrev_b32 v38, 16, v143
    v_and_b32 v39, 0xffff0000, v143
    v_pk_add_f32 v[38:39], v[38:39], v[22:23] neg_lo:[0,1] neg_hi:[0,1]
    v_pk_fma_f32 v[28:29], v[38:39], v[38:39], v[28:29]
    v_cvt_pk_bf16_f32 v143, v38, v39
    v_lshlrev_b32 v32, 16, v144
    v_and_b32 v33, 0xffff0000, v144
    v_pk_add_f32 v[32:33], v[32:33], v[22:23] neg_lo:[0,1] neg_hi:[0,1]
    v_pk_fma_f32 v[26:27], v[32:33], v[32:33], v[26:27]
    v_cvt_pk_bf16_f32 v144, v32, v33
    v_lshlrev_b32 v34, 16, v145
    v_and_b32 v35, 0xffff0000, v145
    v_pk_add_f32 v[34:35], v[34:35], v[22:23] neg_lo:[0,1] neg_hi:[0,1]
    v_pk_fma_f32 v[28:29], v[34:35], v[34:35], v[28:29]
    v_cvt_pk_bf16_f32 v145, v34, v35
    v_lshlrev_b32 v36, 16, v146
    v_and_b32 v37, 0xffff0000, v146
    v_pk_add_f32 v[36:37], v[36:37], v[22:23] neg_lo:[0,1] neg_hi:[0,1]
    v_pk_fma_f32 v[26:27], v[36:37], v[36:37], v[26:27]
    v_cvt_pk_bf16_f32 v146, v36, v37
    v_lshlrev_b32 v38, 16, v147
    v_and_b32 v39, 0xffff0000, v147
    v_pk_add_f32 v[38:39], v[38:39], v[22:23] neg_lo:[0,1] neg_hi:[0,1]
    v_pk_fma_f32 v[28:29], v[38:39], v[38:39], v[28:29]
    v_cvt_pk_bf16_f32 v147, v38, v39
    v_lshlrev_b32 v32, 16, v148
    v_and_b32 v33, 0xffff0000, v148
    v_pk_add_f32 v[32:33], v[32:33], v[22:23] neg_lo:[0,1] neg_hi:[0,1]
    v_pk_fma_f32 v[26:27], v[32:33], v[32:33], v[26:27]
    v_cvt_pk_bf16_f32 v148, v32, v33
    v_lshlrev_b32 v34, 16, v149
    v_and_b32 v35, 0xffff0000, v149
    v_pk_add_f32 v[34:35], v[34:35], v[22:23] neg_lo:[0,1] neg_hi:[0,1]
    v_pk_fma_f32 v[28:29], v[34:35], v[34:35], v[28:29]
    v_cvt_pk_bf16_f32 v149, v34, v35
    v_lshlrev_b32 v36, 16, v150
    v_and_b32 v37, 0xffff0000, v150
    v_pk_add_f32 v[36:37], v[36:37], v[22:23] neg_lo:[0,1] neg_hi:[0,1]
    v_pk_fma_f32 v[26:27], v[36:37], v[36:37], v[26:27]
    v_cvt_pk_bf16_f32 v150, v36, v37
    v_lshlrev_b32 v38, 16, v151
    v_and_b32 v39, 0xffff0000, v151
    v_pk_add_f32 v[38:39], v[38:39], v[22:23] neg_lo:[0,1] neg_hi:[0,1]
    v_pk_fma_f32 v[28:29], v[38:39], v[38:39], v[28:29]
    v_cvt_pk_bf16_f32 v151, v38, v39
    v_lshlrev_b32 v32, 16, v152
    v_and_b32 v33, 0xffff0000, v152
    v_pk_add_f32 v[32:33], v[32:33], v[22:23] neg_lo:[0,1] neg_hi:[0,1]
    v_pk_fma_f32 v[26:27], v[32:33], v[32:33], v[26:27]
    v_cvt_pk_bf16_f32 v152, v32, v33
    v_lshlrev_b32 v34, 16, v153
    v_and_b32 v35, 0xffff0000, v153
    v_pk_add_f32 v[34:35], v[34:35], v[22:23] neg_lo:[0,1] neg_hi:[0,1]
    v_pk_fma_f32 v[28:29], v[34:35], v[34:35], v[28:29]
    v_cvt_pk_bf16_f32 v153, v34, v35
    v_lshlrev_b32 v36, 16, v154
    v_and_b32 v37, 0xffff0000, v154
    v_pk_add_f32 v[36:37], v[36:37], v[22:23] neg_lo:[0,1] neg_hi:[0,1]
    v_pk_fma_f32 v[26:27], v[36:37], v[36:37], v[26:27]
    v_cvt_pk_bf16_f32 v154, v36, v37
    v_lshlrev_b32 v38, 16, v155
    v_and_b32 v39, 0xffff0000, v155
    v_pk_add_f32 v[38:39], v[38:39], v[22:23] neg_lo:[0,1] neg_hi:[0,1]
    v_pk_fma_f32 v[28:29], v[38:39], v[38:39], v[28:29]
    v_cvt_pk_bf16_f32 v155, v38, v39
    v_lshlrev_b32 v32, 16, v156
    v_and_b32 v33, 0xffff0000, v156
    v_pk_add_f32 v[32:33], v[32:33], v[22:23] neg_lo:[0,1] neg_hi:[0,1]
    v_pk_fma_f32 v[26:27], v[32:33], v[32:33], v[26:27]
    v_cvt_pk_bf16_f32 v156, v32, v33
    v_lshlrev_b32 v34, 16, v157
    v_and_b32 v35, 0xffff0000, v157
    v_pk_add_f32 v[34:35], v[34:35], v[22:23] neg_lo:[0,1] neg_hi:[0,1]
    v_pk_fma_f32 v[28:29], v[34:35], v[34:35], v[28:29]
    v_cvt_pk_bf16_f32 v157, v34, v35
    v_lshlrev_b32 v36, 16, v158
    v_and_b32 v37, 0xffff0000, v158
    v_pk_add_f32 v[36:37], v[36:37], v[22:23] neg_lo:[0,1] neg_hi:[0,1]
    v_pk_fma_f32 v[26:27], v[36:37], v[36:37], v[26:27]
    v_cvt_pk_bf16_f32 v158, v36, v37
    v_lshlrev_b32 v38, 16, v159
    v_and_b32 v39, 0xffff0000, v159
    v_pk_add_f32 v[38:39], v[38:39], v[22:23] neg_lo:[0,1] neg_hi:[0,1]
    v_pk_fma_f32 v[28:29], v[38:39], v[38:39], v[28:29]
    v_cvt_pk_bf16_f32 v159, v38, v39
    v_lshlrev_b32 v32, 16, v160
    v_and_b32 v33, 0xffff0000, v160
    v_pk_add_f32 v[32:33], v[32:33], v[22:23] neg_lo:[0,1] neg_hi:[0,1]
    v_pk_fma_f32 v[26:27], v[32:33], v[32:33], v[26:27]
    v_cvt_pk_bf16_f32 v160, v32, v33
    v_lshlrev_b32 v34, 16, v161
    v_and_b32 v35, 0xffff0000, v161
    v_pk_add_f32 v[34:35], v[34:35], v[22:23] neg_lo:[0,1] neg_hi:[0,1]
    v_pk_fma_f32 v[28:29], v[34:35], v[34:35], v[28:29]
    v_cvt_pk_bf16_f32 v161, v34, v35
    v_lshlrev_b32 v36, 16, v162
    v_and_b32 v37, 0xffff0000, v162
    v_pk_add_f32 v[36:37], v[36:37], v[22:23] neg_lo:[0,1] neg_hi:[0,1]
    v_pk_fma_f32 v[26:27], v[36:37], v[36:37], v[26:27]
    v_cvt_pk_bf16_f32 v162, v36, v37
    v_lshlrev_b32 v38, 16, v163
    v_and_b32 v39, 0xffff0000, v163
    v_pk_add_f32 v[38:39], v[38:39], v[22:23] neg_lo:[0,1] neg_hi:[0,1]
    v_pk_fma_f32 v[28:29], v[38:39], v[38:39], v[28:29]
    v_cvt_pk_bf16_f32 v163, v38, v39
    v_lshlrev_b32 v32, 16, v164
    v_and_b32 v33, 0xffff0000, v164
    v_pk_add_f32 v[32:33], v[32:33], v[22:23] neg_lo:[0,1] neg_hi:[0,1]
    v_pk_fma_f32 v[26:27], v[32:33], v[32:33], v[26:27]
    v_cvt_pk_bf16_f32 v164, v32, v33
    v_lshlrev_b32 v34, 16, v165
    v_and_b32 v35, 0xffff0000, v165
    v_pk_add_f32 v[34:35], v[34:35], v[22:23] neg_lo:[0,1] neg_hi:[0,1]
    v_pk_fma_f32 v[28:29], v[34:35], v[34:35], v[28:29]
    v_cvt_pk_bf16_f32 v165, v34, v35
    v_lshlrev_b32 v36, 16, v166
    v_and_b32 v37, 0xffff0000, v166
    v_pk_add_f32 v[36:37], v[36:37], v[22:23] neg_lo:[0,1] neg_hi:[0,1]
    v_pk_fma_f32 v[26:27], v[36:37], v[36:37], v[26:27]
    v_cvt_pk_bf16_f32 v166, v36, v37
    v_lshlrev_b32 v38, 16, v167
    v_and_b32 v39, 0xffff0000, v167
    v_pk_add_f32 v[38:39], v[38:39], v[22:23] neg_lo:[0,1] neg_hi:[0,1]
    v_pk_fma_f32 v[28:29], v[38:39], v[38:39], v[28:29]
    v_cvt_pk_bf16_f32 v167, v38, v39
    v_lshlrev_b32 v32, 16, v168
    v_and_b32 v33, 0xffff0000, v168
    v_pk_add_f32 v[32:33], v[32:33], v[22:23] neg_lo:[0,1] neg_hi:[0,1]
    v_pk_fma_f32 v[26:27], v[32:33], v[32:33], v[26:27]
    v_cvt_pk_bf16_f32 v168, v32, v33
    v_lshlrev_b32 v34, 16, v169
    v_and_b32 v35, 0xffff0000, v169
    v_pk_add_f32 v[34:35], v[34:35], v[22:23] neg_lo:[0,1] neg_hi:[0,1]
    v_pk_fma_f32 v[28:29], v[34:35], v[34:35], v[28:29]
    v_cvt_pk_bf16_f32 v169, v34, v35
    v_lshlrev_b32 v36, 16, v170
    v_and_b32 v37, 0xffff0000, v170
    v_pk_add_f32 v[36:37], v[36:37], v[22:23] neg_lo:[0,1] neg_hi:[0,1]
    v_pk_fma_f32 v[26:27], v[36:37], v[36:37], v[26:27]
    v_cvt_pk_bf16_f32 v170, v36, v37
    v_lshlrev_b32 v38, 16, v171
    v_and_b32 v39, 0xffff0000, v171
    v_pk_add_f32 v[38:39], v[38:39], v[22:23] neg_lo:[0,1] neg_hi:[0,1]
    v_pk_fma_f32 v[28:29], v[38:39], v[38:39], v[28:29]
    v_cvt_pk_bf16_f32 v171, v38, v39
    v_lshlrev_b32 v32, 16, v172
    v_and_b32 v33, 0xffff0000, v172
    v_pk_add_f32 v[32:33], v[32:33], v[22:23] neg_lo:[0,1] neg_hi:[0,1]
    v_pk_fma_f32 v[26:27], v[32:33], v[32:33], v[26:27]
    v_cvt_pk_bf16_f32 v172, v32, v33
    v_lshlrev_b32 v34, 16, v173
    v_and_b32 v35, 0xffff0000, v173
    v_pk_add_f32 v[34:35], v[34:35], v[22:23] neg_lo:[0,1] neg_hi:[0,1]
    v_pk_fma_f32 v[28:29], v[34:35], v[34:35], v[28:29]
    v_cvt_pk_bf16_f32 v173, v34, v35
    v_lshlrev_b32 v36, 16, v174
    v_and_b32 v37, 0xffff0000, v174
    v_pk_add_f32 v[36:37], v[36:37], v[22:23] neg_lo:[0,1] neg_hi:[0,1]
    v_pk_fma_f32 v[26:27], v[36:37], v[36:37], v[26:27]
    v_cvt_pk_bf16_f32 v174, v36, v37
    v_lshlrev_b32 v38, 16, v175
    v_and_b32 v39, 0xffff0000, v175
    v_pk_add_f32 v[38:39], v[38:39], v[22:23] neg_lo:[0,1] neg_hi:[0,1]
    v_pk_fma_f32 v[28:29], v[38:39], v[38:39], v[28:29]
    v_cvt_pk_bf16_f32 v175, v38, v39
    v_lshlrev_b32 v32, 16, v176
    v_and_b32 v33, 0xffff0000, v176
    v_pk_add_f32 v[32:33], v[32:33], v[22:23] neg_lo:[0,1] neg_hi:[0,1]
    v_pk_fma_f32 v[26:27], v[32:33], v[32:33], v[26:27]
    v_cvt_pk_bf16_f32 v176, v32, v33
    v_lshlrev_b32 v34, 16, v177
    v_and_b32 v35, 0xffff0000, v177
    v_pk_add_f32 v[34:35], v[34:35], v[22:23] neg_lo:[0,1] neg_hi:[0,1]
    v_pk_fma_f32 v[28:29], v[34:35], v[34:35], v[28:29]
    v_cvt_pk_bf16_f32 v177, v34, v35
    v_lshlrev_b32 v36, 16, v178
    v_and_b32 v37, 0xffff0000, v178
    v_pk_add_f32 v[36:37], v[36:37], v[22:23] neg_lo:[0,1] neg_hi:[0,1]
    v_pk_fma_f32 v[26:27], v[36:37], v[36:37], v[26:27]
    v_cvt_pk_bf16_f32 v178, v36, v37
    v_lshlrev_b32 v38, 16, v179
    v_and_b32 v39, 0xffff0000, v179
    v_pk_add_f32 v[38:39], v[38:39], v[22:23] neg_lo:[0,1] neg_hi:[0,1]
    v_pk_fma_f32 v[28:29], v[38:39], v[38:39], v[28:29]
    v_cvt_pk_bf16_f32 v179, v38, v39
    v_lshlrev_b32 v32, 16, v180
    v_and_b32 v33, 0xffff0000, v180
    v_pk_add_f32 v[32:33], v[32:33], v[22:23] neg_lo:[0,1] neg_hi:[0,1]
    v_pk_fma_f32 v[26:27], v[32:33], v[32:33], v[26:27]
    v_cvt_pk_bf16_f32 v180, v32, v33
    v_lshlrev_b32 v34, 16, v181
    v_and_b32 v35, 0xffff0000, v181
    v_pk_add_f32 v[34:35], v[34:35], v[22:23] neg_lo:[0,1] neg_hi:[0,1]
    v_pk_fma_f32 v[28:29], v[34:35], v[34:35], v[28:29]
    v_cvt_pk_bf16_f32 v181, v34, v35
    v_lshlrev_b32 v36, 16, v182
    v_and_b32 v37, 0xffff0000, v182
    v_pk_add_f32 v[36:37], v[36:37], v[22:23] neg_lo:[0,1] neg_hi:[0,1]
    v_pk_fma_f32 v[26:27], v[36:37], v[36:37], v[26:27]
    v_cvt_pk_bf16_f32 v182, v36, v37
    v_lshlrev_b32 v38, 16, v183
    v_and_b32 v39, 0xffff0000, v183
    v_pk_add_f32 v[38:39], v[38:39], v[22:23] neg_lo:[0,1] neg_hi:[0,1]
    v_pk_fma_f32 v[28:29], v[38:39], v[38:39], v[28:29]
    v_cvt_pk_bf16_f32 v183, v38, v39
    v_lshlrev_b32 v32, 16, v184
    v_and_b32 v33, 0xffff0000, v184
    v_pk_add_f32 v[32:33], v[32:33], v[22:23] neg_lo:[0,1] neg_hi:[0,1]
    v_pk_fma_f32 v[26:27], v[32:33], v[32:33], v[26:27]
    v_cvt_pk_bf16_f32 v184, v32, v33
    v_lshlrev_b32 v34, 16, v185
    v_and_b32 v35, 0xffff0000, v185
    v_pk_add_f32 v[34:35], v[34:35], v[22:23] neg_lo:[0,1] neg_hi:[0,1]
    v_pk_fma_f32 v[28:29], v[34:35], v[34:35], v[28:29]
    v_cvt_pk_bf16_f32 v185, v34, v35
    v_lshlrev_b32 v36, 16, v186
    v_and_b32 v37, 0xffff0000, v186
    v_pk_add_f32 v[36:37], v[36:37], v[22:23] neg_lo:[0,1] neg_hi:[0,1]
    v_pk_fma_f32 v[26:27], v[36:37], v[36:37], v[26:27]
    v_cvt_pk_bf16_f32 v186, v36, v37
    v_lshlrev_b32 v38, 16, v187
    v_and_b32 v39, 0xffff0000, v187
    v_pk_add_f32 v[38:39], v[38:39], v[22:23] neg_lo:[0,1] neg_hi:[0,1]
    v_pk_fma_f32 v[28:29], v[38:39], v[38:39], v[28:29]
    v_cvt_pk_bf16_f32 v187, v38, v39
    v_lshlrev_b32 v32, 16, v188
    v_and_b32 v33, 0xffff0000, v188
    v_pk_add_f32 v[32:33], v[32:33], v[22:23] neg_lo:[0,1] neg_hi:[0,1]
    v_pk_fma_f32 v[26:27], v[32:33], v[32:33], v[26:27]
    v_cvt_pk_bf16_f32 v188, v32, v33
    v_lshlrev_b32 v34, 16, v189
    v_and_b32 v35, 0xffff0000, v189
    v_pk_add_f32 v[34:35], v[34:35], v[22:23] neg_lo:[0,1] neg_hi:[0,1]
    v_pk_fma_f32 v[28:29], v[34:35], v[34:35], v[28:29]
    v_cvt_pk_bf16_f32 v189, v34, v35
    v_lshlrev_b32 v36, 16, v190
    v_and_b32 v37, 0xffff0000, v190
    v_pk_add_f32 v[36:37], v[36:37], v[22:23] neg_lo:[0,1] neg_hi:[0,1]
    v_pk_fma_f32 v[26:27], v[36:37], v[36:37], v[26:27]
    v_cvt_pk_bf16_f32 v190, v36, v37
    v_lshlrev_b32 v38, 16, v191
    v_and_b32 v39, 0xffff0000, v191
    v_pk_add_f32 v[38:39], v[38:39], v[22:23] neg_lo:[0,1] neg_hi:[0,1]
    v_pk_fma_f32 v[28:29], v[38:39], v[38:39], v[28:29]
    v_cvt_pk_bf16_f32 v191, v38, v39
    v_lshlrev_b32 v32, 16, v192
    v_and_b32 v33, 0xffff0000, v192
    v_pk_add_f32 v[32:33], v[32:33], v[22:23] neg_lo:[0,1] neg_hi:[0,1]
    v_pk_fma_f32 v[26:27], v[32:33], v[32:33], v[26:27]
    v_cvt_pk_bf16_f32 v192, v32, v33
    v_lshlrev_b32 v34, 16, v193
    v_and_b32 v35, 0xffff0000, v193
    v_pk_add_f32 v[34:35], v[34:35], v[22:23] neg_lo:[0,1] neg_hi:[0,1]
    v_pk_fma_f32 v[28:29], v[34:35], v[34:35], v[28:29]
    v_cvt_pk_bf16_f32 v193, v34, v35
    v_lshlrev_b32 v36, 16, v194
    v_and_b32 v37, 0xffff0000, v194
    v_pk_add_f32 v[36:37], v[36:37], v[22:23] neg_lo:[0,1] neg_hi:[0,1]
    v_pk_fma_f32 v[26:27], v[36:37], v[36:37], v[26:27]
    v_cvt_pk_bf16_f32 v194, v36, v37
    v_lshlrev_b32 v38, 16, v195
    v_and_b32 v39, 0xffff0000, v195
    v_pk_add_f32 v[38:39], v[38:39], v[22:23] neg_lo:[0,1] neg_hi:[0,1]
    v_pk_fma_f32 v[28:29], v[38:39], v[38:39], v[28:29]
    v_cvt_pk_bf16_f32 v195, v38, v39
    v_lshlrev_b32 v32, 16, v196
    v_and_b32 v33, 0xffff0000, v196
    v_pk_add_f32 v[32:33], v[32:33], v[22:23] neg_lo:[0,1] neg_hi:[0,1]
    v_pk_fma_f32 v[26:27], v[32:33], v[32:33], v[26:27]
    v_cvt_pk_bf16_f32 v196, v32, v33
    v_lshlrev_b32 v34, 16, v197
    v_and_b32 v35, 0xffff0000, v197
    v_pk_add_f32 v[34:35], v[34:35], v[22:23] neg_lo:[0,1] neg_hi:[0,1]
    v_pk_fma_f32 v[28:29], v[34:35], v[34:35], v[28:29]
    v_cvt_pk_bf16_f32 v197, v34, v35
    v_lshlrev_b32 v36, 16, v198
    v_and_b32 v37, 0xffff0000, v198
    v_pk_add_f32 v[36:37], v[36:37], v[22:23] neg_lo:[0,1] neg_hi:[0,1]
    v_pk_fma_f32 v[26:27], v[36:37], v[36:37], v[26:27]
    v_cvt_pk_bf16_f32 v198, v36, v37
    v_lshlrev_b32 v38, 16, v199
    v_and_b32 v39, 0xffff0000, v199
    v_pk_add_f32 v[38:39], v[38:39], v[22:23] neg_lo:[0,1] neg_hi:[0,1]
    v_pk_fma_f32 v[28:29], v[38:39], v[38:39], v[28:29]
    v_cvt_pk_bf16_f32 v199, v38, v39
    v_lshlrev_b32 v32, 16, v200
    v_and_b32 v33, 0xffff0000, v200
    v_pk_add_f32 v[32:33], v[32:33], v[22:23] neg_lo:[0,1] neg_hi:[0,1]
    v_pk_fma_f32 v[26:27], v[32:33], v[32:33], v[26:27]
    v_cvt_pk_bf16_f32 v200, v32, v33
    v_lshlrev_b32 v34, 16, v201
    v_and_b32 v35, 0xffff0000, v201
    v_pk_add_f32 v[34:35], v[34:35], v[22:23] neg_lo:[0,1] neg_hi:[0,1]
    v_pk_fma_f32 v[28:29], v[34:35], v[34:35], v[28:29]
    v_cvt_pk_bf16_f32 v201, v34, v35
    v_lshlrev_b32 v36, 16, v202
    v_and_b32 v37, 0xffff0000, v202
    v_pk_add_f32 v[36:37], v[36:37], v[22:23] neg_lo:[0,1] neg_hi:[0,1]
    v_pk_fma_f32 v[26:27], v[36:37], v[36:37], v[26:27]
    v_cvt_pk_bf16_f32 v202, v36, v37
    v_lshlrev_b32 v38, 16, v203
    v_and_b32 v39, 0xffff0000, v203
    v_pk_add_f32 v[38:39], v[38:39], v[22:23] neg_lo:[0,1] neg_hi:[0,1]
    v_pk_fma_f32 v[28:29], v[38:39], v[38:39], v[28:29]
    v_cvt_pk_bf16_f32 v203, v38, v39
    v_lshlrev_b32 v32, 16, v204
    v_and_b32 v33, 0xffff0000, v204
    v_pk_add_f32 v[32:33], v[32:33], v[22:23] neg_lo:[0,1] neg_hi:[0,1]
    v_pk_fma_f32 v[26:27], v[32:33], v[32:33], v[26:27]
    v_cvt_pk_bf16_f32 v204, v32, v33
    v_lshlrev_b32 v34, 16, v205
    v_and_b32 v35, 0xffff0000, v205
    v_pk_add_f32 v[34:35], v[34:35], v[22:23] neg_lo:[0,1] neg_hi:[0,1]
    v_pk_fma_f32 v[28:29], v[34:35], v[34:35], v[28:29]
    v_cvt_pk_bf16_f32 v205, v34, v35
    v_lshlrev_b32 v36, 16, v206
    v_and_b32 v37, 0xffff0000, v206
    v_pk_add_f32 v[36:37], v[36:37], v[22:23] neg_lo:[0,1] neg_hi:[0,1]
    v_pk_fma_f32 v[26:27], v[36:37], v[36:37], v[26:27]
    v_cvt_pk_bf16_f32 v206, v36, v37
    v_lshlrev_b32 v38, 16, v207
    v_and_b32 v39, 0xffff0000, v207
    v_pk_add_f32 v[38:39], v[38:39], v[22:23] neg_lo:[0,1] neg_hi:[0,1]
    v_pk_fma_f32 v[28:29], v[38:39], v[38:39], v[28:29]
    v_cvt_pk_bf16_f32 v207, v38, v39
    v_lshlrev_b32 v32, 16, v208
    v_and_b32 v33, 0xffff0000, v208
    v_pk_add_f32 v[32:33], v[32:33], v[22:23] neg_lo:[0,1] neg_hi:[0,1]
    v_pk_fma_f32 v[26:27], v[32:33], v[32:33], v[26:27]
    v_cvt_pk_bf16_f32 v208, v32, v33
    v_lshlrev_b32 v34, 16, v209
    v_and_b32 v35, 0xffff0000, v209
    v_pk_add_f32 v[34:35], v[34:35], v[22:23] neg_lo:[0,1] neg_hi:[0,1]
    v_pk_fma_f32 v[28:29], v[34:35], v[34:35], v[28:29]
    v_cvt_pk_bf16_f32 v209, v34, v35
    v_lshlrev_b32 v36, 16, v210
    v_and_b32 v37, 0xffff0000, v210
    v_pk_add_f32 v[36:37], v[36:37], v[22:23] neg_lo:[0,1] neg_hi:[0,1]
    v_pk_fma_f32 v[26:27], v[36:37], v[36:37], v[26:27]
    v_cvt_pk_bf16_f32 v210, v36, v37
    v_lshlrev_b32 v38, 16, v211
    v_and_b32 v39, 0xffff0000, v211
    v_pk_add_f32 v[38:39], v[38:39], v[22:23] neg_lo:[0,1] neg_hi:[0,1]
    v_pk_fma_f32 v[28:29], v[38:39], v[38:39], v[28:29]
    v_cvt_pk_bf16_f32 v211, v38, v39
    v_lshlrev_b32 v32, 16, v212
    v_and_b32 v33, 0xffff0000, v212
    v_pk_add_f32 v[32:33], v[32:33], v[22:23] neg_lo:[0,1] neg_hi:[0,1]
    v_pk_fma_f32 v[26:27], v[32:33], v[32:33], v[26:27]
    v_cvt_pk_bf16_f32 v212, v32, v33
    v_lshlrev_b32 v34, 16, v213
    v_and_b32 v35, 0xffff0000, v213
    v_pk_add_f32 v[34:35], v[34:35], v[22:23] neg_lo:[0,1] neg_hi:[0,1]
    v_pk_fma_f32 v[28:29], v[34:35], v[34:35], v[28:29]
    v_cvt_pk_bf16_f32 v213, v34, v35
    v_lshlrev_b32 v36, 16, v214
    v_and_b32 v37, 0xffff0000, v214
    v_pk_add_f32 v[36:37], v[36:37], v[22:23] neg_lo:[0,1] neg_hi:[0,1]
    v_pk_fma_f32 v[26:27], v[36:37], v[36:37], v[26:27]
    v_cvt_pk_bf16_f32 v214, v36, v37
    v_lshlrev_b32 v38, 16, v215
    v_and_b32 v39, 0xffff0000, v215
    v_pk_add_f32 v[38:39], v[38:39], v[22:23] neg_lo:[0,1] neg_hi:[0,1]
    v_pk_fma_f32 v[28:29], v[38:39], v[38:39], v[28:29]
    v_cvt_pk_bf16_f32 v215, v38, v39
    v_lshlrev_b32 v32, 16, v216
    v_and_b32 v33, 0xffff0000, v216
    v_pk_add_f32 v[32:33], v[32:33], v[22:23] neg_lo:[0,1] neg_hi:[0,1]
    v_pk_fma_f32 v[26:27], v[32:33], v[32:33], v[26:27]
    v_cvt_pk_bf16_f32 v216, v32, v33
    v_lshlrev_b32 v34, 16, v217
    v_and_b32 v35, 0xffff0000, v217
    v_pk_add_f32 v[34:35], v[34:35], v[22:23] neg_lo:[0,1] neg_hi:[0,1]
    v_pk_fma_f32 v[28:29], v[34:35], v[34:35], v[28:29]
    v_cvt_pk_bf16_f32 v217, v34, v35
    v_lshlrev_b32 v36, 16, v218
    v_and_b32 v37, 0xffff0000, v218
    v_pk_add_f32 v[36:37], v[36:37], v[22:23] neg_lo:[0,1] neg_hi:[0,1]
    v_pk_fma_f32 v[26:27], v[36:37], v[36:37], v[26:27]
    v_cvt_pk_bf16_f32 v218, v36, v37
    v_lshlrev_b32 v38, 16, v219
    v_and_b32 v39, 0xffff0000, v219
    v_pk_add_f32 v[38:39], v[38:39], v[22:23] neg_lo:[0,1] neg_hi:[0,1]
    v_pk_fma_f32 v[28:29], v[38:39], v[38:39], v[28:29]
    v_cvt_pk_bf16_f32 v219, v38, v39
    v_lshlrev_b32 v32, 16, v220
    v_and_b32 v33, 0xffff0000, v220
    v_pk_add_f32 v[32:33], v[32:33], v[22:23] neg_lo:[0,1] neg_hi:[0,1]
    v_pk_fma_f32 v[26:27], v[32:33], v[32:33], v[26:27]
    v_cvt_pk_bf16_f32 v220, v32, v33
    v_lshlrev_b32 v34, 16, v221
    v_and_b32 v35, 0xffff0000, v221
    v_pk_add_f32 v[34:35], v[34:35], v[22:23] neg_lo:[0,1] neg_hi:[0,1]
    v_pk_fma_f32 v[28:29], v[34:35], v[34:35], v[28:29]
    v_cvt_pk_bf16_f32 v221, v34, v35
    v_lshlrev_b32 v36, 16, v222
    v_and_b32 v37, 0xffff0000, v222
    v_pk_add_f32 v[36:37], v[36:37], v[22:23] neg_lo:[0,1] neg_hi:[0,1]
    v_pk_fma_f32 v[26:27], v[36:37], v[36:37], v[26:27]
    v_cvt_pk_bf16_f32 v222, v36, v37
    v_lshlrev_b32 v38, 16, v223
    v_and_b32 v39, 0xffff0000, v223
    v_pk_add_f32 v[38:39], v[38:39], v[22:23] neg_lo:[0,1] neg_hi:[0,1]
    v_pk_fma_f32 v[28:29], v[38:39], v[38:39], v[28:29]
    v_cvt_pk_bf16_f32 v223, v38, v39
    v_lshlrev_b32 v32, 16, v224
    v_and_b32 v33, 0xffff0000, v224
    v_pk_add_f32 v[32:33], v[32:33], v[22:23] neg_lo:[0,1] neg_hi:[0,1]
    v_pk_fma_f32 v[26:27], v[32:33], v[32:33], v[26:27]
    v_cvt_pk_bf16_f32 v224, v32, v33
    v_lshlrev_b32 v34, 16, v225
    v_and_b32 v35, 0xffff0000, v225
    v_pk_add_f32 v[34:35], v[34:35], v[22:23] neg_lo:[0,1] neg_hi:[0,1]
    v_pk_fma_f32 v[28:29], v[34:35], v[34:35], v[28:29]
    v_cvt_pk_bf16_f32 v225, v34, v35
    v_lshlrev_b32 v36, 16, v226
    v_and_b32 v37, 0xffff0000, v226
    v_pk_add_f32 v[36:37], v[36:37], v[22:23] neg_lo:[0,1] neg_hi:[0,1]
    v_pk_fma_f32 v[26:27], v[36:37], v[36:37], v[26:27]
    v_cvt_pk_bf16_f32 v226, v36, v37
    v_lshlrev_b32 v38, 16, v227
    v_and_b32 v39, 0xffff0000, v227
    v_pk_add_f32 v[38:39], v[38:39], v[22:23] neg_lo:[0,1] neg_hi:[0,1]
    v_pk_fma_f32 v[28:29], v[38:39], v[38:39], v[28:29]
    v_cvt_pk_bf16_f32 v227, v38, v39
    v_lshlrev_b32 v32, 16, v228
    v_and_b32 v33, 0xffff0000, v228
    v_pk_add_f32 v[32:33], v[32:33], v[22:23] neg_lo:[0,1] neg_hi:[0,1]
    v_pk_fma_f32 v[26:27], v[32:33], v[32:33], v[26:27]
    v_cvt_pk_bf16_f32 v228, v32, v33
    v_lshlrev_b32 v34, 16, v229
    v_and_b32 v35, 0xffff0000, v229
    v_pk_add_f32 v[34:35], v[34:35], v[22:23] neg_lo:[0,1] neg_hi:[0,1]
    v_pk_fma_f32 v[28:29], v[34:35], v[34:35], v[28:29]
    v_cvt_pk_bf16_f32 v229, v34, v35
    v_lshlrev_b32 v36, 16, v230
    v_and_b32 v37, 0xffff0000, v230
    v_pk_add_f32 v[36:37], v[36:37], v[22:23] neg_lo:[0,1] neg_hi:[0,1]
    v_pk_fma_f32 v[26:27], v[36:37], v[36:37], v[26:27]
    v_cvt_pk_bf16_f32 v230, v36, v37
    v_lshlrev_b32 v38, 16, v231
    v_and_b32 v39, 0xffff0000, v231
    v_pk_add_f32 v[38:39], v[38:39], v[22:23] neg_lo:[0,1] neg_hi:[0,1]
    v_pk_fma_f32 v[28:29], v[38:39], v[38:39], v[28:29]
    v_cvt_pk_bf16_f32 v231, v38, v39
    v_lshlrev_b32 v32, 16, v232
    v_and_b32 v33, 0xffff0000, v232
    v_pk_add_f32 v[32:33], v[32:33], v[22:23] neg_lo:[0,1] neg_hi:[0,1]
    v_pk_fma_f32 v[26:27], v[32:33], v[32:33], v[26:27]
    v_cvt_pk_bf16_f32 v232, v32, v33
    v_lshlrev_b32 v34, 16, v233
    v_and_b32 v35, 0xffff0000, v233
    v_pk_add_f32 v[34:35], v[34:35], v[22:23] neg_lo:[0,1] neg_hi:[0,1]
    v_pk_fma_f32 v[28:29], v[34:35], v[34:35], v[28:29]
    v_cvt_pk_bf16_f32 v233, v34, v35
    v_lshlrev_b32 v36, 16, v234
    v_and_b32 v37, 0xffff0000, v234
    v_pk_add_f32 v[36:37], v[36:37], v[22:23] neg_lo:[0,1] neg_hi:[0,1]
    v_pk_fma_f32 v[26:27], v[36:37], v[36:37], v[26:27]
    v_cvt_pk_bf16_f32 v234, v36, v37
    v_lshlrev_b32 v38, 16, v235
    v_and_b32 v39, 0xffff0000, v235
    v_pk_add_f32 v[38:39], v[38:39], v[22:23] neg_lo:[0,1] neg_hi:[0,1]
    v_pk_fma_f32 v[28:29], v[38:39], v[38:39], v[28:29]
    v_cvt_pk_bf16_f32 v235, v38, v39
    v_lshlrev_b32 v32, 16, v236
    v_and_b32 v33, 0xffff0000, v236
    v_pk_add_f32 v[32:33], v[32:33], v[22:23] neg_lo:[0,1] neg_hi:[0,1]
    v_pk_fma_f32 v[26:27], v[32:33], v[32:33], v[26:27]
    v_cvt_pk_bf16_f32 v236, v32, v33
    v_lshlrev_b32 v34, 16, v237
    v_and_b32 v35, 0xffff0000, v237
    v_pk_add_f32 v[34:35], v[34:35], v[22:23] neg_lo:[0,1] neg_hi:[0,1]
    v_pk_fma_f32 v[28:29], v[34:35], v[34:35], v[28:29]
    v_cvt_pk_bf16_f32 v237, v34, v35
    v_lshlrev_b32 v36, 16, v238
    v_and_b32 v37, 0xffff0000, v238
    v_pk_add_f32 v[36:37], v[36:37], v[22:23] neg_lo:[0,1] neg_hi:[0,1]
    v_pk_fma_f32 v[26:27], v[36:37], v[36:37], v[26:27]
    v_cvt_pk_bf16_f32 v238, v36, v37
    v_lshlrev_b32 v38, 16, v239
    v_and_b32 v39, 0xffff0000, v239
    v_pk_add_f32 v[38:39], v[38:39], v[22:23] neg_lo:[0,1] neg_hi:[0,1]
    v_pk_fma_f32 v[28:29], v[38:39], v[38:39], v[28:29]
    v_cvt_pk_bf16_f32 v239, v38, v39
    v_lshlrev_b32 v32, 16, v240
    v_and_b32 v33, 0xffff0000, v240
    v_pk_add_f32 v[32:33], v[32:33], v[22:23] neg_lo:[0,1] neg_hi:[0,1]
    v_pk_fma_f32 v[26:27], v[32:33], v[32:33], v[26:27]
    v_cvt_pk_bf16_f32 v240, v32, v33
    v_lshlrev_b32 v34, 16, v241
    v_and_b32 v35, 0xffff0000, v241
    v_pk_add_f32 v[34:35], v[34:35], v[22:23] neg_lo:[0,1] neg_hi:[0,1]
    v_pk_fma_f32 v[28:29], v[34:35], v[34:35], v[28:29]
    v_cvt_pk_bf16_f32 v241, v34, v35
    v_lshlrev_b32 v36, 16, v242
    v_and_b32 v37, 0xffff0000, v242
    v_pk_add_f32 v[36:37], v[36:37], v[22:23] neg_lo:[0,1] neg_hi:[0,1]
    v_pk_fma_f32 v[26:27], v[36:37], v[36:37], v[26:27]
    v_cvt_pk_bf16_f32 v242, v36, v37
    v_lshlrev_b32 v38, 16, v243
    v_and_b32 v39, 0xffff0000, v243
    v_pk_add_f32 v[38:39], v[38:39], v[22:23] neg_lo:[0,1] neg_hi:[0,1]
    v_pk_fma_f32 v[28:29], v[38:39], v[38:39], v[28:29]
    v_cvt_pk_bf16_f32 v243, v38, v39
    v_lshlrev_b32 v32, 16, v244
    v_and_b32 v33, 0xffff0000, v244
    v_pk_add_f32 v[32:33], v[32:33], v[22:23] neg_lo:[0,1] neg_hi:[0,1]
    v_pk_fma_f32 v[26:27], v[32:33], v[32:33], v[26:27]
    v_cvt_pk_bf16_f32 v244, v32, v33
    v_lshlrev_b32 v34, 16, v245
    v_and_b32 v35, 0xffff0000, v245
    v_pk_add_f32 v[34:35], v[34:35], v[22:23] neg_lo:[0,1] neg_hi:[0,1]
    v_pk_fma_f32 v[28:29], v[34:35], v[34:35], v[28:29]
    v_cvt_pk_bf16_f32 v245, v34, v35
    v_lshlrev_b32 v36, 16, v246
    v_and_b32 v37, 0xffff0000, v246
    v_pk_add_f32 v[36:37], v[36:37], v[22:23] neg_lo:[0,1] neg_hi:[0,1]
    v_pk_fma_f32 v[26:27], v[36:37], v[36:37], v[26:27]
    v_cvt_pk_bf16_f32 v246, v36, v37
    v_lshlrev_b32 v38, 16, v247
    v_and_b32 v39, 0xffff0000, v247
    v_pk_add_f32 v[38:39], v[38:39], v[22:23] neg_lo:[0,1] neg_hi:[0,1]
    v_pk_fma_f32 v[28:29], v[38:39], v[38:39], v[28:29]
    v_cvt_pk_bf16_f32 v247, v38, v39
    v_lshlrev_b32 v32, 16, v248
    v_and_b32 v33, 0xffff0000, v248
    v_pk_add_f32 v[32:33], v[32:33], v[22:23] neg_lo:[0,1] neg_hi:[0,1]
    v_pk_fma_f32 v[26:27], v[32:33], v[32:33], v[26:27]
    v_cvt_pk_bf16_f32 v248, v32, v33
    v_lshlrev_b32 v34, 16, v249
    v_and_b32 v35, 0xffff0000, v249
    v_pk_add_f32 v[34:35], v[34:35], v[22:23] neg_lo:[0,1] neg_hi:[0,1]
    v_pk_fma_f32 v[28:29], v[34:35], v[34:35], v[28:29]
    v_cvt_pk_bf16_f32 v249, v34, v35
    v_lshlrev_b32 v36, 16, v250
    v_and_b32 v37, 0xffff0000, v250
    v_pk_add_f32 v[36:37], v[36:37], v[22:23] neg_lo:[0,1] neg_hi:[0,1]
    v_pk_fma_f32 v[26:27], v[36:37], v[36:37], v[26:27]
    v_cvt_pk_bf16_f32 v250, v36, v37
    v_lshlrev_b32 v38, 16, v251
    v_and_b32 v39, 0xffff0000, v251
    v_pk_add_f32 v[38:39], v[38:39], v[22:23] neg_lo:[0,1] neg_hi:[0,1]
    v_pk_fma_f32 v[28:29], v[38:39], v[38:39], v[28:29]
    v_cvt_pk_bf16_f32 v251, v38, v39
    v_lshlrev_b32 v32, 16, v252
    v_and_b32 v33, 0xffff0000, v252
    v_pk_add_f32 v[32:33], v[32:33], v[22:23] neg_lo:[0,1] neg_hi:[0,1]
    v_pk_fma_f32 v[26:27], v[32:33], v[32:33], v[26:27]
    v_cvt_pk_bf16_f32 v252, v32, v33
    v_lshlrev_b32 v34, 16, v253
    v_and_b32 v35, 0xffff0000, v253
    v_pk_add_f32 v[34:35], v[34:35], v[22:23] neg_lo:[0,1] neg_hi:[0,1]
    v_pk_fma_f32 v[28:29], v[34:35], v[34:35], v[28:29]
    v_cvt_pk_bf16_f32 v253, v34, v35
    v_lshlrev_b32 v36, 16, v254
    v_and_b32 v37, 0xffff0000, v254
    v_pk_add_f32 v[36:37], v[36:37], v[22:23] neg_lo:[0,1] neg_hi:[0,1]
    v_pk_fma_f32 v[26:27], v[36:37], v[36:37], v[26:27]
    v_cvt_pk_bf16_f32 v254, v36, v37
    v_lshlrev_b32 v38, 16, v255
    v_and_b32 v39, 0xffff0000, v255
    v_pk_add_f32 v[38:39], v[38:39], v[22:23] neg_lo:[0,1] neg_hi:[0,1]
    v_pk_fma_f32 v[28:29], v[38:39], v[38:39], v[28:29]
    v_cvt_pk_bf16_f32 v255, v38, v39
    v_pk_add_f32 v[26:27], v[26:27], v[28:29]
    v_add_f32 v26, v26, v27
    v_mov_b32 v27, v26
    s_nop 1
    v_permlane32_swap_b32 v26, v27
    v_add_f32 v26, v26, v27
    v_mul_f32 v26, 0x3ae38e39, v26
    v_fma_f32 v26, -v24, v24, v26
    v_max_f32 v26, 0, v26
    v_cvt_pk_bf16_f32 v26, v26, v26
    v_lshlrev_b32 v26, 16, v26
    v_add_f32 v26, 0x3727c5ac, v26
    v_cvt_pk_bf16_f32 v26, v26, v26
    v_lshlrev_b32 v26, 16, v26
    v_sqrt_f32 v26, v26
    s_nop 0
    v_cvt_pk_bf16_f32 v26, v26, v26
    v_lshlrev_b32 v26, 16, v26
    v_rcp_f32 v26, v26
    s_nop 0
    v_mov_b32 v27, v26
    v_lshlrev_b32 v32, 16, v112
    v_and_b32 v33, 0xffff0000, v112
    v_pk_mul_f32 v[32:33], v[32:33], v[26:27]
    v_cvt_pk_bf16_f32 v112, v32, v33
    v_lshlrev_b32 v34, 16, v113
    v_and_b32 v35, 0xffff0000, v113
    v_pk_mul_f32 v[34:35], v[34:35], v[26:27]
    v_cvt_pk_bf16_f32 v113, v34, v35
    v_lshlrev_b32 v36, 16, v114
    v_and_b32 v37, 0xffff0000, v114
    v_pk_mul_f32 v[36:37], v[36:37], v[26:27]
    v_cvt_pk_bf16_f32 v114, v36, v37
    v_lshlrev_b32 v38, 16, v115
    v_and_b32 v39, 0xffff0000, v115
    v_pk_mul_f32 v[38:39], v[38:39], v[26:27]
    v_cvt_pk_bf16_f32 v115, v38, v39
    v_lshlrev_b32 v32, 16, v116
    v_and_b32 v33, 0xffff0000, v116
    v_pk_mul_f32 v[32:33], v[32:33], v[26:27]
    v_cvt_pk_bf16_f32 v116, v32, v33
    v_lshlrev_b32 v34, 16, v117
    v_and_b32 v35, 0xffff0000, v117
    v_pk_mul_f32 v[34:35], v[34:35], v[26:27]
    v_cvt_pk_bf16_f32 v117, v34, v35
    v_lshlrev_b32 v36, 16, v118
    v_and_b32 v37, 0xffff0000, v118
    v_pk_mul_f32 v[36:37], v[36:37], v[26:27]
    v_cvt_pk_bf16_f32 v118, v36, v37
    v_lshlrev_b32 v38, 16, v119
    v_and_b32 v39, 0xffff0000, v119
    v_pk_mul_f32 v[38:39], v[38:39], v[26:27]
    v_cvt_pk_bf16_f32 v119, v38, v39
    v_lshlrev_b32 v32, 16, v120
    v_and_b32 v33, 0xffff0000, v120
    v_pk_mul_f32 v[32:33], v[32:33], v[26:27]
    v_cvt_pk_bf16_f32 v120, v32, v33
    v_lshlrev_b32 v34, 16, v121
    v_and_b32 v35, 0xffff0000, v121
    v_pk_mul_f32 v[34:35], v[34:35], v[26:27]
    v_cvt_pk_bf16_f32 v121, v34, v35
    v_lshlrev_b32 v36, 16, v122
    v_and_b32 v37, 0xffff0000, v122
    v_pk_mul_f32 v[36:37], v[36:37], v[26:27]
    v_cvt_pk_bf16_f32 v122, v36, v37
    v_lshlrev_b32 v38, 16, v123
    v_and_b32 v39, 0xffff0000, v123
    v_pk_mul_f32 v[38:39], v[38:39], v[26:27]
    v_cvt_pk_bf16_f32 v123, v38, v39
    v_lshlrev_b32 v32, 16, v124
    v_and_b32 v33, 0xffff0000, v124
    v_pk_mul_f32 v[32:33], v[32:33], v[26:27]
    v_cvt_pk_bf16_f32 v124, v32, v33
    v_lshlrev_b32 v34, 16, v125
    v_and_b32 v35, 0xffff0000, v125
    v_pk_mul_f32 v[34:35], v[34:35], v[26:27]
    v_cvt_pk_bf16_f32 v125, v34, v35
    v_lshlrev_b32 v36, 16, v126
    v_and_b32 v37, 0xffff0000, v126
    v_pk_mul_f32 v[36:37], v[36:37], v[26:27]
    v_cvt_pk_bf16_f32 v126, v36, v37
    v_lshlrev_b32 v38, 16, v127
    v_and_b32 v39, 0xffff0000, v127
    v_pk_mul_f32 v[38:39], v[38:39], v[26:27]
    v_cvt_pk_bf16_f32 v127, v38, v39
    v_lshlrev_b32 v32, 16, v128
    v_and_b32 v33, 0xffff0000, v128
    v_pk_mul_f32 v[32:33], v[32:33], v[26:27]
    v_cvt_pk_bf16_f32 v128, v32, v33
    v_lshlrev_b32 v34, 16, v129
    v_and_b32 v35, 0xffff0000, v129
    v_pk_mul_f32 v[34:35], v[34:35], v[26:27]
    v_cvt_pk_bf16_f32 v129, v34, v35
    v_lshlrev_b32 v36, 16, v130
    v_and_b32 v37, 0xffff0000, v130
    v_pk_mul_f32 v[36:37], v[36:37], v[26:27]
    v_cvt_pk_bf16_f32 v130, v36, v37
    v_lshlrev_b32 v38, 16, v131
    v_and_b32 v39, 0xffff0000, v131
    v_pk_mul_f32 v[38:39], v[38:39], v[26:27]
    v_cvt_pk_bf16_f32 v131, v38, v39
    v_lshlrev_b32 v32, 16, v132
    v_and_b32 v33, 0xffff0000, v132
    v_pk_mul_f32 v[32:33], v[32:33], v[26:27]
    v_cvt_pk_bf16_f32 v132, v32, v33
    v_lshlrev_b32 v34, 16, v133
    v_and_b32 v35, 0xffff0000, v133
    v_pk_mul_f32 v[34:35], v[34:35], v[26:27]
    v_cvt_pk_bf16_f32 v133, v34, v35
    v_lshlrev_b32 v36, 16, v134
    v_and_b32 v37, 0xffff0000, v134
    v_pk_mul_f32 v[36:37], v[36:37], v[26:27]
    v_cvt_pk_bf16_f32 v134, v36, v37
    v_lshlrev_b32 v38, 16, v135
    v_and_b32 v39, 0xffff0000, v135
    v_pk_mul_f32 v[38:39], v[38:39], v[26:27]
    v_cvt_pk_bf16_f32 v135, v38, v39
    v_lshlrev_b32 v32, 16, v136
    v_and_b32 v33, 0xffff0000, v136
    v_pk_mul_f32 v[32:33], v[32:33], v[26:27]
    v_cvt_pk_bf16_f32 v136, v32, v33
    v_lshlrev_b32 v34, 16, v137
    v_and_b32 v35, 0xffff0000, v137
    v_pk_mul_f32 v[34:35], v[34:35], v[26:27]
    v_cvt_pk_bf16_f32 v137, v34, v35
    v_lshlrev_b32 v36, 16, v138
    v_and_b32 v37, 0xffff0000, v138
    v_pk_mul_f32 v[36:37], v[36:37], v[26:27]
    v_cvt_pk_bf16_f32 v138, v36, v37
    v_lshlrev_b32 v38, 16, v139
    v_and_b32 v39, 0xffff0000, v139
    v_pk_mul_f32 v[38:39], v[38:39], v[26:27]
    v_cvt_pk_bf16_f32 v139, v38, v39
    v_lshlrev_b32 v32, 16, v140
    v_and_b32 v33, 0xffff0000, v140
    v_pk_mul_f32 v[32:33], v[32:33], v[26:27]
    v_cvt_pk_bf16_f32 v140, v32, v33
    v_lshlrev_b32 v34, 16, v141
    v_and_b32 v35, 0xffff0000, v141
    v_pk_mul_f32 v[34:35], v[34:35], v[26:27]
    v_cvt_pk_bf16_f32 v141, v34, v35
    v_lshlrev_b32 v36, 16, v142
    v_and_b32 v37, 0xffff0000, v142
    v_pk_mul_f32 v[36:37], v[36:37], v[26:27]
    v_cvt_pk_bf16_f32 v142, v36, v37
    v_lshlrev_b32 v38, 16, v143
    v_and_b32 v39, 0xffff0000, v143
    v_pk_mul_f32 v[38:39], v[38:39], v[26:27]
    v_cvt_pk_bf16_f32 v143, v38, v39
    v_lshlrev_b32 v32, 16, v144
    v_and_b32 v33, 0xffff0000, v144
    v_pk_mul_f32 v[32:33], v[32:33], v[26:27]
    v_cvt_pk_bf16_f32 v144, v32, v33
    v_lshlrev_b32 v34, 16, v145
    v_and_b32 v35, 0xffff0000, v145
    v_pk_mul_f32 v[34:35], v[34:35], v[26:27]
    v_cvt_pk_bf16_f32 v145, v34, v35
    v_lshlrev_b32 v36, 16, v146
    v_and_b32 v37, 0xffff0000, v146
    v_pk_mul_f32 v[36:37], v[36:37], v[26:27]
    v_cvt_pk_bf16_f32 v146, v36, v37
    v_lshlrev_b32 v38, 16, v147
    v_and_b32 v39, 0xffff0000, v147
    v_pk_mul_f32 v[38:39], v[38:39], v[26:27]
    v_cvt_pk_bf16_f32 v147, v38, v39
    v_lshlrev_b32 v32, 16, v148
    v_and_b32 v33, 0xffff0000, v148
    v_pk_mul_f32 v[32:33], v[32:33], v[26:27]
    v_cvt_pk_bf16_f32 v148, v32, v33
    v_lshlrev_b32 v34, 16, v149
    v_and_b32 v35, 0xffff0000, v149
    v_pk_mul_f32 v[34:35], v[34:35], v[26:27]
    v_cvt_pk_bf16_f32 v149, v34, v35
    v_lshlrev_b32 v36, 16, v150
    v_and_b32 v37, 0xffff0000, v150
    v_pk_mul_f32 v[36:37], v[36:37], v[26:27]
    v_cvt_pk_bf16_f32 v150, v36, v37
    v_lshlrev_b32 v38, 16, v151
    v_and_b32 v39, 0xffff0000, v151
    v_pk_mul_f32 v[38:39], v[38:39], v[26:27]
    v_cvt_pk_bf16_f32 v151, v38, v39
    v_lshlrev_b32 v32, 16, v152
    v_and_b32 v33, 0xffff0000, v152
    v_pk_mul_f32 v[32:33], v[32:33], v[26:27]
    v_cvt_pk_bf16_f32 v152, v32, v33
    v_lshlrev_b32 v34, 16, v153
    v_and_b32 v35, 0xffff0000, v153
    v_pk_mul_f32 v[34:35], v[34:35], v[26:27]
    v_cvt_pk_bf16_f32 v153, v34, v35
    v_lshlrev_b32 v36, 16, v154
    v_and_b32 v37, 0xffff0000, v154
    v_pk_mul_f32 v[36:37], v[36:37], v[26:27]
    v_cvt_pk_bf16_f32 v154, v36, v37
    v_lshlrev_b32 v38, 16, v155
    v_and_b32 v39, 0xffff0000, v155
    v_pk_mul_f32 v[38:39], v[38:39], v[26:27]
    v_cvt_pk_bf16_f32 v155, v38, v39
    v_lshlrev_b32 v32, 16, v156
    v_and_b32 v33, 0xffff0000, v156
    v_pk_mul_f32 v[32:33], v[32:33], v[26:27]
    v_cvt_pk_bf16_f32 v156, v32, v33
    v_lshlrev_b32 v34, 16, v157
    v_and_b32 v35, 0xffff0000, v157
    v_pk_mul_f32 v[34:35], v[34:35], v[26:27]
    v_cvt_pk_bf16_f32 v157, v34, v35
    v_lshlrev_b32 v36, 16, v158
    v_and_b32 v37, 0xffff0000, v158
    v_pk_mul_f32 v[36:37], v[36:37], v[26:27]
    v_cvt_pk_bf16_f32 v158, v36, v37
    v_lshlrev_b32 v38, 16, v159
    v_and_b32 v39, 0xffff0000, v159
    v_pk_mul_f32 v[38:39], v[38:39], v[26:27]
    v_cvt_pk_bf16_f32 v159, v38, v39
    v_lshlrev_b32 v32, 16, v160
    v_and_b32 v33, 0xffff0000, v160
    v_pk_mul_f32 v[32:33], v[32:33], v[26:27]
    v_cvt_pk_bf16_f32 v160, v32, v33
    v_lshlrev_b32 v34, 16, v161
    v_and_b32 v35, 0xffff0000, v161
    v_pk_mul_f32 v[34:35], v[34:35], v[26:27]
    v_cvt_pk_bf16_f32 v161, v34, v35
    v_lshlrev_b32 v36, 16, v162
    v_and_b32 v37, 0xffff0000, v162
    v_pk_mul_f32 v[36:37], v[36:37], v[26:27]
    v_cvt_pk_bf16_f32 v162, v36, v37
    v_lshlrev_b32 v38, 16, v163
    v_and_b32 v39, 0xffff0000, v163
    v_pk_mul_f32 v[38:39], v[38:39], v[26:27]
    v_cvt_pk_bf16_f32 v163, v38, v39
    v_lshlrev_b32 v32, 16, v164
    v_and_b32 v33, 0xffff0000, v164
    v_pk_mul_f32 v[32:33], v[32:33], v[26:27]
    v_cvt_pk_bf16_f32 v164, v32, v33
    v_lshlrev_b32 v34, 16, v165
    v_and_b32 v35, 0xffff0000, v165
    v_pk_mul_f32 v[34:35], v[34:35], v[26:27]
    v_cvt_pk_bf16_f32 v165, v34, v35
    v_lshlrev_b32 v36, 16, v166
    v_and_b32 v37, 0xffff0000, v166
    v_pk_mul_f32 v[36:37], v[36:37], v[26:27]
    v_cvt_pk_bf16_f32 v166, v36, v37
    v_lshlrev_b32 v38, 16, v167
    v_and_b32 v39, 0xffff0000, v167
    v_pk_mul_f32 v[38:39], v[38:39], v[26:27]
    v_cvt_pk_bf16_f32 v167, v38, v39
    v_lshlrev_b32 v32, 16, v168
    v_and_b32 v33, 0xffff0000, v168
    v_pk_mul_f32 v[32:33], v[32:33], v[26:27]
    v_cvt_pk_bf16_f32 v168, v32, v33
    v_lshlrev_b32 v34, 16, v169
    v_and_b32 v35, 0xffff0000, v169
    v_pk_mul_f32 v[34:35], v[34:35], v[26:27]
    v_cvt_pk_bf16_f32 v169, v34, v35
    v_lshlrev_b32 v36, 16, v170
    v_and_b32 v37, 0xffff0000, v170
    v_pk_mul_f32 v[36:37], v[36:37], v[26:27]
    v_cvt_pk_bf16_f32 v170, v36, v37
    v_lshlrev_b32 v38, 16, v171
    v_and_b32 v39, 0xffff0000, v171
    v_pk_mul_f32 v[38:39], v[38:39], v[26:27]
    v_cvt_pk_bf16_f32 v171, v38, v39
    v_lshlrev_b32 v32, 16, v172
    v_and_b32 v33, 0xffff0000, v172
    v_pk_mul_f32 v[32:33], v[32:33], v[26:27]
    v_cvt_pk_bf16_f32 v172, v32, v33
    v_lshlrev_b32 v34, 16, v173
    v_and_b32 v35, 0xffff0000, v173
    v_pk_mul_f32 v[34:35], v[34:35], v[26:27]
    v_cvt_pk_bf16_f32 v173, v34, v35
    v_lshlrev_b32 v36, 16, v174
    v_and_b32 v37, 0xffff0000, v174
    v_pk_mul_f32 v[36:37], v[36:37], v[26:27]
    v_cvt_pk_bf16_f32 v174, v36, v37
    v_lshlrev_b32 v38, 16, v175
    v_and_b32 v39, 0xffff0000, v175
    v_pk_mul_f32 v[38:39], v[38:39], v[26:27]
    v_cvt_pk_bf16_f32 v175, v38, v39
    v_lshlrev_b32 v32, 16, v176
    v_and_b32 v33, 0xffff0000, v176
    v_pk_mul_f32 v[32:33], v[32:33], v[26:27]
    v_cvt_pk_bf16_f32 v176, v32, v33
    v_lshlrev_b32 v34, 16, v177
    v_and_b32 v35, 0xffff0000, v177
    v_pk_mul_f32 v[34:35], v[34:35], v[26:27]
    v_cvt_pk_bf16_f32 v177, v34, v35
    v_lshlrev_b32 v36, 16, v178
    v_and_b32 v37, 0xffff0000, v178
    v_pk_mul_f32 v[36:37], v[36:37], v[26:27]
    v_cvt_pk_bf16_f32 v178, v36, v37
    v_lshlrev_b32 v38, 16, v179
    v_and_b32 v39, 0xffff0000, v179
    v_pk_mul_f32 v[38:39], v[38:39], v[26:27]
    v_cvt_pk_bf16_f32 v179, v38, v39
    v_lshlrev_b32 v32, 16, v180
    v_and_b32 v33, 0xffff0000, v180
    v_pk_mul_f32 v[32:33], v[32:33], v[26:27]
    v_cvt_pk_bf16_f32 v180, v32, v33
    v_lshlrev_b32 v34, 16, v181
    v_and_b32 v35, 0xffff0000, v181
    v_pk_mul_f32 v[34:35], v[34:35], v[26:27]
    v_cvt_pk_bf16_f32 v181, v34, v35
    v_lshlrev_b32 v36, 16, v182
    v_and_b32 v37, 0xffff0000, v182
    v_pk_mul_f32 v[36:37], v[36:37], v[26:27]
    v_cvt_pk_bf16_f32 v182, v36, v37
    v_lshlrev_b32 v38, 16, v183
    v_and_b32 v39, 0xffff0000, v183
    v_pk_mul_f32 v[38:39], v[38:39], v[26:27]
    v_cvt_pk_bf16_f32 v183, v38, v39
    v_lshlrev_b32 v32, 16, v184
    v_and_b32 v33, 0xffff0000, v184
    v_pk_mul_f32 v[32:33], v[32:33], v[26:27]
    v_cvt_pk_bf16_f32 v184, v32, v33
    v_lshlrev_b32 v34, 16, v185
    v_and_b32 v35, 0xffff0000, v185
    v_pk_mul_f32 v[34:35], v[34:35], v[26:27]
    v_cvt_pk_bf16_f32 v185, v34, v35
    v_lshlrev_b32 v36, 16, v186
    v_and_b32 v37, 0xffff0000, v186
    v_pk_mul_f32 v[36:37], v[36:37], v[26:27]
    v_cvt_pk_bf16_f32 v186, v36, v37
    v_lshlrev_b32 v38, 16, v187
    v_and_b32 v39, 0xffff0000, v187
    v_pk_mul_f32 v[38:39], v[38:39], v[26:27]
    v_cvt_pk_bf16_f32 v187, v38, v39
    v_lshlrev_b32 v32, 16, v188
    v_and_b32 v33, 0xffff0000, v188
    v_pk_mul_f32 v[32:33], v[32:33], v[26:27]
    v_cvt_pk_bf16_f32 v188, v32, v33
    v_lshlrev_b32 v34, 16, v189
    v_and_b32 v35, 0xffff0000, v189
    v_pk_mul_f32 v[34:35], v[34:35], v[26:27]
    v_cvt_pk_bf16_f32 v189, v34, v35
    v_lshlrev_b32 v36, 16, v190
    v_and_b32 v37, 0xffff0000, v190
    v_pk_mul_f32 v[36:37], v[36:37], v[26:27]
    v_cvt_pk_bf16_f32 v190, v36, v37
    v_lshlrev_b32 v38, 16, v191
    v_and_b32 v39, 0xffff0000, v191
    v_pk_mul_f32 v[38:39], v[38:39], v[26:27]
    v_cvt_pk_bf16_f32 v191, v38, v39
    v_lshlrev_b32 v32, 16, v192
    v_and_b32 v33, 0xffff0000, v192
    v_pk_mul_f32 v[32:33], v[32:33], v[26:27]
    v_cvt_pk_bf16_f32 v192, v32, v33
    v_lshlrev_b32 v34, 16, v193
    v_and_b32 v35, 0xffff0000, v193
    v_pk_mul_f32 v[34:35], v[34:35], v[26:27]
    v_cvt_pk_bf16_f32 v193, v34, v35
    v_lshlrev_b32 v36, 16, v194
    v_and_b32 v37, 0xffff0000, v194
    v_pk_mul_f32 v[36:37], v[36:37], v[26:27]
    v_cvt_pk_bf16_f32 v194, v36, v37
    v_lshlrev_b32 v38, 16, v195
    v_and_b32 v39, 0xffff0000, v195
    v_pk_mul_f32 v[38:39], v[38:39], v[26:27]
    v_cvt_pk_bf16_f32 v195, v38, v39
    v_lshlrev_b32 v32, 16, v196
    v_and_b32 v33, 0xffff0000, v196
    v_pk_mul_f32 v[32:33], v[32:33], v[26:27]
    v_cvt_pk_bf16_f32 v196, v32, v33
    v_lshlrev_b32 v34, 16, v197
    v_and_b32 v35, 0xffff0000, v197
    v_pk_mul_f32 v[34:35], v[34:35], v[26:27]
    v_cvt_pk_bf16_f32 v197, v34, v35
    v_lshlrev_b32 v36, 16, v198
    v_and_b32 v37, 0xffff0000, v198
    v_pk_mul_f32 v[36:37], v[36:37], v[26:27]
    v_cvt_pk_bf16_f32 v198, v36, v37
    v_lshlrev_b32 v38, 16, v199
    v_and_b32 v39, 0xffff0000, v199
    v_pk_mul_f32 v[38:39], v[38:39], v[26:27]
    v_cvt_pk_bf16_f32 v199, v38, v39
    v_lshlrev_b32 v32, 16, v200
    v_and_b32 v33, 0xffff0000, v200
    v_pk_mul_f32 v[32:33], v[32:33], v[26:27]
    v_cvt_pk_bf16_f32 v200, v32, v33
    v_lshlrev_b32 v34, 16, v201
    v_and_b32 v35, 0xffff0000, v201
    v_pk_mul_f32 v[34:35], v[34:35], v[26:27]
    v_cvt_pk_bf16_f32 v201, v34, v35
    v_lshlrev_b32 v36, 16, v202
    v_and_b32 v37, 0xffff0000, v202
    v_pk_mul_f32 v[36:37], v[36:37], v[26:27]
    v_cvt_pk_bf16_f32 v202, v36, v37
    v_lshlrev_b32 v38, 16, v203
    v_and_b32 v39, 0xffff0000, v203
    v_pk_mul_f32 v[38:39], v[38:39], v[26:27]
    v_cvt_pk_bf16_f32 v203, v38, v39
    v_lshlrev_b32 v32, 16, v204
    v_and_b32 v33, 0xffff0000, v204
    v_pk_mul_f32 v[32:33], v[32:33], v[26:27]
    v_cvt_pk_bf16_f32 v204, v32, v33
    v_lshlrev_b32 v34, 16, v205
    v_and_b32 v35, 0xffff0000, v205
    v_pk_mul_f32 v[34:35], v[34:35], v[26:27]
    v_cvt_pk_bf16_f32 v205, v34, v35
    v_lshlrev_b32 v36, 16, v206
    v_and_b32 v37, 0xffff0000, v206
    v_pk_mul_f32 v[36:37], v[36:37], v[26:27]
    v_cvt_pk_bf16_f32 v206, v36, v37
    v_lshlrev_b32 v38, 16, v207
    v_and_b32 v39, 0xffff0000, v207
    v_pk_mul_f32 v[38:39], v[38:39], v[26:27]
    v_cvt_pk_bf16_f32 v207, v38, v39
    v_lshlrev_b32 v32, 16, v208
    v_and_b32 v33, 0xffff0000, v208
    v_pk_mul_f32 v[32:33], v[32:33], v[26:27]
    v_cvt_pk_bf16_f32 v208, v32, v33
    v_lshlrev_b32 v34, 16, v209
    v_and_b32 v35, 0xffff0000, v209
    v_pk_mul_f32 v[34:35], v[34:35], v[26:27]
    v_cvt_pk_bf16_f32 v209, v34, v35
    v_lshlrev_b32 v36, 16, v210
    v_and_b32 v37, 0xffff0000, v210
    v_pk_mul_f32 v[36:37], v[36:37], v[26:27]
    v_cvt_pk_bf16_f32 v210, v36, v37
    v_lshlrev_b32 v38, 16, v211
    v_and_b32 v39, 0xffff0000, v211
    v_pk_mul_f32 v[38:39], v[38:39], v[26:27]
    v_cvt_pk_bf16_f32 v211, v38, v39
    v_lshlrev_b32 v32, 16, v212
    v_and_b32 v33, 0xffff0000, v212
    v_pk_mul_f32 v[32:33], v[32:33], v[26:27]
    v_cvt_pk_bf16_f32 v212, v32, v33
    v_lshlrev_b32 v34, 16, v213
    v_and_b32 v35, 0xffff0000, v213
    v_pk_mul_f32 v[34:35], v[34:35], v[26:27]
    v_cvt_pk_bf16_f32 v213, v34, v35
    v_lshlrev_b32 v36, 16, v214
    v_and_b32 v37, 0xffff0000, v214
    v_pk_mul_f32 v[36:37], v[36:37], v[26:27]
    v_cvt_pk_bf16_f32 v214, v36, v37
    v_lshlrev_b32 v38, 16, v215
    v_and_b32 v39, 0xffff0000, v215
    v_pk_mul_f32 v[38:39], v[38:39], v[26:27]
    v_cvt_pk_bf16_f32 v215, v38, v39
    v_lshlrev_b32 v32, 16, v216
    v_and_b32 v33, 0xffff0000, v216
    v_pk_mul_f32 v[32:33], v[32:33], v[26:27]
    v_cvt_pk_bf16_f32 v216, v32, v33
    v_lshlrev_b32 v34, 16, v217
    v_and_b32 v35, 0xffff0000, v217
    v_pk_mul_f32 v[34:35], v[34:35], v[26:27]
    v_cvt_pk_bf16_f32 v217, v34, v35
    v_lshlrev_b32 v36, 16, v218
    v_and_b32 v37, 0xffff0000, v218
    v_pk_mul_f32 v[36:37], v[36:37], v[26:27]
    v_cvt_pk_bf16_f32 v218, v36, v37
    v_lshlrev_b32 v38, 16, v219
    v_and_b32 v39, 0xffff0000, v219
    v_pk_mul_f32 v[38:39], v[38:39], v[26:27]
    v_cvt_pk_bf16_f32 v219, v38, v39
    v_lshlrev_b32 v32, 16, v220
    v_and_b32 v33, 0xffff0000, v220
    v_pk_mul_f32 v[32:33], v[32:33], v[26:27]
    v_cvt_pk_bf16_f32 v220, v32, v33
    v_lshlrev_b32 v34, 16, v221
    v_and_b32 v35, 0xffff0000, v221
    v_pk_mul_f32 v[34:35], v[34:35], v[26:27]
    v_cvt_pk_bf16_f32 v221, v34, v35
    v_lshlrev_b32 v36, 16, v222
    v_and_b32 v37, 0xffff0000, v222
    v_pk_mul_f32 v[36:37], v[36:37], v[26:27]
    v_cvt_pk_bf16_f32 v222, v36, v37
    v_lshlrev_b32 v38, 16, v223
    v_and_b32 v39, 0xffff0000, v223
    v_pk_mul_f32 v[38:39], v[38:39], v[26:27]
    v_cvt_pk_bf16_f32 v223, v38, v39
    v_lshlrev_b32 v32, 16, v224
    v_and_b32 v33, 0xffff0000, v224
    v_pk_mul_f32 v[32:33], v[32:33], v[26:27]
    v_cvt_pk_bf16_f32 v224, v32, v33
    v_lshlrev_b32 v34, 16, v225
    v_and_b32 v35, 0xffff0000, v225
    v_pk_mul_f32 v[34:35], v[34:35], v[26:27]
    v_cvt_pk_bf16_f32 v225, v34, v35
    v_lshlrev_b32 v36, 16, v226
    v_and_b32 v37, 0xffff0000, v226
    v_pk_mul_f32 v[36:37], v[36:37], v[26:27]
    v_cvt_pk_bf16_f32 v226, v36, v37
    v_lshlrev_b32 v38, 16, v227
    v_and_b32 v39, 0xffff0000, v227
    v_pk_mul_f32 v[38:39], v[38:39], v[26:27]
    v_cvt_pk_bf16_f32 v227, v38, v39
    v_lshlrev_b32 v32, 16, v228
    v_and_b32 v33, 0xffff0000, v228
    v_pk_mul_f32 v[32:33], v[32:33], v[26:27]
    v_cvt_pk_bf16_f32 v228, v32, v33
    v_lshlrev_b32 v34, 16, v229
    v_and_b32 v35, 0xffff0000, v229
    v_pk_mul_f32 v[34:35], v[34:35], v[26:27]
    v_cvt_pk_bf16_f32 v229, v34, v35
    v_lshlrev_b32 v36, 16, v230
    v_and_b32 v37, 0xffff0000, v230
    v_pk_mul_f32 v[36:37], v[36:37], v[26:27]
    v_cvt_pk_bf16_f32 v230, v36, v37
    v_lshlrev_b32 v38, 16, v231
    v_and_b32 v39, 0xffff0000, v231
    v_pk_mul_f32 v[38:39], v[38:39], v[26:27]
    v_cvt_pk_bf16_f32 v231, v38, v39
    v_lshlrev_b32 v32, 16, v232
    v_and_b32 v33, 0xffff0000, v232
    v_pk_mul_f32 v[32:33], v[32:33], v[26:27]
    v_cvt_pk_bf16_f32 v232, v32, v33
    v_lshlrev_b32 v34, 16, v233
    v_and_b32 v35, 0xffff0000, v233
    v_pk_mul_f32 v[34:35], v[34:35], v[26:27]
    v_cvt_pk_bf16_f32 v233, v34, v35
    v_lshlrev_b32 v36, 16, v234
    v_and_b32 v37, 0xffff0000, v234
    v_pk_mul_f32 v[36:37], v[36:37], v[26:27]
    v_cvt_pk_bf16_f32 v234, v36, v37
    v_lshlrev_b32 v38, 16, v235
    v_and_b32 v39, 0xffff0000, v235
    v_pk_mul_f32 v[38:39], v[38:39], v[26:27]
    v_cvt_pk_bf16_f32 v235, v38, v39
    v_lshlrev_b32 v32, 16, v236
    v_and_b32 v33, 0xffff0000, v236
    v_pk_mul_f32 v[32:33], v[32:33], v[26:27]
    v_cvt_pk_bf16_f32 v236, v32, v33
    v_lshlrev_b32 v34, 16, v237
    v_and_b32 v35, 0xffff0000, v237
    v_pk_mul_f32 v[34:35], v[34:35], v[26:27]
    v_cvt_pk_bf16_f32 v237, v34, v35
    v_lshlrev_b32 v36, 16, v238
    v_and_b32 v37, 0xffff0000, v238
    v_pk_mul_f32 v[36:37], v[36:37], v[26:27]
    v_cvt_pk_bf16_f32 v238, v36, v37
    v_lshlrev_b32 v38, 16, v239
    v_and_b32 v39, 0xffff0000, v239
    v_pk_mul_f32 v[38:39], v[38:39], v[26:27]
    v_cvt_pk_bf16_f32 v239, v38, v39
    v_lshlrev_b32 v32, 16, v240
    v_and_b32 v33, 0xffff0000, v240
    v_pk_mul_f32 v[32:33], v[32:33], v[26:27]
    v_cvt_pk_bf16_f32 v240, v32, v33
    v_lshlrev_b32 v34, 16, v241
    v_and_b32 v35, 0xffff0000, v241
    v_pk_mul_f32 v[34:35], v[34:35], v[26:27]
    v_cvt_pk_bf16_f32 v241, v34, v35
    v_lshlrev_b32 v36, 16, v242
    v_and_b32 v37, 0xffff0000, v242
    v_pk_mul_f32 v[36:37], v[36:37], v[26:27]
    v_cvt_pk_bf16_f32 v242, v36, v37
    v_lshlrev_b32 v38, 16, v243
    v_and_b32 v39, 0xffff0000, v243
    v_pk_mul_f32 v[38:39], v[38:39], v[26:27]
    v_cvt_pk_bf16_f32 v243, v38, v39
    v_lshlrev_b32 v32, 16, v244
    v_and_b32 v33, 0xffff0000, v244
    v_pk_mul_f32 v[32:33], v[32:33], v[26:27]
    v_cvt_pk_bf16_f32 v244, v32, v33
    v_lshlrev_b32 v34, 16, v245
    v_and_b32 v35, 0xffff0000, v245
    v_pk_mul_f32 v[34:35], v[34:35], v[26:27]
    v_cvt_pk_bf16_f32 v245, v34, v35
    v_lshlrev_b32 v36, 16, v246
    v_and_b32 v37, 0xffff0000, v246
    v_pk_mul_f32 v[36:37], v[36:37], v[26:27]
    v_cvt_pk_bf16_f32 v246, v36, v37
    v_lshlrev_b32 v38, 16, v247
    v_and_b32 v39, 0xffff0000, v247
    v_pk_mul_f32 v[38:39], v[38:39], v[26:27]
    v_cvt_pk_bf16_f32 v247, v38, v39
    v_lshlrev_b32 v32, 16, v248
    v_and_b32 v33, 0xffff0000, v248
    v_pk_mul_f32 v[32:33], v[32:33], v[26:27]
    v_cvt_pk_bf16_f32 v248, v32, v33
    v_lshlrev_b32 v34, 16, v249
    v_and_b32 v35, 0xffff0000, v249
    v_pk_mul_f32 v[34:35], v[34:35], v[26:27]
    v_cvt_pk_bf16_f32 v249, v34, v35
    v_lshlrev_b32 v36, 16, v250
    v_and_b32 v37, 0xffff0000, v250
    v_pk_mul_f32 v[36:37], v[36:37], v[26:27]
    v_cvt_pk_bf16_f32 v250, v36, v37
    v_lshlrev_b32 v38, 16, v251
    v_and_b32 v39, 0xffff0000, v251
    v_pk_mul_f32 v[38:39], v[38:39], v[26:27]
    v_cvt_pk_bf16_f32 v251, v38, v39
    v_lshlrev_b32 v32, 16, v252
    v_and_b32 v33, 0xffff0000, v252
    v_pk_mul_f32 v[32:33], v[32:33], v[26:27]
    v_cvt_pk_bf16_f32 v252, v32, v33
    v_lshlrev_b32 v34, 16, v253
    v_and_b32 v35, 0xffff0000, v253
    v_pk_mul_f32 v[34:35], v[34:35], v[26:27]
    v_cvt_pk_bf16_f32 v253, v34, v35
    v_lshlrev_b32 v36, 16, v254
    v_and_b32 v37, 0xffff0000, v254
    v_pk_mul_f32 v[36:37], v[36:37], v[26:27]
    v_cvt_pk_bf16_f32 v254, v36, v37
    v_lshlrev_b32 v38, 16, v255
    v_and_b32 v39, 0xffff0000, v255
    v_pk_mul_f32 v[38:39], v[38:39], v[26:27]
    v_cvt_pk_bf16_f32 v255, v38, v39
    s_load_dwordx2 s[24:25], s[0:1], 16
    s_load_dwordx2 s[26:27], s[0:1], 24
    s_load_dwordx2 s[28:29], s[0:1], 32
    s_waitcnt lgkmcnt(0)
    s_cmp_lt_u32 s5, 2
    s_cselect_b32 s56, 10, 9
    s_cmp_lt_u32 s5, 10
    s_cselect_b32 s53, 14, 13
    s_sub_u32 s49, s53, s56
    s_mov_b32 s51, s3
    s_sub_u32 s37, s51, s49
    s_cmp_lt_u32 s51, s49
    s_cselect_b32 s51, s51, s37
    s_sub_u32 s37, s51, s49
    s_cmp_lt_u32 s51, s49
    s_cselect_b32 s51, s51, s37
    s_sub_u32 s37, s51, s49
    s_cmp_lt_u32 s51, s49
    s_cselect_b32 s51, s51, s37
    s_sub_u32 s37, s51, s49
    s_cmp_lt_u32 s51, s49
    s_cselect_b32 s51, s51, s37
    s_cmp_lg_u32 s2, 0
    s_cbranch_scc1 Lqsp_1007
    s_mov_b32 s48, s56
    s_mov_b32 s54, 0
    s_mov_b32 s55, 1
    s_sub_u32 s50, s3, s48
    s_cmp_lt_u32 s3, s48
    s_cselect_b32 s50, s3, s50
    s_branch Lqse_1008
Lqsp_1007:
    s_sub_u32 s54, s2, 1
    s_mov_b32 s55, 5
    s_mov_b32 s50, 0
    s_add_u32 s37, s54, 5
    s_cmp_lt_u32 s37, s56
    s_cselect_b32 s48, 2, 1
    s_add_u32 s53, s48, s49
    s_cmp_gt_u32 s2, 1
    s_cselect_b32 s53, s48, s53
Lqse_1008:
    s_mov_b32 s52, 0
    s_add_u32 s37, s52, 0
    s_add_u32 s38, s37, s50
    s_sub_u32 s39, s38, s48
    s_cmp_lt_u32 s38, s48
    s_cselect_b32 s34, s38, s39
    s_mul_i32 s34, s34, s55
    s_add_u32 s34, s34, s54
    s_sub_u32 s38, s37, s48
    s_add_u32 s38, s38, s51
    s_sub_u32 s39, s38, s49
    s_cmp_lt_u32 s38, s49
    s_cselect_b32 s38, s38, s39
    s_add_u32 s38, s38, s56
    s_cmp_lt_u32 s37, s48
    s_cselect_b32 s34, s34, s38
    s_mul_i32 s34, s34, 14
    s_add_u32 s34, s34, s5
    s_cmp_lt_u32 s37, s53
    s_cselect_b32 s34, s34, 192
    s_add_u32 s37, s52, 1
    s_add_u32 s38, s37, s50
    s_sub_u32 s39, s38, s48
    s_cmp_lt_u32 s38, s48
    s_cselect_b32 s35, s38, s39
    s_mul_i32 s35, s35, s55
    s_add_u32 s35, s35, s54
    s_sub_u32 s38, s37, s48
    s_add_u32 s38, s38, s51
    s_sub_u32 s39, s38, s49
    s_cmp_lt_u32 s38, s49
    s_cselect_b32 s38, s38, s39
    s_add_u32 s38, s38, s56
    s_cmp_lt_u32 s37, s48
    s_cselect_b32 s35, s35, s38
    s_mul_i32 s35, s35, 14
    s_add_u32 s35, s35, s5
    s_cmp_lt_u32 s37, s53
    s_cselect_b32 s35, s35, 192
    s_min_u32 s38, s34, 191
    s_cmp_lt_u32 s38, 64
    s_cselect_b32 s12, s26, s28
    s_cselect_b32 s13, s27, s29
    s_cmp_lt_u32 s38, 128
    s_cselect_b32 s12, s12, s24
    s_cselect_b32 s13, s13, s25
    s_mov_b32 s14, 4718592
    s_mov_b32 s15, 0x20000
    s_and_b32 s32, s38, 63
    s_lshl_b32 s32, s32, 7
    s_min_u32 s38, s35, 191
    s_cmp_lt_u32 s38, 64
    s_cselect_b32 s16, s26, s28
    s_cselect_b32 s17, s27, s29
    s_cmp_lt_u32 s38, 128
    s_cselect_b32 s16, s16, s24
    s_cselect_b32 s17, s17, s25
    s_mov_b32 s18, 4718592
    s_mov_b32 s19, 0x20000
    s_and_b32 s33, s38, 63
    s_lshl_b32 s33, s33, 7
    s_add_u32 m0, s40, 0
    s_nop 0
    buffer_load_dwordx4 v4, s[12:15], s32 offen lds
    s_add_u32 m0, s40, 4096
    s_add_u32 s37, s32, 262144
    buffer_load_dwordx4 v4, s[12:15], s37 offen lds
    s_add_u32 m0, s40, 8192
    s_add_u32 s37, s32, 524288
    buffer_load_dwordx4 v4, s[12:15], s37 offen lds
    s_add_u32 m0, s40, 12288
    s_add_u32 s37, s32, 786432
    buffer_load_dwordx4 v4, s[12:15], s37 offen lds
    s_add_u32 m0, s40, 16384
    s_add_u32 s37, s32, 1048576
    buffer_load_dwordx4 v4, s[12:15], s37 offen lds
    s_add_u32 m0, s40, 20480
    s_add_u32 s37, s32, 1310720
    buffer_load_dwordx4 v4, s[12:15], s37 offen lds
    s_add_u32 m0, s40, 24576
    s_add_u32 s37, s32, 1572864
    buffer_load_dwordx4 v4, s[12:15], s37 offen lds
    s_add_u32 m0, s40, 28672
    s_add_u32 s37, s32, 1835008
    buffer_load_dwordx4 v4, s[12:15], s37 offen lds
    s_add_u32 m0, s40, 32768
    s_add_u32 s37, s32, 2097152
    buffer_load_dwordx4 v4, s[12:15], s37 offen lds
    s_add_u32 m0, s40, 36864
    s_add_u32 s37, s32, 2359296
    buffer_load_dwordx4 v4, s[12:15], s37 offen lds
    s_add_u32 m0, s40, 40960
    s_add_u32 s37, s32, 2621440
    buffer_load_dwordx4 v4, s[12:15], s37 offen lds
    s_add_u32 m0, s40, 45056
    s_add_u32 s37, s32, 2883584
    buffer_load_dwordx4 v4, s[12:15], s37 offen lds
    s_waitcnt vmcnt(0)
    s_barrier
    ds_read_b64_tr_b16 v[16:17], v10 offset:0
    ds_read_b64_tr_b16 v[18:19], v10 offset:256
    ds_read_b64_tr_b16 v[20:21], v10 offset:512
    ds_read_b64_tr_b16 v[22:23], v10 offset:768
    ds_read_b64_tr_b16 v[24:25], v10 offset:2048
    ds_read_b64_tr_b16 v[26:27], v10 offset:2304
Lqkv_1009:
    s_cmp_lt_u32 s34, 64
    s_cbranch_scc1 Lqkv_1009_k
    s_cmp_lt_u32 s34, 128
    s_cbranch_scc1 Lqkv_v_1010
Lqkv_1009_k:
    s_waitcnt vmcnt(10)
    s_barrier
    s_add_u32 m0, s40, 49152
    s_add_u32 s37, s32, 3145728
    buffer_load_dwordx4 v4, s[12:15], s37 offen lds
    s_add_u32 m0, s40, 53248
    s_add_u32 s37, s32, 3407872
    buffer_load_dwordx4 v4, s[12:15], s37 offen lds
    s_add_u32 m0, s40, 57344
    s_add_u32 s37, s32, 3670016
    buffer_load_dwordx4 v4, s[12:15], s37 offen lds
    ds_read_b64_tr_b16 v[28:29], v10 offset:2560
    ds_read_b64_tr_b16 v[30:31], v10 offset:2816
    s_waitcnt lgkmcnt(6)
    v_mfma_f32_32x32x16_bf16 v[32:47], v[16:19], v[112:115], 0
    ds_read_b64_tr_b16 v[16:17], v10 offset:4096
    ds_read_b64_tr_b16 v[18:19], v10 offset:4352
    s_waitcnt lgkmcnt(6)
    v_mfma_f32_32x32x16_bf16 v[48:63], v[20:23], v[112:115], 0
    ds_read_b64_tr_b16 v[20:21], v10 offset:4608
    ds_read_b64_tr_b16 v[22:23], v10 offset:4864
    s_waitcnt lgkmcnt(6)
    v_mfma_f32_32x32x16_bf16 v[32:47], v[24:27], v[116:119], v[32:47]
    ds_read_b64_tr_b16 v[24:25], v10 offset:6144
    ds_read_b64_tr_b16 v[26:27], v10 offset:6400
    s_waitcnt lgkmcnt(6)
    v_mfma_f32_32x32x16_bf16 v[48:63], v[28:31], v[116:119], v[48:63]
    ds_read_b64_tr_b16 v[28:29], v10 offset:6656
    ds_read_b64_tr_b16 v[30:31], v10 offset:6912
    s_waitcnt lgkmcnt(6)
    v_mfma_f32_32x32x16_bf16 v[32:47], v[16:19], v[120:123], v[32:47]
    ds_read_b64_tr_b16 v[16:17], v10 offset:8192
    ds_read_b64_tr_b16 v[18:19], v10 offset:8448
    s_waitcnt lgkmcnt(6)
    v_mfma_f32_32x32x16_bf16 v[48:63], v[20:23], v[120:123], v[48:63]
    ds_read_b64_tr_b16 v[20:21], v10 offset:8704
    ds_read_b64_tr_b16 v[22:23], v10 offset:8960
    s_waitcnt lgkmcnt(6)
    v_mfma_f32_32x32x16_bf16 v[32:47], v[24:27], v[124:127], v[32:47]
    ds_read_b64_tr_b16 v[24:25], v10 offset:10240
    ds_read_b64_tr_b16 v[26:27], v10 offset:10496
    s_waitcnt lgkmcnt(6)
    v_mfma_f32_32x32x16_bf16 v[48:63], v[28:31], v[124:127], v[48:63]
    ds_read_b64_tr_b16 v[28:29], v10 offset:10752
    ds_read_b64_tr_b16 v[30:31], v10 offset:11008
    s_waitcnt lgkmcnt(6)
    v_mfma_f32_32x32x16_bf16 v[32:47], v[16:19], v[128:131], v[32:47]
    ds_read_b64_tr_b16 v[16:17], v10 offset:12288
    ds_read_b64_tr_b16 v[18:19], v10 offset:12544
    s_waitcnt lgkmcnt(6)
    v_mfma_f32_32x32x16_bf16 v[48:63], v[20:23], v[128:131], v[48:63]
    ds_read_b64_tr_b16 v[20:21], v10 offset:12800
    ds_read_b64_tr_b16 v[22:23], v10 offset:13056
    s_waitcnt lgkmcnt(6)
    v_mfma_f32_32x32x16_bf16 v[32:47], v[24:27], v[132:135], v[32:47]
    ds_read_b64_tr_b16 v[24:25], v10 offset:14336
    ds_read_b64_tr_b16 v[26:27], v10 offset:14592
    s_waitcnt lgkmcnt(6)
    v_mfma_f32_32x32x16_bf16 v[48:63], v[28:31], v[132:135], v[48:63]
    s_waitcnt vmcnt(10)
    s_barrier
    s_add_u32 m0, s40, 61440
    s_add_u32 s37, s32, 3932160
    buffer_load_dwordx4 v4, s[12:15], s37 offen lds
    s_add_u32 m0, s40, 65536
    s_add_u32 s37, s32, 4194304
    buffer_load_dwordx4 v4, s[12:15], s37 offen lds
    s_add_u32 m0, s40, 69632
    s_add_u32 s37, s32, 4456448
    buffer_load_dwordx4 v4, s[12:15], s37 offen lds
    ds_read_b64_tr_b16 v[28:29], v10 offset:14848
    ds_read_b64_tr_b16 v[30:31], v10 offset:15104
    s_waitcnt lgkmcnt(6)
    v_mfma_f32_32x32x16_bf16 v[32:47], v[16:19], v[136:139], v[32:47]
    ds_read_b64_tr_b16 v[16:17], v10 offset:16384
    ds_read_b64_tr_b16 v[18:19], v10 offset:16640
    s_waitcnt lgkmcnt(6)
    v_mfma_f32_32x32x16_bf16 v[48:63], v[20:23], v[136:139], v[48:63]
    ds_read_b64_tr_b16 v[20:21], v10 offset:16896
    ds_read_b64_tr_b16 v[22:23], v10 offset:17152
    s_waitcnt lgkmcnt(6)
    v_mfma_f32_32x32x16_bf16 v[32:47], v[24:27], v[140:143], v[32:47]
    ds_read_b64_tr_b16 v[24:25], v10 offset:18432
    ds_read_b64_tr_b16 v[26:27], v10 offset:18688
    s_waitcnt lgkmcnt(6)
    v_mfma_f32_32x32x16_bf16 v[48:63], v[28:31], v[140:143], v[48:63]
    ds_read_b64_tr_b16 v[28:29], v10 offset:18944
    ds_read_b64_tr_b16 v[30:31], v10 offset:19200
    s_waitcnt lgkmcnt(6)
    v_mfma_f32_32x32x16_bf16 v[32:47], v[16:19], v[144:147], v[32:47]
    ds_read_b64_tr_b16 v[16:17], v10 offset:20480
    ds_read_b64_tr_b16 v[18:19], v10 offset:20736
    s_waitcnt lgkmcnt(6)
    v_mfma_f32_32x32x16_bf16 v[48:63], v[20:23], v[144:147], v[48:63]
    ds_read_b64_tr_b16 v[20:21], v10 offset:20992
    ds_read_b64_tr_b16 v[22:23], v10 offset:21248
    s_waitcnt lgkmcnt(6)
    v_mfma_f32_32x32x16_bf16 v[32:47], v[24:27], v[148:151], v[32:47]
    ds_read_b64_tr_b16 v[24:25], v10 offset:22528
    ds_read_b64_tr_b16 v[26:27], v10 offset:22784
    s_waitcnt lgkmcnt(6)
    v_mfma_f32_32x32x16_bf16 v[48:63], v[28:31], v[148:151], v[48:63]
    ds_read_b64_tr_b16 v[28:29], v10 offset:23040
    ds_read_b64_tr_b16 v[30:31], v10 offset:23296
    s_waitcnt lgkmcnt(6)
    v_mfma_f32_32x32x16_bf16 v[32:47], v[16:19], v[152:155], v[32:47]
    ds_read_b64_tr_b16 v[16:17], v10 offset:24576
    ds_read_b64_tr_b16 v[18:19], v10 offset:24832
    s_waitcnt lgkmcnt(6)
    v_mfma_f32_32x32x16_bf16 v[48:63], v[20:23], v[152:155], v[48:63]
    ds_read_b64_tr_b16 v[20:21], v10 offset:25088
    ds_read_b64_tr_b16 v[22:23], v10 offset:25344
    s_waitcnt lgkmcnt(6)
    v_mfma_f32_32x32x16_bf16 v[32:47], v[24:27], v[156:159], v[32:47]
    ds_read_b64_tr_b16 v[24:25], v10 offset:26624
    ds_read_b64_tr_b16 v[26:27], v10 offset:26880
    s_waitcnt lgkmcnt(6)
    v_mfma_f32_32x32x16_bf16 v[48:63], v[28:31], v[156:159], v[48:63]
    s_waitcnt vmcnt(10)
    s_barrier
    s_add_u32 m0, s40, 0
    s_nop 0
    buffer_load_dwordx4 v4, s[16:19], s33 offen lds
    s_add_u32 m0, s40, 4096
    s_add_u32 s37, s33, 262144
    buffer_load_dwordx4 v4, s[16:19], s37 offen lds
    s_add_u32 m0, s40, 8192
    s_add_u32 s37, s33, 524288
    buffer_load_dwordx4 v4, s[16:19], s37 offen lds
    ds_read_b64_tr_b16 v[28:29], v10 offset:27136
    ds_read_b64_tr_b16 v[30:31], v10 offset:27392
    s_waitcnt lgkmcnt(6)
    v_mfma_f32_32x32x16_bf16 v[32:47], v[16:19], v[160:163], v[32:47]
    ds_read_b64_tr_b16 v[16:17], v10 offset:28672
    ds_read_b64_tr_b16 v[18:19], v10 offset:28928
    s_waitcnt lgkmcnt(6)
    v_mfma_f32_32x32x16_bf16 v[48:63], v[20:23], v[160:163], v[48:63]
    ds_read_b64_tr_b16 v[20:21], v10 offset:29184
    ds_read_b64_tr_b16 v[22:23], v10 offset:29440
    s_waitcnt lgkmcnt(6)
    v_mfma_f32_32x32x16_bf16 v[32:47], v[24:27], v[164:167], v[32:47]
    ds_read_b64_tr_b16 v[24:25], v10 offset:30720
    ds_read_b64_tr_b16 v[26:27], v10 offset:30976
    s_waitcnt lgkmcnt(6)
    v_mfma_f32_32x32x16_bf16 v[48:63], v[28:31], v[164:167], v[48:63]
    ds_read_b64_tr_b16 v[28:29], v10 offset:31232
    ds_read_b64_tr_b16 v[30:31], v10 offset:31488
    s_waitcnt lgkmcnt(6)
    v_mfma_f32_32x32x16_bf16 v[32:47], v[16:19], v[168:171], v[32:47]
    ds_read_b64_tr_b16 v[16:17], v10 offset:32768
    ds_read_b64_tr_b16 v[18:19], v10 offset:33024
    s_waitcnt lgkmcnt(6)
    v_mfma_f32_32x32x16_bf16 v[48:63], v[20:23], v[168:171], v[48:63]
    ds_read_b64_tr_b16 v[20:21], v10 offset:33280
    ds_read_b64_tr_b16 v[22:23], v10 offset:33536
    s_waitcnt lgkmcnt(6)
    v_mfma_f32_32x32x16_bf16 v[32:47], v[24:27], v[172:175], v[32:47]
    ds_read_b64_tr_b16 v[24:25], v10 offset:34816
    ds_read_b64_tr_b16 v[26:27], v10 offset:35072
    s_waitcnt lgkmcnt(6)
    v_mfma_f32_32x32x16_bf16 v[48:63], v[28:31], v[172:175], v[48:63]
    ds_read_b64_tr_b16 v[28:29], v10 offset:35328
    ds_read_b64_tr_b16 v[30:31], v10 offset:35584
    s_waitcnt lgkmcnt(6)
    v_mfma_f32_32x32x16_bf16 v[32:47], v[16:19], v[176:179], v[32:47]
    ds_read_b64_tr_b16 v[16:17], v10 offset:36864
    ds_read_b64_tr_b16 v[18:19], v10 offset:37120
    s_waitcnt lgkmcnt(6)
    v_mfma_f32_32x32x16_bf16 v[48:63], v[20:23], v[176:179], v[48:63]
    ds_read_b64_tr_b16 v[20:21], v10 offset:37376
    ds_read_b64_tr_b16 v[22:23], v10 offset:37632
    s_waitcnt lgkmcnt(6)
    v_mfma_f32_32x32x16_bf16 v[32:47], v[24:27], v[180:183], v[32:47]
    ds_read_b64_tr_b16 v[24:25], v10 offset:38912
    ds_read_b64_tr_b16 v[26:27], v10 offset:39168
    s_waitcnt lgkmcnt(6)
    v_mfma_f32_32x32x16_bf16 v[48:63], v[28:31], v[180:183], v[48:63]
    s_waitcnt vmcnt(6)
    s_barrier
    s_cmp_lg_u32 s52, s48
    s_cbranch_scc1 Lnosig_1013
    s_cmp_lg_u32 s4, 0
    s_cbranch_scc1 Lsig_1014
    s_lshl_b32 s37, s3, 2
    v_mov_b32 v12, s37
    v_mov_b32 v13, s48
    s_mov_b64 exec, 1
    global_atomic_add v12, v13, s[30:31] offset:128 sc1
    s_mov_b64 exec, -1
Lsig_1014:
Lnosig_1013:
    s_add_u32 m0, s40, 12288
    s_add_u32 s37, s33, 786432
    buffer_load_dwordx4 v4, s[16:19], s37 offen lds
    s_add_u32 m0, s40, 16384
    s_add_u32 s37, s33, 1048576
    buffer_load_dwordx4 v4, s[16:19], s37 offen lds
    s_add_u32 m0, s40, 20480
    s_add_u32 s37, s33, 1310720
    buffer_load_dwordx4 v4, s[16:19], s37 offen lds
    ds_read_b64_tr_b16 v[28:29], v10 offset:39424
    ds_read_b64_tr_b16 v[30:31], v10 offset:39680
    s_waitcnt lgkmcnt(6)
    v_mfma_f32_32x32x16_bf16 v[32:47], v[16:19], v[184:187], v[32:47]
    ds_read_b64_tr_b16 v[16:17], v10 offset:40960
    ds_read_b64_tr_b16 v[18:19], v10 offset:41216
    s_waitcnt lgkmcnt(6)
    v_mfma_f32_32x32x16_bf16 v[48:63], v[20:23], v[184:187], v[48:63]
    ds_read_b64_tr_b16 v[20:21], v10 offset:41472
    ds_read_b64_tr_b16 v[22:23], v10 offset:41728
    s_waitcnt lgkmcnt(6)
    v_mfma_f32_32x32x16_bf16 v[32:47], v[24:27], v[188:191], v[32:47]
    ds_read_b64_tr_b16 v[24:25], v10 offset:43008
    ds_read_b64_tr_b16 v[26:27], v10 offset:43264
    s_waitcnt lgkmcnt(6)
    v_mfma_f32_32x32x16_bf16 v[48:63], v[28:31], v[188:191], v[48:63]
    ds_read_b64_tr_b16 v[28:29], v10 offset:43520
    ds_read_b64_tr_b16 v[30:31], v10 offset:43776
    s_waitcnt lgkmcnt(6)
    v_mfma_f32_32x32x16_bf16 v[32:47], v[16:19], v[192:195], v[32:47]
    ds_read_b64_tr_b16 v[16:17], v10 offset:45056
    ds_read_b64_tr_b16 v[18:19], v10 offset:45312
    s_waitcnt lgkmcnt(6)
    v_mfma_f32_32x32x16_bf16 v[48:63], v[20:23], v[192:195], v[48:63]
    ds_read_b64_tr_b16 v[20:21], v10 offset:45568
    ds_read_b64_tr_b16 v[22:23], v10 offset:45824
    s_waitcnt lgkmcnt(6)
    v_mfma_f32_32x32x16_bf16 v[32:47], v[24:27], v[196:199], v[32:47]
    ds_read_b64_tr_b16 v[24:25], v10 offset:47104
    ds_read_b64_tr_b16 v[26:27], v10 offset:47360
    s_waitcnt lgkmcnt(6)
    v_mfma_f32_32x32x16_bf16 v[48:63], v[28:31], v[196:199], v[48:63]
    ds_read_b64_tr_b16 v[28:29], v10 offset:47616
    ds_read_b64_tr_b16 v[30:31], v10 offset:47872
    s_waitcnt lgkmcnt(6)
    v_mfma_f32_32x32x16_bf16 v[32:47], v[16:19], v[200:203], v[32:47]
    ds_read_b64_tr_b16 v[16:17], v10 offset:49152
    ds_read_b64_tr_b16 v[18:19], v10 offset:49408
    s_waitcnt lgkmcnt(6)
    v_mfma_f32_32x32x16_bf16 v[48:63], v[20:23], v[200:203], v[48:63]
    ds_read_b64_tr_b16 v[20:21], v10 offset:49664
    ds_read_b64_tr_b16 v[22:23], v10 offset:49920
    s_waitcnt lgkmcnt(6)
    v_mfma_f32_32x32x16_bf16 v[32:47], v[24:27], v[204:207], v[32:47]
    ds_read_b64_tr_b16 v[24:25], v10 offset:51200
    ds_read_b64_tr_b16 v[26:27], v10 offset:51456
    s_waitcnt lgkmcnt(6)
    v_mfma_f32_32x32x16_bf16 v[48:63], v[28:31], v[204:207], v[48:63]
    s_waitcnt vmcnt(6)
    s_barrier
    s_add_u32 m0, s40, 24576
    s_add_u32 s37, s33, 1572864
    buffer_load_dwordx4 v4, s[16:19], s37 offen lds
    s_add_u32 m0, s40, 28672
    s_add_u32 s37, s33, 1835008
    buffer_load_dwordx4 v4, s[16:19], s37 offen lds
    s_add_u32 m0, s40, 32768
    s_add_u32 s37, s33, 2097152
    buffer_load_dwordx4 v4, s[16:19], s37 offen lds
    ds_read_b64_tr_b16 v[28:29], v10 offset:51712
    ds_read_b64_tr_b16 v[30:31], v10 offset:51968
    s_waitcnt lgkmcnt(6)
    v_mfma_f32_32x32x16_bf16 v[32:47], v[16:19], v[208:211], v[32:47]
    ds_read_b64_tr_b16 v[16:17], v10 offset:53248
    ds_read_b64_tr_b16 v[18:19], v10 offset:53504
    s_waitcnt lgkmcnt(6)
    v_mfma_f32_32x32x16_bf16 v[48:63], v[20:23], v[208:211], v[48:63]
    ds_read_b64_tr_b16 v[20:21], v10 offset:53760
    ds_read_b64_tr_b16 v[22:23], v10 offset:54016
    s_waitcnt lgkmcnt(6)
    v_mfma_f32_32x32x16_bf16 v[32:47], v[24:27], v[212:215], v[32:47]
    ds_read_b64_tr_b16 v[24:25], v10 offset:55296
    ds_read_b64_tr_b16 v[26:27], v10 offset:55552
    s_waitcnt lgkmcnt(6)
    v_mfma_f32_32x32x16_bf16 v[48:63], v[28:31], v[212:215], v[48:63]
    ds_read_b64_tr_b16 v[28:29], v10 offset:55808
    ds_read_b64_tr_b16 v[30:31], v10 offset:56064
    s_waitcnt lgkmcnt(6)
    v_mfma_f32_32x32x16_bf16 v[32:47], v[16:19], v[216:219], v[32:47]
    ds_read_b64_tr_b16 v[16:17], v10 offset:57344
    ds_read_b64_tr_b16 v[18:19], v10 offset:57600
    s_waitcnt lgkmcnt(6)
    v_mfma_f32_32x32x16_bf16 v[48:63], v[20:23], v[216:219], v[48:63]
    ds_read_b64_tr_b16 v[20:21], v10 offset:57856
    ds_read_b64_tr_b16 v[22:23], v10 offset:58112
    s_waitcnt lgkmcnt(6)
    v_mfma_f32_32x32x16_bf16 v[32:47], v[24:27], v[220:223], v[32:47]
    ds_read_b64_tr_b16 v[24:25], v10 offset:59392
    ds_read_b64_tr_b16 v[26:27], v10 offset:59648
    s_waitcnt lgkmcnt(6)
    v_mfma_f32_32x32x16_bf16 v[48:63], v[28:31], v[220:223], v[48:63]
    ds_read_b64_tr_b16 v[28:29], v10 offset:59904
    ds_read_b64_tr_b16 v[30:31], v10 offset:60160
    s_waitcnt lgkmcnt(6)
    v_mfma_f32_32x32x16_bf16 v[32:47], v[16:19], v[224:227], v[32:47]
    ds_read_b64_tr_b16 v[16:17], v10 offset:61440
    ds_read_b64_tr_b16 v[18:19], v10 offset:61696
    s_waitcnt lgkmcnt(6)
    v_mfma_f32_32x32x16_bf16 v[48:63], v[20:23], v[224:227], v[48:63]
    ds_read_b64_tr_b16 v[20:21], v10 offset:61952
    ds_read_b64_tr_b16 v[22:23], v10 offset:62208
    s_waitcnt lgkmcnt(6)
    v_mfma_f32_32x32x16_bf16 v[32:47], v[24:27], v[228:231], v[32:47]
    ds_read_b64_tr_b16 v[24:25], v10 offset:63488
    ds_read_b64_tr_b16 v[26:27], v10 offset:63744
    s_waitcnt lgkmcnt(6)
    v_mfma_f32_32x32x16_bf16 v[48:63], v[28:31], v[228:231], v[48:63]
    s_waitcnt vmcnt(6)
    s_barrier
    s_add_u32 m0, s40, 36864
    s_add_u32 s37, s33, 2359296
    buffer_load_dwordx4 v4, s[16:19], s37 offen lds
    s_add_u32 m0, s40, 40960
    s_add_u32 s37, s33, 2621440
    buffer_load_dwordx4 v4, s[16:19], s37 offen lds
    s_add_u32 m0, s40, 45056
    s_add_u32 s37, s33, 2883584
    buffer_load_dwordx4 v4, s[16:19], s37 offen lds
    ds_read_b64_tr_b16 v[28:29], v10 offset:64000
    ds_read_b64_tr_b16 v[30:31], v10 offset:64256
    s_waitcnt lgkmcnt(6)
    v_mfma_f32_32x32x16_bf16 v[32:47], v[16:19], v[232:235], v[32:47]
    ds_read_b64_tr_b16 v[16:17], v11 offset:0
    ds_read_b64_tr_b16 v[18:19], v11 offset:256
    s_waitcnt lgkmcnt(6)
    v_mfma_f32_32x32x16_bf16 v[48:63], v[20:23], v[232:235], v[48:63]
    ds_read_b64_tr_b16 v[20:21], v11 offset:512
    ds_read_b64_tr_b16 v[22:23], v11 offset:768
    s_waitcnt lgkmcnt(6)
    v_mfma_f32_32x32x16_bf16 v[32:47], v[24:27], v[236:239], v[32:47]
    ds_read_b64_tr_b16 v[24:25], v11 offset:2048
    ds_read_b64_tr_b16 v[26:27], v11 offset:2304
    s_waitcnt lgkmcnt(6)
    v_mfma_f32_32x32x16_bf16 v[48:63], v[28:31], v[236:239], v[48:63]
    ds_read_b64_tr_b16 v[28:29], v11 offset:2560
    ds_read_b64_tr_b16 v[30:31], v11 offset:2816
    s_waitcnt lgkmcnt(6)
    v_mfma_f32_32x32x16_bf16 v[32:47], v[16:19], v[240:243], v[32:47]
    ds_read_b64_tr_b16 v[16:17], v11 offset:4096
    ds_read_b64_tr_b16 v[18:19], v11 offset:4352
    s_waitcnt lgkmcnt(6)
    v_mfma_f32_32x32x16_bf16 v[48:63], v[20:23], v[240:243], v[48:63]
    ds_read_b64_tr_b16 v[20:21], v11 offset:4608
    ds_read_b64_tr_b16 v[22:23], v11 offset:4864
    s_waitcnt lgkmcnt(6)
    v_mfma_f32_32x32x16_bf16 v[32:47], v[24:27], v[244:247], v[32:47]
    ds_read_b64_tr_b16 v[24:25], v11 offset:6144
    ds_read_b64_tr_b16 v[26:27], v11 offset:6400
    s_waitcnt lgkmcnt(6)
    v_mfma_f32_32x32x16_bf16 v[48:63], v[28:31], v[244:247], v[48:63]
    ds_read_b64_tr_b16 v[28:29], v11 offset:6656
    ds_read_b64_tr_b16 v[30:31], v11 offset:6912
    s_waitcnt lgkmcnt(6)
    v_mfma_f32_32x32x16_bf16 v[32:47], v[16:19], v[248:251], v[32:47]
    ds_read_b64_tr_b16 v[16:17], v10 offset:0
    ds_read_b64_tr_b16 v[18:19], v10 offset:256
    s_waitcnt lgkmcnt(6)
    v_mfma_f32_32x32x16_bf16 v[48:63], v[20:23], v[248:251], v[48:63]
    ds_read_b64_tr_b16 v[20:21], v10 offset:512
    ds_read_b64_tr_b16 v[22:23], v10 offset:768
    s_waitcnt lgkmcnt(6)
    v_mfma_f32_32x32x16_bf16 v[32:47], v[24:27], v[252:255], v[32:47]
    ds_read_b64_tr_b16 v[24:25], v10 offset:2048
    ds_read_b64_tr_b16 v[26:27], v10 offset:2304
    s_waitcnt lgkmcnt(6)
    v_mfma_f32_32x32x16_bf16 v[48:63], v[28:31], v[252:255], v[48:63]
    s_and_b32 s38, s34, 63
    s_lshr_b32 s41, s38, 1
    s_lshl_b32 s41, s41, 19
    s_and_b32 s38, s38, 1
    s_lshl_b32 s38, s38, 12
    s_add_u32 s41, s41, s38
    s_cmp_lt_u32 s34, 64
    s_cselect_b32 s38, 16777216, 0
    s_add_u32 s41, s41, s38
    v_cvt_pk_bf16_f32 v64, v32, v33
    v_cvt_pk_bf16_f32 v65, v34, v35
    v_cvt_pk_bf16_f32 v66, v36, v37
    v_cvt_pk_bf16_f32 v67, v38, v39
    buffer_store_dwordx4 v[64:67], v7, s[8:11], s41 offen offset:0 sc1
    v_cvt_pk_bf16_f32 v68, v40, v41
    v_cvt_pk_bf16_f32 v69, v42, v43
    v_cvt_pk_bf16_f32 v70, v44, v45
    v_cvt_pk_bf16_f32 v71, v46, v47
    buffer_store_dwordx4 v[68:71], v7, s[8:11], s41 offen offset:1024 sc1
    v_cvt_pk_bf16_f32 v72, v48, v49
    v_cvt_pk_bf16_f32 v73, v50, v51
    v_cvt_pk_bf16_f32 v74, v52, v53
    v_cvt_pk_bf16_f32 v75, v54, v55
    buffer_store_dwordx4 v[72:75], v7, s[8:11], s41 offen offset:2048 sc1
    v_cvt_pk_bf16_f32 v76, v56, v57
    v_cvt_pk_bf16_f32 v77, v58, v59
    v_cvt_pk_bf16_f32 v78, v60, v61
    v_cvt_pk_bf16_f32 v79, v62, v63
    buffer_store_dwordx4 v[76:79], v7, s[8:11], s41 offen offset:3072 sc1
    s_branch Lqkv_n_1011
Lqkv_v_1010:
    s_waitcnt vmcnt(10)
    s_barrier
    s_add_u32 m0, s40, 49152
    s_add_u32 s37, s32, 3145728
    buffer_load_dwordx4 v4, s[12:15], s37 offen lds
    s_add_u32 m0, s40, 53248
    s_add_u32 s37, s32, 3407872
    buffer_load_dwordx4 v4, s[12:15], s37 offen lds
    s_add_u32 m0, s40, 57344
    s_add_u32 s37, s32, 3670016
    buffer_load_dwordx4 v4, s[12:15], s37 offen lds
    ds_read_b64_tr_b16 v[28:29], v10 offset:2560
    ds_read_b64_tr_b16 v[30:31], v10 offset:2816
    s_waitcnt lgkmcnt(6)
    v_mfma_f32_32x32x16_bf16 v[32:47], v[112:115], v[16:19], 0
    ds_read_b64_tr_b16 v[16:17], v10 offset:4096
    ds_read_b64_tr_b16 v[18:19], v10 offset:4352
    s_waitcnt lgkmcnt(6)
    v_mfma_f32_32x32x16_bf16 v[48:63], v[112:115], v[20:23], 0
    ds_read_b64_tr_b16 v[20:21], v10 offset:4608
    ds_read_b64_tr_b16 v[22:23], v10 offset:4864
    s_waitcnt lgkmcnt(6)
    v_mfma_f32_32x32x16_bf16 v[32:47], v[116:119], v[24:27], v[32:47]
    ds_read_b64_tr_b16 v[24:25], v10 offset:6144
    ds_read_b64_tr_b16 v[26:27], v10 offset:6400
    s_waitcnt lgkmcnt(6)
    v_mfma_f32_32x32x16_bf16 v[48:63], v[116:119], v[28:31], v[48:63]
    ds_read_b64_tr_b16 v[28:29], v10 offset:6656
    ds_read_b64_tr_b16 v[30:31], v10 offset:6912
    s_waitcnt lgkmcnt(6)
    v_mfma_f32_32x32x16_bf16 v[32:47], v[120:123], v[16:19], v[32:47]
    ds_read_b64_tr_b16 v[16:17], v10 offset:8192
    ds_read_b64_tr_b16 v[18:19], v10 offset:8448
    s_waitcnt lgkmcnt(6)
    v_mfma_f32_32x32x16_bf16 v[48:63], v[120:123], v[20:23], v[48:63]
    ds_read_b64_tr_b16 v[20:21], v10 offset:8704
    ds_read_b64_tr_b16 v[22:23], v10 offset:8960
    s_waitcnt lgkmcnt(6)
    v_mfma_f32_32x32x16_bf16 v[32:47], v[124:127], v[24:27], v[32:47]
    ds_read_b64_tr_b16 v[24:25], v10 offset:10240
    ds_read_b64_tr_b16 v[26:27], v10 offset:10496
    s_waitcnt lgkmcnt(6)
    v_mfma_f32_32x32x16_bf16 v[48:63], v[124:127], v[28:31], v[48:63]
    ds_read_b64_tr_b16 v[28:29], v10 offset:10752
    ds_read_b64_tr_b16 v[30:31], v10 offset:11008
    s_waitcnt lgkmcnt(6)
    v_mfma_f32_32x32x16_bf16 v[32:47], v[128:131], v[16:19], v[32:47]
    ds_read_b64_tr_b16 v[16:17], v10 offset:12288
    ds_read_b64_tr_b16 v[18:19], v10 offset:12544
    s_waitcnt lgkmcnt(6)
    v_mfma_f32_32x32x16_bf16 v[48:63], v[128:131], v[20:23], v[48:63]
    ds_read_b64_tr_b16 v[20:21], v10 offset:12800
    ds_read_b64_tr_b16 v[22:23], v10 offset:13056
    s_waitcnt lgkmcnt(6)
    v_mfma_f32_32x32x16_bf16 v[32:47], v[132:135], v[24:27], v[32:47]
    ds_read_b64_tr_b16 v[24:25], v10 offset:14336
    ds_read_b64_tr_b16 v[26:27], v10 offset:14592
    s_waitcnt lgkmcnt(6)
    v_mfma_f32_32x32x16_bf16 v[48:63], v[132:135], v[28:31], v[48:63]
    s_waitcnt vmcnt(10)
    s_barrier
    s_add_u32 m0, s40, 61440
    s_add_u32 s37, s32, 3932160
    buffer_load_dwordx4 v4, s[12:15], s37 offen lds
    s_add_u32 m0, s40, 65536
    s_add_u32 s37, s32, 4194304
    buffer_load_dwordx4 v4, s[12:15], s37 offen lds
    s_add_u32 m0, s40, 69632
    s_add_u32 s37, s32, 4456448
    buffer_load_dwordx4 v4, s[12:15], s37 offen lds
    ds_read_b64_tr_b16 v[28:29], v10 offset:14848
    ds_read_b64_tr_b16 v[30:31], v10 offset:15104
    s_waitcnt lgkmcnt(6)
    v_mfma_f32_32x32x16_bf16 v[32:47], v[136:139], v[16:19], v[32:47]
    ds_read_b64_tr_b16 v[16:17], v10 offset:16384
    ds_read_b64_tr_b16 v[18:19], v10 offset:16640
    s_waitcnt lgkmcnt(6)
    v_mfma_f32_32x32x16_bf16 v[48:63], v[136:139], v[20:23], v[48:63]
    ds_read_b64_tr_b16 v[20:21], v10 offset:16896
    ds_read_b64_tr_b16 v[22:23], v10 offset:17152
    s_waitcnt lgkmcnt(6)
    v_mfma_f32_32x32x16_bf16 v[32:47], v[140:143], v[24:27], v[32:47]
    ds_read_b64_tr_b16 v[24:25], v10 offset:18432
    ds_read_b64_tr_b16 v[26:27], v10 offset:18688
    s_waitcnt lgkmcnt(6)
    v_mfma_f32_32x32x16_bf16 v[48:63], v[140:143], v[28:31], v[48:63]
    ds_read_b64_tr_b16 v[28:29], v10 offset:18944
    ds_read_b64_tr_b16 v[30:31], v10 offset:19200
    s_waitcnt lgkmcnt(6)
    v_mfma_f32_32x32x16_bf16 v[32:47], v[144:147], v[16:19], v[32:47]
    ds_read_b64_tr_b16 v[16:17], v10 offset:20480
    ds_read_b64_tr_b16 v[18:19], v10 offset:20736
    s_waitcnt lgkmcnt(6)
    v_mfma_f32_32x32x16_bf16 v[48:63], v[144:147], v[20:23], v[48:63]
    ds_read_b64_tr_b16 v[20:21], v10 offset:20992
    ds_read_b64_tr_b16 v[22:23], v10 offset:21248
    s_waitcnt lgkmcnt(6)
    v_mfma_f32_32x32x16_bf16 v[32:47], v[148:151], v[24:27], v[32:47]
    ds_read_b64_tr_b16 v[24:25], v10 offset:22528
    ds_read_b64_tr_b16 v[26:27], v10 offset:22784
    s_waitcnt lgkmcnt(6)
    v_mfma_f32_32x32x16_bf16 v[48:63], v[148:151], v[28:31], v[48:63]
    ds_read_b64_tr_b16 v[28:29], v10 offset:23040
    ds_read_b64_tr_b16 v[30:31], v10 offset:23296
    s_waitcnt lgkmcnt(6)
    v_mfma_f32_32x32x16_bf16 v[32:47], v[152:155], v[16:19], v[32:47]
    ds_read_b64_tr_b16 v[16:17], v10 offset:24576
    ds_read_b64_tr_b16 v[18:19], v10 offset:24832
    s_waitcnt lgkmcnt(6)
    v_mfma_f32_32x32x16_bf16 v[48:63], v[152:155], v[20:23], v[48:63]
    ds_read_b64_tr_b16 v[20:21], v10 offset:25088
    ds_read_b64_tr_b16 v[22:23], v10 offset:25344
    s_waitcnt lgkmcnt(6)
    v_mfma_f32_32x32x16_bf16 v[32:47], v[156:159], v[24:27], v[32:47]
    ds_read_b64_tr_b16 v[24:25], v10 offset:26624
    ds_read_b64_tr_b16 v[26:27], v10 offset:26880
    s_waitcnt lgkmcnt(6)
    v_mfma_f32_32x32x16_bf16 v[48:63], v[156:159], v[28:31], v[48:63]
    s_waitcnt vmcnt(10)
    s_barrier
    s_add_u32 m0, s40, 0
    s_nop 0
    buffer_load_dwordx4 v4, s[16:19], s33 offen lds
    s_add_u32 m0, s40, 4096
    s_add_u32 s37, s33, 262144
    buffer_load_dwordx4 v4, s[16:19], s37 offen lds
    s_add_u32 m0, s40, 8192
    s_add_u32 s37, s33, 524288
    buffer_load_dwordx4 v4, s[16:19], s37 offen lds
    ds_read_b64_tr_b16 v[28:29], v10 offset:27136
    ds_read_b64_tr_b16 v[30:31], v10 offset:27392
    s_waitcnt lgkmcnt(6)
    v_mfma_f32_32x32x16_bf16 v[32:47], v[160:163], v[16:19], v[32:47]
    ds_read_b64_tr_b16 v[16:17], v10 offset:28672
    ds_read_b64_tr_b16 v[18:19], v10 offset:28928
    s_waitcnt lgkmcnt(6)
    v_mfma_f32_32x32x16_bf16 v[48:63], v[160:163], v[20:23], v[48:63]
    ds_read_b64_tr_b16 v[20:21], v10 offset:29184
    ds_read_b64_tr_b16 v[22:23], v10 offset:29440
    s_waitcnt lgkmcnt(6)
    v_mfma_f32_32x32x16_bf16 v[32:47], v[164:167], v[24:27], v[32:47]
    ds_read_b64_tr_b16 v[24:25], v10 offset:30720
    ds_read_b64_tr_b16 v[26:27], v10 offset:30976
    s_waitcnt lgkmcnt(6)
    v_mfma_f32_32x32x16_bf16 v[48:63], v[164:167], v[28:31], v[48:63]
    ds_read_b64_tr_b16 v[28:29], v10 offset:31232
    ds_read_b64_tr_b16 v[30:31], v10 offset:31488
    s_waitcnt lgkmcnt(6)
    v_mfma_f32_32x32x16_bf16 v[32:47], v[168:171], v[16:19], v[32:47]
    ds_read_b64_tr_b16 v[16:17], v10 offset:32768
    ds_read_b64_tr_b16 v[18:19], v10 offset:33024
    s_waitcnt lgkmcnt(6)
    v_mfma_f32_32x32x16_bf16 v[48:63], v[168:171], v[20:23], v[48:63]
    ds_read_b64_tr_b16 v[20:21], v10 offset:33280
    ds_read_b64_tr_b16 v[22:23], v10 offset:33536
    s_waitcnt lgkmcnt(6)
    v_mfma_f32_32x32x16_bf16 v[32:47], v[172:175], v[24:27], v[32:47]
    ds_read_b64_tr_b16 v[24:25], v10 offset:34816
    ds_read_b64_tr_b16 v[26:27], v10 offset:35072
    s_waitcnt lgkmcnt(6)
    v_mfma_f32_32x32x16_bf16 v[48:63], v[172:175], v[28:31], v[48:63]
    ds_read_b64_tr_b16 v[28:29], v10 offset:35328
    ds_read_b64_tr_b16 v[30:31], v10 offset:35584
    s_waitcnt lgkmcnt(6)
    v_mfma_f32_32x32x16_bf16 v[32:47], v[176:179], v[16:19], v[32:47]
    ds_read_b64_tr_b16 v[16:17], v10 offset:36864
    ds_read_b64_tr_b16 v[18:19], v10 offset:37120
    s_waitcnt lgkmcnt(6)
    v_mfma_f32_32x32x16_bf16 v[48:63], v[176:179], v[20:23], v[48:63]
    ds_read_b64_tr_b16 v[20:21], v10 offset:37376
    ds_read_b64_tr_b16 v[22:23], v10 offset:37632
    s_waitcnt lgkmcnt(6)
    v_mfma_f32_32x32x16_bf16 v[32:47], v[180:183], v[24:27], v[32:47]
    ds_read_b64_tr_b16 v[24:25], v10 offset:38912
    ds_read_b64_tr_b16 v[26:27], v10 offset:39168
    s_waitcnt lgkmcnt(6)
    v_mfma_f32_32x32x16_bf16 v[48:63], v[180:183], v[28:31], v[48:63]
    s_waitcnt vmcnt(6)
    s_barrier
    s_cmp_lg_u32 s52, s48
    s_cbranch_scc1 Lnosig_1015
    s_cmp_lg_u32 s4, 0
    s_cbranch_scc1 Lsig_1016
    s_lshl_b32 s37, s3, 2
    v_mov_b32 v12, s37
    v_mov_b32 v13, s48
    s_mov_b64 exec, 1
    global_atomic_add v12, v13, s[30:31] offset:128 sc1
    s_mov_b64 exec, -1
Lsig_1016:
Lnosig_1015:
    s_add_u32 m0, s40, 12288
    s_add_u32 s37, s33, 786432
    buffer_load_dwordx4 v4, s[16:19], s37 offen lds
    s_add_u32 m0, s40, 16384
    s_add_u32 s37, s33, 1048576
    buffer_load_dwordx4 v4, s[16:19], s37 offen lds
    s_add_u32 m0, s40, 20480
    s_add_u32 s37, s33, 1310720
    buffer_load_dwordx4 v4, s[16:19], s37 offen lds
    ds_read_b64_tr_b16 v[28:29], v10 offset:39424
    ds_read_b64_tr_b16 v[30:31], v10 offset:39680
    s_waitcnt lgkmcnt(6)
    v_mfma_f32_32x32x16_bf16 v[32:47], v[184:187], v[16:19], v[32:47]
    ds_read_b64_tr_b16 v[16:17], v10 offset:40960
    ds_read_b64_tr_b16 v[18:19], v10 offset:41216
    s_waitcnt lgkmcnt(6)
    v_mfma_f32_32x32x16_bf16 v[48:63], v[184:187], v[20:23], v[48:63]
    ds_read_b64_tr_b16 v[20:21], v10 offset:41472
    ds_read_b64_tr_b16 v[22:23], v10 offset:41728
    s_waitcnt lgkmcnt(6)
    v_mfma_f32_32x32x16_bf16 v[32:47], v[188:191], v[24:27], v[32:47]
    ds_read_b64_tr_b16 v[24:25], v10 offset:43008
    ds_read_b64_tr_b16 v[26:27], v10 offset:43264
    s_waitcnt lgkmcnt(6)
    v_mfma_f32_32x32x16_bf16 v[48:63], v[188:191], v[28:31], v[48:63]
    ds_read_b64_tr_b16 v[28:29], v10 offset:43520
    ds_read_b64_tr_b16 v[30:31], v10 offset:43776
    s_waitcnt lgkmcnt(6)
    v_mfma_f32_32x32x16_bf16 v[32:47], v[192:195], v[16:19], v[32:47]
    ds_read_b64_tr_b16 v[16:17], v10 offset:45056
    ds_read_b64_tr_b16 v[18:19], v10 offset:45312
    s_waitcnt lgkmcnt(6)
    v_mfma_f32_32x32x16_bf16 v[48:63], v[192:195], v[20:23], v[48:63]
    ds_read_b64_tr_b16 v[20:21], v10 offset:45568
    ds_read_b64_tr_b16 v[22:23], v10 offset:45824
    s_waitcnt lgkmcnt(6)
    v_mfma_f32_32x32x16_bf16 v[32:47], v[196:199], v[24:27], v[32:47]
    ds_read_b64_tr_b16 v[24:25], v10 offset:47104
    ds_read_b64_tr_b16 v[26:27], v10 offset:47360
    s_waitcnt lgkmcnt(6)
    v_mfma_f32_32x32x16_bf16 v[48:63], v[196:199], v[28:31], v[48:63]
    ds_read_b64_tr_b16 v[28:29], v10 offset:47616
    ds_read_b64_tr_b16 v[30:31], v10 offset:47872
    s_waitcnt lgkmcnt(6)
    v_mfma_f32_32x32x16_bf16 v[32:47], v[200:203], v[16:19], v[32:47]
    ds_read_b64_tr_b16 v[16:17], v10 offset:49152
    ds_read_b64_tr_b16 v[18:19], v10 offset:49408
    s_waitcnt lgkmcnt(6)
    v_mfma_f32_32x32x16_bf16 v[48:63], v[200:203], v[20:23], v[48:63]
    ds_read_b64_tr_b16 v[20:21], v10 offset:49664
    ds_read_b64_tr_b16 v[22:23], v10 offset:49920
    s_waitcnt lgkmcnt(6)
    v_mfma_f32_32x32x16_bf16 v[32:47], v[204:207], v[24:27], v[32:47]
    ds_read_b64_tr_b16 v[24:25], v10 offset:51200
    ds_read_b64_tr_b16 v[26:27], v10 offset:51456
    s_waitcnt lgkmcnt(6)
    v_mfma_f32_32x32x16_bf16 v[48:63], v[204:207], v[28:31], v[48:63]
    s_waitcnt vmcnt(6)
    s_barrier
    s_add_u32 m0, s40, 24576
    s_add_u32 s37, s33, 1572864
    buffer_load_dwordx4 v4, s[16:19], s37 offen lds
    s_add_u32 m0, s40, 28672
    s_add_u32 s37, s33, 1835008
    buffer_load_dwordx4 v4, s[16:19], s37 offen lds
    s_add_u32 m0, s40, 32768
    s_add_u32 s37, s33, 2097152
    buffer_load_dwordx4 v4, s[16:19], s37 offen lds
    ds_read_b64_tr_b16 v[28:29], v10 offset:51712
    ds_read_b64_tr_b16 v[30:31], v10 offset:51968
    s_waitcnt lgkmcnt(6)
    v_mfma_f32_32x32x16_bf16 v[32:47], v[208:211], v[16:19], v[32:47]
    ds_read_b64_tr_b16 v[16:17], v10 offset:53248
    ds_read_b64_tr_b16 v[18:19], v10 offset:53504
    s_waitcnt lgkmcnt(6)
    v_mfma_f32_32x32x16_bf16 v[48:63], v[208:211], v[20:23], v[48:63]
    ds_read_b64_tr_b16 v[20:21], v10 offset:53760
    ds_read_b64_tr_b16 v[22:23], v10 offset:54016
    s_waitcnt lgkmcnt(6)
    v_mfma_f32_32x32x16_bf16 v[32:47], v[212:215], v[24:27], v[32:47]
    ds_read_b64_tr_b16 v[24:25], v10 offset:55296
    ds_read_b64_tr_b16 v[26:27], v10 offset:55552
    s_waitcnt lgkmcnt(6)
    v_mfma_f32_32x32x16_bf16 v[48:63], v[212:215], v[28:31], v[48:63]
    ds_read_b64_tr_b16 v[28:29], v10 offset:55808
    ds_read_b64_tr_b16 v[30:31], v10 offset:56064
    s_waitcnt lgkmcnt(6)
    v_mfma_f32_32x32x16_bf16 v[32:47], v[216:219], v[16:19], v[32:47]
    ds_read_b64_tr_b16 v[16:17], v10 offset:57344
    ds_read_b64_tr_b16 v[18:19], v10 offset:57600
    s_waitcnt lgkmcnt(6)
    v_mfma_f32_32x32x16_bf16 v[48:63], v[216:219], v[20:23], v[48:63]
    ds_read_b64_tr_b16 v[20:21], v10 offset:57856
    ds_read_b64_tr_b16 v[22:23], v10 offset:58112
    s_waitcnt lgkmcnt(6)
    v_mfma_f32_32x32x16_bf16 v[32:47], v[220:223], v[24:27], v[32:47]
    ds_read_b64_tr_b16 v[24:25], v10 offset:59392
    ds_read_b64_tr_b16 v[26:27], v10 offset:59648
    s_waitcnt lgkmcnt(6)
    v_mfma_f32_32x32x16_bf16 v[48:63], v[220:223], v[28:31], v[48:63]
    ds_read_b64_tr_b16 v[28:29], v10 offset:59904
    ds_read_b64_tr_b16 v[30:31], v10 offset:60160
    s_waitcnt lgkmcnt(6)
    v_mfma_f32_32x32x16_bf16 v[32:47], v[224:227], v[16:19], v[32:47]
    ds_read_b64_tr_b16 v[16:17], v10 offset:61440
    ds_read_b64_tr_b16 v[18:19], v10 offset:61696
    s_waitcnt lgkmcnt(6)
    v_mfma_f32_32x32x16_bf16 v[48:63], v[224:227], v[20:23], v[48:63]
    ds_read_b64_tr_b16 v[20:21], v10 offset:61952
    ds_read_b64_tr_b16 v[22:23], v10 offset:62208
    s_waitcnt lgkmcnt(6)
    v_mfma_f32_32x32x16_bf16 v[32:47], v[228:231], v[24:27], v[32:47]
    ds_read_b64_tr_b16 v[24:25], v10 offset:63488
    ds_read_b64_tr_b16 v[26:27], v10 offset:63744
    s_waitcnt lgkmcnt(6)
    v_mfma_f32_32x32x16_bf16 v[48:63], v[228:231], v[28:31], v[48:63]
    s_waitcnt vmcnt(6)
    s_barrier
    s_add_u32 m0, s40, 36864
    s_add_u32 s37, s33, 2359296
    buffer_load_dwordx4 v4, s[16:19], s37 offen lds
    s_add_u32 m0, s40, 40960
    s_add_u32 s37, s33, 2621440
    buffer_load_dwordx4 v4, s[16:19], s37 offen lds
    s_add_u32 m0, s40, 45056
    s_add_u32 s37, s33, 2883584
    buffer_load_dwordx4 v4, s[16:19], s37 offen lds
    ds_read_b64_tr_b16 v[28:29], v10 offset:64000
    ds_read_b64_tr_b16 v[30:31], v10 offset:64256
    s_waitcnt lgkmcnt(6)
    v_mfma_f32_32x32x16_bf16 v[32:47], v[232:235], v[16:19], v[32:47]
    ds_read_b64_tr_b16 v[16:17], v11 offset:0
    ds_read_b64_tr_b16 v[18:19], v11 offset:256
    s_waitcnt lgkmcnt(6)
    v_mfma_f32_32x32x16_bf16 v[48:63], v[232:235], v[20:23], v[48:63]
    ds_read_b64_tr_b16 v[20:21], v11 offset:512
    ds_read_b64_tr_b16 v[22:23], v11 offset:768
    s_waitcnt lgkmcnt(6)
    v_mfma_f32_32x32x16_bf16 v[32:47], v[236:239], v[24:27], v[32:47]
    ds_read_b64_tr_b16 v[24:25], v11 offset:2048
    ds_read_b64_tr_b16 v[26:27], v11 offset:2304
    s_waitcnt lgkmcnt(6)
    v_mfma_f32_32x32x16_bf16 v[48:63], v[236:239], v[28:31], v[48:63]
    ds_read_b64_tr_b16 v[28:29], v11 offset:2560
    ds_read_b64_tr_b16 v[30:31], v11 offset:2816
    s_waitcnt lgkmcnt(6)
    v_mfma_f32_32x32x16_bf16 v[32:47], v[240:243], v[16:19], v[32:47]
    ds_read_b64_tr_b16 v[16:17], v11 offset:4096
    ds_read_b64_tr_b16 v[18:19], v11 offset:4352
    s_waitcnt lgkmcnt(6)
    v_mfma_f32_32x32x16_bf16 v[48:63], v[240:243], v[20:23], v[48:63]
    ds_read_b64_tr_b16 v[20:21], v11 offset:4608
    ds_read_b64_tr_b16 v[22:23], v11 offset:4864
    s_waitcnt lgkmcnt(6)
    v_mfma_f32_32x32x16_bf16 v[32:47], v[244:247], v[24:27], v[32:47]
    ds_read_b64_tr_b16 v[24:25], v11 offset:6144
    ds_read_b64_tr_b16 v[26:27], v11 offset:6400
    s_waitcnt lgkmcnt(6)
    v_mfma_f32_32x32x16_bf16 v[48:63], v[244:247], v[28:31], v[48:63]
    ds_read_b64_tr_b16 v[28:29], v11 offset:6656
    ds_read_b64_tr_b16 v[30:31], v11 offset:6912
    s_waitcnt lgkmcnt(6)
    v_mfma_f32_32x32x16_bf16 v[32:47], v[248:251], v[16:19], v[32:47]
    ds_read_b64_tr_b16 v[16:17], v10 offset:0
    ds_read_b64_tr_b16 v[18:19], v10 offset:256
    s_waitcnt lgkmcnt(6)
    v_mfma_f32_32x32x16_bf16 v[48:63], v[248:251], v[20:23], v[48:63]
    ds_read_b64_tr_b16 v[20:21], v10 offset:512
    ds_read_b64_tr_b16 v[22:23], v10 offset:768
    s_waitcnt lgkmcnt(6)
    v_mfma_f32_32x32x16_bf16 v[32:47], v[252:255], v[24:27], v[32:47]
    ds_read_b64_tr_b16 v[24:25], v10 offset:2048
    ds_read_b64_tr_b16 v[26:27], v10 offset:2304
    s_waitcnt lgkmcnt(6)
    v_mfma_f32_32x32x16_bf16 v[48:63], v[252:255], v[28:31], v[48:63]
    s_and_b32 s38, s34, 63
    s_lshr_b32 s41, s38, 1
    s_lshl_b32 s41, s41, 19
    s_and_b32 s38, s38, 1
    s_lshl_b32 s38, s38, 12
    s_add_u32 s41, s41, s38
    s_add_u32 s41, s41, 33554432
    s_nop 0
    v_cvt_pk_bf16_f32 v64, v32, v33
    v_cvt_pk_bf16_f32 v65, v34, v35
    v_cvt_pk_bf16_f32 v66, v36, v37
    v_cvt_pk_bf16_f32 v67, v38, v39
    buffer_store_dwordx4 v[64:67], v7, s[8:11], s41 offen offset:0 sc1
    v_cvt_pk_bf16_f32 v68, v40, v41
    v_cvt_pk_bf16_f32 v69, v42, v43
    v_cvt_pk_bf16_f32 v70, v44, v45
    v_cvt_pk_bf16_f32 v71, v46, v47
    buffer_store_dwordx4 v[68:71], v7, s[8:11], s41 offen offset:1024 sc1
    v_cvt_pk_bf16_f32 v72, v48, v49
    v_cvt_pk_bf16_f32 v73, v50, v51
    v_cvt_pk_bf16_f32 v74, v52, v53
    v_cvt_pk_bf16_f32 v75, v54, v55
    buffer_store_dwordx4 v[72:75], v7, s[8:11], s41 offen offset:2048 sc1
    v_cvt_pk_bf16_f32 v76, v56, v57
    v_cvt_pk_bf16_f32 v77, v58, v59
    v_cvt_pk_bf16_f32 v78, v60, v61
    v_cvt_pk_bf16_f32 v79, v62, v63
    buffer_store_dwordx4 v[76:79], v7, s[8:11], s41 offen offset:3072 sc1
Lqkv_n_1011:
    s_mov_b32 s34, s35
    s_add_u32 s52, s52, 1
    s_mov_b32 s12, s16
    s_mov_b32 s13, s17
    s_mov_b32 s32, s33
    s_add_u32 s37, s52, 1
    s_add_u32 s38, s37, s50
    s_sub_u32 s39, s38, s48
    s_cmp_lt_u32 s38, s48
    s_cselect_b32 s35, s38, s39
    s_mul_i32 s35, s35, s55
    s_add_u32 s35, s35, s54
    s_sub_u32 s38, s37, s48
    s_add_u32 s38, s38, s51
    s_sub_u32 s39, s38, s49
    s_cmp_lt_u32 s38, s49
    s_cselect_b32 s38, s38, s39
    s_add_u32 s38, s38, s56
    s_cmp_lt_u32 s37, s48
    s_cselect_b32 s35, s35, s38
    s_mul_i32 s35, s35, 14
    s_add_u32 s35, s35, s5
    s_cmp_lt_u32 s37, s53
    s_cselect_b32 s35, s35, 192
    s_min_u32 s38, s35, 191
    s_cmp_lt_u32 s38, 64
    s_cselect_b32 s16, s26, s28
    s_cselect_b32 s17, s27, s29
    s_cmp_lt_u32 s38, 128
    s_cselect_b32 s16, s16, s24
    s_cselect_b32 s17, s17, s25
    s_mov_b32 s18, 4718592
    s_mov_b32 s19, 0x20000
    s_and_b32 s33, s38, 63
    s_lshl_b32 s33, s33, 7
    s_cmp_lt_u32 s34, 192
    s_cbranch_scc1 Lqkv_1009
    s_waitcnt vmcnt(0) lgkmcnt(0)
    s_barrier
    s_lshl_b32 s38, s49, 16
    s_cmp_eq_u32 s53, s48
    s_cselect_b32 s38, s48, s38
    s_cmp_lg_u32 s4, 0
    s_cbranch_scc1 Lsig_1017
    s_lshl_b32 s37, s3, 2
    v_mov_b32 v12, s37
    v_mov_b32 v13, s38
    s_mov_b64 exec, 1
    global_atomic_add v12, v13, s[30:31] offset:128 sc1
    s_mov_b64 exec, -1
Lsig_1017:
    s_cmp_lt_u32 s2, 2
    s_cbranch_scc1 Lpend_1006
    s_mov_b32 s2, 0
    s_mov_b32 s3, s6
    s_branch Lpass_1004
Lpend_1006:
    s_cmp_ge_u32 s3, 12
    s_cbranch_scc1 Lws2_1019
    s_mul_i32 s34, s5, 9
    s_add_u32 s36, s34, 9
    s_mul_i32 s45, s5, 3
    s_add_u32 s47, s45, 3
    s_cmp_lt_u32 s5, 4
    s_cbranch_scc1 Lws_1018
    s_sub_u32 s37, s5, 4
    s_mul_i32 s34, s37, 11
    s_add_u32 s34, s34, 36
    s_add_u32 s36, s34, 11
    s_lshl_b32 s45, s37, 1
    s_add_u32 s45, s45, 12
    s_add_u32 s47, s45, 2
    s_cmp_lt_u32 s5, 12
    s_cbranch_scc1 Lws_1018
    s_sub_u32 s37, s5, 12
    s_mul_i32 s34, s37, 10
    s_add_u32 s34, s34, 124
    s_add_u32 s36, s34, 10
    s_branch Lws_1018
Lws2_1019:
    s_mul_i32 s34, s5, 10
    s_min_u32 s37, s5, 4
    s_add_u32 s34, s34, s37
    s_cmp_lt_u32 s5, 4
    s_cselect_b32 s37, 11, 10
    s_add_u32 s36, s34, s37
Lws_1018:
    s_load_dwordx2 s[24:25], s[0:1], 64
    s_load_dwordx2 s[26:27], s[0:1], 72
    s_load_dwordx2 s[28:29], s[0:1], 80
    s_mov_b32 s56, 0xbdd2d3e8
    v_mov_b32 v8, 0xc0135761
    s_mov_b32 s57, s34
    s_waitcnt lgkmcnt(0)
    s_mov_b32 s12, s24
    s_mov_b32 s13, s25
    s_mov_b32 s14, 5308416
    s_mov_b32 s15, 0x20000
    s_mov_b32 s16, s26
    s_mov_b32 s17, s27
    s_mov_b32 s18, 5308416
    s_mov_b32 s19, 0x20000
    s_mov_b32 s20, s28
    s_mov_b32 s21, s29
    s_mov_b32 s22, 5308416
    s_mov_b32 s23, 0x20000
    s_lshl_b32 s32, s34, 6
    s_cmp_lt_u32 s34, s36
    s_cselect_b32 s32, s32, 2130706432
    s_add_u32 s37, s34, 1
    s_lshl_b32 s33, s37, 6
    s_cmp_lt_u32 s37, s36
    s_cselect_b32 s33, s33, 2130706432
    s_mul_i32 s43, s34, 36864
    s_sub_u32 s42, s43, 36864
    s_cmp_lt_u32 s34, s36
    s_cselect_b32 s43, s43, 2130706432
    s_cmp_gt_u32 s34, s57
    s_cselect_b32 s42, s42, 2130706432
    s_add_u32 m0, s40, 0
    s_nop 0
    buffer_load_dwordx4 v5, s[12:15], s32 offen lds
    s_add_u32 m0, s40, 4096
    s_add_u32 s37, s32, 589824
    buffer_load_dwordx4 v5, s[12:15], s37 offen lds
    s_add_u32 m0, s40, 8192
    s_add_u32 s37, s32, 1179648
    buffer_load_dwordx4 v5, s[12:15], s37 offen lds
    s_add_u32 m0, s40, 12288
    s_add_u32 s37, s32, 1769472
    buffer_load_dwordx4 v5, s[12:15], s37 offen lds
    s_add_u32 m0, s40, 16384
    s_add_u32 s37, s32, 2359296
    buffer_load_dwordx4 v5, s[12:15], s37 offen lds
    s_add_u32 m0, s40, 20480
    s_add_u32 s37, s32, 2949120
    buffer_load_dwordx4 v5, s[12:15], s37 offen lds
    s_add_u32 m0, s40, 24576
    s_add_u32 s37, s32, 3538944
    buffer_load_dwordx4 v5, s[12:15], s37 offen lds
    s_add_u32 m0, s40, 28672
    s_add_u32 s37, s32, 4128768
    buffer_load_dwordx4 v5, s[12:15], s37 offen lds
    s_add_u32 m0, s40, 32768
    s_add_u32 s37, s32, 4718592
    buffer_load_dwordx4 v5, s[12:15], s37 offen lds
    s_add_u32 m0, s40, 36864
    s_nop 0
    buffer_load_dwordx4 v5, s[16:19], s32 offen lds
    s_add_u32 m0, s40, 40960
    s_add_u32 s37, s32, 589824
    buffer_load_dwordx4 v5, s[16:19], s37 offen lds
    s_add_u32 m0, s40, 45056
    s_add_u32 s37, s32, 1179648
    buffer_load_dwordx4 v5, s[16:19], s37 offen lds
    s_add_u32 m0, s40, 49152
    s_add_u32 s37, s32, 1769472
    buffer_load_dwordx4 v5, s[16:19], s37 offen lds
    s_add_u32 m0, s40, 53248
    s_add_u32 s37, s32, 2359296
    buffer_load_dwordx4 v5, s[16:19], s37 offen lds
    s_add_u32 m0, s40, 57344
    s_add_u32 s37, s32, 2949120
    buffer_load_dwordx4 v5, s[16:19], s37 offen lds
    s_add_u32 m0, s40, 61440
    s_add_u32 s37, s32, 3538944
    buffer_load_dwordx4 v5, s[16:19], s37 offen lds
    s_add_u32 m0, s40, 65536
    s_add_u32 s37, s32, 4128768
    buffer_load_dwordx4 v5, s[16:19], s37 offen lds
    s_add_u32 m0, s40, 69632
    s_add_u32 s37, s32, 4718592
    buffer_load_dwordx4 v5, s[16:19], s37 offen lds
    s_add_u32 m0, s40, 73728
    s_nop 0
    buffer_load_dwordx4 v6, s[20:23], s42 offen lds
    s_add_u32 m0, s40, 77824
    s_add_u32 s37, s42, 128
    buffer_load_dwordx4 v6, s[20:23], s37 offen lds
    s_add_u32 m0, s40, 81920
    s_add_u32 s37, s42, 256
    buffer_load_dwordx4 v6, s[20:23], s37 offen lds
    v_accvgpr_write_b32 a0, 0
    v_accvgpr_write_b32 a1, 0
    v_accvgpr_write_b32 a2, 0
    v_accvgpr_write_b32 a3, 0
    v_accvgpr_write_b32 a4, 0
    v_accvgpr_write_b32 a5, 0
    v_accvgpr_write_b32 a6, 0
    v_accvgpr_write_b32 a7, 0
    v_accvgpr_write_b32 a8, 0
    v_accvgpr_write_b32 a9, 0
    v_accvgpr_write_b32 a10, 0
    v_accvgpr_write_b32 a11, 0
    v_accvgpr_write_b32 a12, 0
    v_accvgpr_write_b32 a13, 0
    v_accvgpr_write_b32 a14, 0
    v_accvgpr_write_b32 a15, 0
    v_accvgpr_write_b32 a16, 0
    v_accvgpr_write_b32 a17, 0
    v_accvgpr_write_b32 a18, 0
    v_accvgpr_write_b32 a19, 0
    v_accvgpr_write_b32 a20, 0
    v_accvgpr_write_b32 a21, 0
    v_accvgpr_write_b32 a22, 0
    v_accvgpr_write_b32 a23, 0
    v_accvgpr_write_b32 a24, 0
    v_accvgpr_write_b32 a25, 0
    v_accvgpr_write_b32 a26, 0
    v_accvgpr_write_b32 a27, 0
    v_accvgpr_write_b32 a28, 0
    v_accvgpr_write_b32 a29, 0
    v_accvgpr_write_b32 a30, 0
    v_accvgpr_write_b32 a31, 0
    v_accvgpr_write_b32 a32, 0
    v_accvgpr_write_b32 a33, 0
    v_accvgpr_write_b32 a34, 0
    v_accvgpr_write_b32 a35, 0
    v_accvgpr_write_b32 a36, 0
    v_accvgpr_write_b32 a37, 0
    v_accvgpr_write_b32 a38, 0
    v_accvgpr_write_b32 a39, 0
    v_accvgpr_write_b32 a40, 0
    v_accvgpr_write_b32 a41, 0
    v_accvgpr_write_b32 a42, 0
    v_accvgpr_write_b32 a43, 0
    v_accvgpr_write_b32 a44, 0
    v_accvgpr_write_b32 a45, 0
    v_accvgpr_write_b32 a46, 0
    v_accvgpr_write_b32 a47, 0
    v_accvgpr_write_b32 a48, 0
    v_accvgpr_write_b32 a49, 0
    v_accvgpr_write_b32 a50, 0
    v_accvgpr_write_b32 a51, 0
    v_accvgpr_write_b32 a52, 0
    v_accvgpr_write_b32 a53, 0
    v_accvgpr_write_b32 a54, 0
    v_accvgpr_write_b32 a55, 0
    v_accvgpr_write_b32 a56, 0
    v_accvgpr_write_b32 a57, 0
    v_accvgpr_write_b32 a58, 0
    v_accvgpr_write_b32 a59, 0
    v_accvgpr_write_b32 a60, 0
    v_accvgpr_write_b32 a61, 0
    v_accvgpr_write_b32 a62, 0
    v_accvgpr_write_b32 a63, 0
    v_accvgpr_write_b32 a64, 0
    v_accvgpr_write_b32 a65, 0
    v_accvgpr_write_b32 a66, 0
    v_accvgpr_write_b32 a67, 0
    v_accvgpr_write_b32 a68, 0
    v_accvgpr_write_b32 a69, 0
    v_accvgpr_write_b32 a70, 0
    v_accvgpr_write_b32 a71, 0
    v_accvgpr_write_b32 a72, 0
    v_accvgpr_write_b32 a73, 0
    v_accvgpr_write_b32 a74, 0
    v_accvgpr_write_b32 a75, 0
    v_accvgpr_write_b32 a76, 0
    v_accvgpr_write_b32 a77, 0
    v_accvgpr_write_b32 a78, 0
    v_accvgpr_write_b32 a79, 0
    v_accvgpr_write_b32 a80, 0
    v_accvgpr_write_b32 a81, 0
    v_accvgpr_write_b32 a82, 0
    v_accvgpr_write_b32 a83, 0
    v_accvgpr_write_b32 a84, 0
    v_accvgpr_write_b32 a85, 0
    v_accvgpr_write_b32 a86, 0
    v_accvgpr_write_b32 a87, 0
    v_accvgpr_write_b32 a88, 0
    v_accvgpr_write_b32 a89, 0
    v_accvgpr_write_b32 a90, 0
    v_accvgpr_write_b32 a91, 0
    v_accvgpr_write_b32 a92, 0
    v_accvgpr_write_b32 a93, 0
    v_accvgpr_write_b32 a94, 0
    v_accvgpr_write_b32 a95, 0
    v_accvgpr_write_b32 a96, 0
    v_accvgpr_write_b32 a97, 0
    v_accvgpr_write_b32 a98, 0
    v_accvgpr_write_b32 a99, 0
    v_accvgpr_write_b32 a100, 0
    v_accvgpr_write_b32 a101, 0
    v_accvgpr_write_b32 a102, 0
    v_accvgpr_write_b32 a103, 0
    v_accvgpr_write_b32 a104, 0
    v_accvgpr_write_b32 a105, 0
    v_accvgpr_write_b32 a106, 0
    v_accvgpr_write_b32 a107, 0
    v_accvgpr_write_b32 a108, 0
    v_accvgpr_write_b32 a109, 0
    v_accvgpr_write_b32 a110, 0
    v_accvgpr_write_b32 a111, 0
    v_accvgpr_write_b32 a112, 0
    v_accvgpr_write_b32 a113, 0
    v_accvgpr_write_b32 a114, 0
    v_accvgpr_write_b32 a115, 0
    v_accvgpr_write_b32 a116, 0
    v_accvgpr_write_b32 a117, 0
    v_accvgpr_write_b32 a118, 0
    v_accvgpr_write_b32 a119, 0
    v_accvgpr_write_b32 a120, 0
    v_accvgpr_write_b32 a121, 0
    v_accvgpr_write_b32 a122, 0
    v_accvgpr_write_b32 a123, 0
    v_accvgpr_write_b32 a124, 0
    v_accvgpr_write_b32 a125, 0
    v_accvgpr_write_b32 a126, 0
    v_accvgpr_write_b32 a127, 0
    v_accvgpr_write_b32 a128, 0
    v_accvgpr_write_b32 a129, 0
    v_accvgpr_write_b32 a130, 0
    v_accvgpr_write_b32 a131, 0
    v_accvgpr_write_b32 a132, 0
    v_accvgpr_write_b32 a133, 0
    v_accvgpr_write_b32 a134, 0
    v_accvgpr_write_b32 a135, 0
    v_accvgpr_write_b32 a136, 0
    v_accvgpr_write_b32 a137, 0
    v_accvgpr_write_b32 a138, 0
    v_accvgpr_write_b32 a139, 0
    v_accvgpr_write_b32 a140, 0
    v_accvgpr_write_b32 a141, 0
    v_accvgpr_write_b32 a142, 0
    v_accvgpr_write_b32 a143, 0
    v_accvgpr_write_b32 a144, 0
    v_accvgpr_write_b32 a145, 0
    v_accvgpr_write_b32 a146, 0
    v_accvgpr_write_b32 a147, 0
    v_accvgpr_write_b32 a148, 0
    v_accvgpr_write_b32 a149, 0
    v_accvgpr_write_b32 a150, 0
    v_accvgpr_write_b32 a151, 0
    v_accvgpr_write_b32 a152, 0
    v_accvgpr_write_b32 a153, 0
    v_accvgpr_write_b32 a154, 0
    v_accvgpr_write_b32 a155, 0
    v_accvgpr_write_b32 a156, 0
    v_accvgpr_write_b32 a157, 0
    v_accvgpr_write_b32 a158, 0
    v_accvgpr_write_b32 a159, 0
    v_accvgpr_write_b32 a160, 0
    v_accvgpr_write_b32 a161, 0
    v_accvgpr_write_b32 a162, 0
    v_accvgpr_write_b32 a163, 0
    v_accvgpr_write_b32 a164, 0
    v_accvgpr_write_b32 a165, 0
    v_accvgpr_write_b32 a166, 0
    v_accvgpr_write_b32 a167, 0
    v_accvgpr_write_b32 a168, 0
    v_accvgpr_write_b32 a169, 0
    v_accvgpr_write_b32 a170, 0
    v_accvgpr_write_b32 a171, 0
    v_accvgpr_write_b32 a172, 0
    v_accvgpr_write_b32 a173, 0
    v_accvgpr_write_b32 a174, 0
    v_accvgpr_write_b32 a175, 0
    v_accvgpr_write_b32 a176, 0
    v_accvgpr_write_b32 a177, 0
    v_accvgpr_write_b32 a178, 0
    v_accvgpr_write_b32 a179, 0
    v_accvgpr_write_b32 a180, 0
    v_accvgpr_write_b32 a181, 0
    v_accvgpr_write_b32 a182, 0
    v_accvgpr_write_b32 a183, 0
    v_accvgpr_write_b32 a184, 0
    v_accvgpr_write_b32 a185, 0
    v_accvgpr_write_b32 a186, 0
    v_accvgpr_write_b32 a187, 0
    v_accvgpr_write_b32 a188, 0
    v_accvgpr_write_b32 a189, 0
    v_accvgpr_write_b32 a190, 0
    v_accvgpr_write_b32 a191, 0
    v_accvgpr_write_b32 a192, 0
    v_accvgpr_write_b32 a193, 0
    v_accvgpr_write_b32 a194, 0
    v_accvgpr_write_b32 a195, 0
    v_accvgpr_write_b32 a196, 0
    v_accvgpr_write_b32 a197, 0
    v_accvgpr_write_b32 a198, 0
    v_accvgpr_write_b32 a199, 0
    v_accvgpr_write_b32 a200, 0
    v_accvgpr_write_b32 a201, 0
    v_accvgpr_write_b32 a202, 0
    v_accvgpr_write_b32 a203, 0
    v_accvgpr_write_b32 a204, 0
    v_accvgpr_write_b32 a205, 0
    v_accvgpr_write_b32 a206, 0
    v_accvgpr_write_b32 a207, 0
    v_accvgpr_write_b32 a208, 0
    v_accvgpr_write_b32 a209, 0
    v_accvgpr_write_b32 a210, 0
    v_accvgpr_write_b32 a211, 0
    v_accvgpr_write_b32 a212, 0
    v_accvgpr_write_b32 a213, 0
    v_accvgpr_write_b32 a214, 0
    v_accvgpr_write_b32 a215, 0
    v_accvgpr_write_b32 a216, 0
    v_accvgpr_write_b32 a217, 0
    v_accvgpr_write_b32 a218, 0
    v_accvgpr_write_b32 a219, 0
    v_accvgpr_write_b32 a220, 0
    v_accvgpr_write_b32 a221, 0
    v_accvgpr_write_b32 a222, 0
    v_accvgpr_write_b32 a223, 0
    v_accvgpr_write_b32 a224, 0
    v_accvgpr_write_b32 a225, 0
    v_accvgpr_write_b32 a226, 0
    v_accvgpr_write_b32 a227, 0
    v_accvgpr_write_b32 a228, 0
    v_accvgpr_write_b32 a229, 0
    v_accvgpr_write_b32 a230, 0
    v_accvgpr_write_b32 a231, 0
    v_accvgpr_write_b32 a232, 0
    v_accvgpr_write_b32 a233, 0
    v_accvgpr_write_b32 a234, 0
    v_accvgpr_write_b32 a235, 0
    v_accvgpr_write_b32 a236, 0
    v_accvgpr_write_b32 a237, 0
    v_accvgpr_write_b32 a238, 0
    v_accvgpr_write_b32 a239, 0
    v_accvgpr_write_b32 a240, 0
    v_accvgpr_write_b32 a241, 0
    v_accvgpr_write_b32 a242, 0
    v_accvgpr_write_b32 a243, 0
    v_accvgpr_write_b32 a244, 0
    v_accvgpr_write_b32 a245, 0
    v_accvgpr_write_b32 a246, 0
    v_accvgpr_write_b32 a247, 0
    v_accvgpr_write_b32 a248, 0
    v_accvgpr_write_b32 a249, 0
    v_accvgpr_write_b32 a250, 0
    v_accvgpr_write_b32 a251, 0
    v_accvgpr_write_b32 a252, 0
    v_accvgpr_write_b32 a253, 0
    v_accvgpr_write_b32 a254, 0
    v_accvgpr_write_b32 a255, 0
    v_mov_b64 v[80:81], 0
    v_mov_b64 v[82:83], 0
    v_mov_b64 v[84:85], 0
    v_mov_b64 v[86:87], 0
    v_mov_b64 v[88:89], 0
    v_mov_b64 v[90:91], 0
    v_mov_b64 v[92:93], 0
    v_mov_b64 v[94:95], 0
    v_mov_b64 v[96:97], 0
    v_mov_b64 v[98:99], 0
    v_mov_b64 v[100:101], 0
    v_mov_b64 v[102:103], 0
    v_mov_b64 v[104:105], 0
    v_mov_b64 v[106:107], 0
    v_mov_b64 v[108:109], 0
    v_mov_b64 v[110:111], 0
    s_waitcnt vmcnt(0)
    s_barrier
    ds_read_b64_tr_b16 v[16:17], v1 offset:0
    ds_read_b64_tr_b16 v[18:19], v1 offset:256
    ds_read_b64_tr_b16 v[20:21], v1 offset:1024
    ds_read_b64_tr_b16 v[22:23], v1 offset:1280
    ds_read_b64_tr_b16 v[24:25], v1 offset:2048
    ds_read_b64_tr_b16 v[26:27], v1 offset:2304
Lffn_1020:
    s_cmp_lt_u32 s34, s36
    s_cbranch_scc0 Lffn_l_1021
    s_waitcnt vmcnt(15)
    s_barrier
    s_add_u32 m0, s40, 86016
    s_add_u32 s37, s42, 384
    buffer_load_dwordx4 v6, s[20:23], s37 offen lds
    s_add_u32 m0, s40, 90112
    s_add_u32 s37, s42, 512
    buffer_load_dwordx4 v6, s[20:23], s37 offen lds
    s_add_u32 m0, s40, 94208
    s_add_u32 s37, s42, 640
    buffer_load_dwordx4 v6, s[20:23], s37 offen lds
    ds_read_b64_tr_b16 v[28:29], v1 offset:3072
    ds_read_b64_tr_b16 v[30:31], v1 offset:3328
    s_waitcnt lgkmcnt(6)
    v_mfma_f32_32x32x16_bf16 v[32:47], v[16:19], v[112:115], 0
    ds_read_b64_tr_b16 v[16:17], v1 offset:4096
    ds_read_b64_tr_b16 v[18:19], v1 offset:4352
    s_waitcnt lgkmcnt(6)
    v_mfma_f32_32x32x16_bf16 v[32:47], v[20:23], v[116:119], v[32:47]
    v_lshlrev_b32 v12, 16, v64
    v_and_b32 v13, 0xffff0000, v64
    ds_read_b64_tr_b16 v[20:21], v1 offset:5120
    ds_read_b64_tr_b16 v[22:23], v1 offset:5376
    s_waitcnt lgkmcnt(6)
    v_mfma_f32_32x32x16_bf16 v[32:47], v[24:27], v[120:123], v[32:47]
    v_mul_f32 v12, v12, v48
    v_mul_f32 v13, v13, v49
    ds_read_b64_tr_b16 v[24:25], v1 offset:6144
    ds_read_b64_tr_b16 v[26:27], v1 offset:6400
    s_waitcnt lgkmcnt(6)
    v_mfma_f32_32x32x16_bf16 v[32:47], v[28:31], v[124:127], v[32:47]
    v_cvt_pk_bf16_f32 v72, v12, v13
    v_lshlrev_b32 v14, 16, v65
    ds_read_b64_tr_b16 v[28:29], v1 offset:7168
    ds_read_b64_tr_b16 v[30:31], v1 offset:7424
    s_waitcnt lgkmcnt(6)
    v_mfma_f32_32x32x16_bf16 v[32:47], v[16:19], v[128:131], v[32:47]
    v_and_b32 v15, 0xffff0000, v65
    v_mul_f32 v14, v14, v50
    ds_read_b64_tr_b16 v[16:17], v1 offset:8192
    ds_read_b64_tr_b16 v[18:19], v1 offset:8448
    s_waitcnt lgkmcnt(6)
    v_mfma_f32_32x32x16_bf16 v[32:47], v[20:23], v[132:135], v[32:47]
    v_mul_f32 v15, v15, v51
    v_cvt_pk_bf16_f32 v73, v14, v15
    ds_read_b64_tr_b16 v[20:21], v1 offset:9216
    ds_read_b64_tr_b16 v[22:23], v1 offset:9472
    s_waitcnt lgkmcnt(6)
    v_mfma_f32_32x32x16_bf16 v[32:47], v[24:27], v[136:139], v[32:47]
    v_lshlrev_b32 v12, 16, v66
    v_and_b32 v13, 0xffff0000, v66
    ds_read_b64_tr_b16 v[24:25], v1 offset:10240
    ds_read_b64_tr_b16 v[26:27], v1 offset:10496
    s_waitcnt lgkmcnt(6)
    v_mfma_f32_32x32x16_bf16 v[32:47], v[28:31], v[140:143], v[32:47]
    v_mul_f32 v12, v12, v52
    v_mul_f32 v13, v13, v53
    ds_read_b64_tr_b16 v[28:29], v1 offset:11264
    ds_read_b64_tr_b16 v[30:31], v1 offset:11520
    s_waitcnt lgkmcnt(6)
    v_mfma_f32_32x32x16_bf16 v[32:47], v[16:19], v[144:147], v[32:47]
    v_cvt_pk_bf16_f32 v74, v12, v13
    v_lshlrev_b32 v14, 16, v67
    ds_read_b64_tr_b16 v[16:17], v1 offset:12288
    ds_read_b64_tr_b16 v[18:19], v1 offset:12544
    s_waitcnt lgkmcnt(6)
    v_mfma_f32_32x32x16_bf16 v[32:47], v[20:23], v[148:151], v[32:47]
    v_and_b32 v15, 0xffff0000, v67
    v_mul_f32 v14, v14, v54
    ds_read_b64_tr_b16 v[20:21], v1 offset:13312
    ds_read_b64_tr_b16 v[22:23], v1 offset:13568
    s_waitcnt lgkmcnt(6)
    v_mfma_f32_32x32x16_bf16 v[32:47], v[24:27], v[152:155], v[32:47]
    v_mul_f32 v15, v15, v55
    v_cvt_pk_bf16_f32 v75, v14, v15
    ds_read_b64_tr_b16 v[24:25], v1 offset:14336
    ds_read_b64_tr_b16 v[26:27], v1 offset:14592
    s_waitcnt lgkmcnt(6)
    v_mfma_f32_32x32x16_bf16 v[32:47], v[28:31], v[156:159], v[32:47]
    v_lshlrev_b32 v12, 16, v68
    v_and_b32 v13, 0xffff0000, v68
    s_waitcnt vmcnt(15)
    s_barrier
    s_add_u32 m0, s40, 98304
    s_add_u32 s37, s42, 768
    buffer_load_dwordx4 v6, s[20:23], s37 offen lds
    s_add_u32 m0, s40, 102400
    s_add_u32 s37, s42, 896
    buffer_load_dwordx4 v6, s[20:23], s37 offen lds
    s_add_u32 m0, s40, 106496
    s_add_u32 s37, s42, 1024
    buffer_load_dwordx4 v6, s[20:23], s37 offen lds
    ds_read_b64_tr_b16 v[28:29], v1 offset:15360
    ds_read_b64_tr_b16 v[30:31], v1 offset:15616
    s_waitcnt lgkmcnt(6)
    v_mfma_f32_32x32x16_bf16 v[32:47], v[16:19], v[160:163], v[32:47]
    v_mul_f32 v12, v12, v56
    v_mul_f32 v13, v13, v57
    ds_read_b64_tr_b16 v[16:17], v1 offset:16384
    ds_read_b64_tr_b16 v[18:19], v1 offset:16640
    s_waitcnt lgkmcnt(6)
    v_mfma_f32_32x32x16_bf16 v[32:47], v[20:23], v[164:167], v[32:47]
    v_cvt_pk_bf16_f32 v76, v12, v13
    v_lshlrev_b32 v14, 16, v69
    ds_read_b64_tr_b16 v[20:21], v1 offset:17408
    ds_read_b64_tr_b16 v[22:23], v1 offset:17664
    s_waitcnt lgkmcnt(6)
    v_mfma_f32_32x32x16_bf16 v[32:47], v[24:27], v[168:171], v[32:47]
    v_and_b32 v15, 0xffff0000, v69
    v_mul_f32 v14, v14, v58
    ds_read_b64_tr_b16 v[24:25], v1 offset:18432
    ds_read_b64_tr_b16 v[26:27], v1 offset:18688
    s_waitcnt lgkmcnt(6)
    v_mfma_f32_32x32x16_bf16 v[32:47], v[28:31], v[172:175], v[32:47]
    v_mul_f32 v15, v15, v59
    v_cvt_pk_bf16_f32 v77, v14, v15
    ds_read_b64_tr_b16 v[28:29], v1 offset:19456
    ds_read_b64_tr_b16 v[30:31], v1 offset:19712
    s_waitcnt lgkmcnt(6)
    v_mfma_f32_32x32x16_bf16 v[32:47], v[16:19], v[176:179], v[32:47]
    v_lshlrev_b32 v12, 16, v70
    v_and_b32 v13, 0xffff0000, v70
    ds_read_b64_tr_b16 v[16:17], v1 offset:20480
    ds_read_b64_tr_b16 v[18:19], v1 offset:20736
    s_waitcnt lgkmcnt(6)
    v_mfma_f32_32x32x16_bf16 v[32:47], v[20:23], v[180:183], v[32:47]
    v_mul_f32 v12, v12, v60
    v_mul_f32 v13, v13, v61
    ds_read_b64_tr_b16 v[20:21], v1 offset:21504
    ds_read_b64_tr_b16 v[22:23], v1 offset:21760
    s_waitcnt lgkmcnt(6)
    v_mfma_f32_32x32x16_bf16 v[32:47], v[24:27], v[184:187], v[32:47]
    v_cvt_pk_bf16_f32 v78, v12, v13
    v_lshlrev_b32 v14, 16, v71
    ds_read_b64_tr_b16 v[24:25], v1 offset:22528
    ds_read_b64_tr_b16 v[26:27], v1 offset:22784
    s_waitcnt lgkmcnt(6)
    v_mfma_f32_32x32x16_bf16 v[32:47], v[28:31], v[188:191], v[32:47]
    v_and_b32 v15, 0xffff0000, v71
    v_mul_f32 v14, v14, v62
    ds_read_b64_tr_b16 v[28:29], v1 offset:23552
    ds_read_b64_tr_b16 v[30:31], v1 offset:23808
    s_waitcnt lgkmcnt(6)
    v_mfma_f32_32x32x16_bf16 v[32:47], v[16:19], v[192:195], v[32:47]
    v_mul_f32 v15, v15, v63
    v_cvt_pk_bf16_f32 v79, v14, v15
    ds_read_b64_tr_b16 v[16:17], v1 offset:24576
    ds_read_b64_tr_b16 v[18:19], v1 offset:24832
    s_waitcnt lgkmcnt(6)
    v_mfma_f32_32x32x16_bf16 v[32:47], v[20:23], v[196:199], v[32:47]
    ds_read_b64_tr_b16 v[20:21], v1 offset:25600
    ds_read_b64_tr_b16 v[22:23], v1 offset:25856
    s_waitcnt lgkmcnt(6)
    v_mfma_f32_32x32x16_bf16 v[32:47], v[24:27], v[200:203], v[32:47]
    ds_read_b64_tr_b16 v[24:25], v1 offset:26624
    ds_read_b64_tr_b16 v[26:27], v1 offset:26880
    s_waitcnt lgkmcnt(6)
    v_mfma_f32_32x32x16_bf16 v[32:47], v[28:31], v[204:207], v[32:47]
    s_waitcnt vmcnt(15)
    s_barrier
    s_add_u32 m0, s40, 0
    s_nop 0
    buffer_load_dwordx4 v5, s[12:15], s33 offen lds
    s_add_u32 m0, s40, 4096
    s_add_u32 s37, s33, 589824
    buffer_load_dwordx4 v5, s[12:15], s37 offen lds
    s_add_u32 m0, s40, 8192
    s_add_u32 s37, s33, 1179648
    buffer_load_dwordx4 v5, s[12:15], s37 offen lds
    ds_read_b64_tr_b16 v[28:29], v1 offset:27648
    ds_read_b64_tr_b16 v[30:31], v1 offset:27904
    s_waitcnt lgkmcnt(6)
    v_mfma_f32_32x32x16_bf16 v[32:47], v[16:19], v[208:211], v[32:47]
    ds_read_b64_tr_b16 v[16:17], v1 offset:28672
    ds_read_b64_tr_b16 v[18:19], v1 offset:28928
    s_waitcnt lgkmcnt(6)
    v_mfma_f32_32x32x16_bf16 v[32:47], v[20:23], v[212:215], v[32:47]
    ds_read_b64_tr_b16 v[20:21], v1 offset:29696
    ds_read_b64_tr_b16 v[22:23], v1 offset:29952
    s_waitcnt lgkmcnt(6)
    v_mfma_f32_32x32x16_bf16 v[32:47], v[24:27], v[216:219], v[32:47]
    ds_read_b64_tr_b16 v[24:25], v1 offset:30720
    ds_read_b64_tr_b16 v[26:27], v1 offset:30976
    s_waitcnt lgkmcnt(6)
    v_mfma_f32_32x32x16_bf16 v[32:47], v[28:31], v[220:223], v[32:47]
    ds_read_b64_tr_b16 v[28:29], v1 offset:31744
    ds_read_b64_tr_b16 v[30:31], v1 offset:32000
    s_waitcnt lgkmcnt(6)
    v_mfma_f32_32x32x16_bf16 v[32:47], v[16:19], v[224:227], v[32:47]
    ds_read_b64_tr_b16 v[16:17], v1 offset:32768
    ds_read_b64_tr_b16 v[18:19], v1 offset:33024
    s_waitcnt lgkmcnt(6)
    v_mfma_f32_32x32x16_bf16 v[32:47], v[20:23], v[228:231], v[32:47]
    ds_read_b64_tr_b16 v[20:21], v1 offset:33792
    ds_read_b64_tr_b16 v[22:23], v1 offset:34048
    s_waitcnt lgkmcnt(6)
    v_mfma_f32_32x32x16_bf16 v[32:47], v[24:27], v[232:235], v[32:47]
    ds_read_b64_tr_b16 v[24:25], v1 offset:34816
    ds_read_b64_tr_b16 v[26:27], v1 offset:35072
    s_waitcnt lgkmcnt(6)
    v_mfma_f32_32x32x16_bf16 v[32:47], v[28:31], v[236:239], v[32:47]
    ds_read_b64_tr_b16 v[28:29], v1 offset:35840
    ds_read_b64_tr_b16 v[30:31], v1 offset:36096
    s_waitcnt lgkmcnt(6)
    v_mfma_f32_32x32x16_bf16 v[32:47], v[16:19], v[240:243], v[32:47]
    ds_read_b64_tr_b16 v[16:17], v1 offset:36864
    ds_read_b64_tr_b16 v[18:19], v1 offset:37120
    s_waitcnt lgkmcnt(6)
    v_mfma_f32_32x32x16_bf16 v[32:47], v[20:23], v[244:247], v[32:47]
    ds_read_b64_tr_b16 v[20:21], v1 offset:37888
    ds_read_b64_tr_b16 v[22:23], v1 offset:38144
    s_waitcnt lgkmcnt(6)
    v_mfma_f32_32x32x16_bf16 v[32:47], v[24:27], v[248:251], v[32:47]
    ds_read_b64_tr_b16 v[24:25], v1 offset:38912
    ds_read_b64_tr_b16 v[26:27], v1 offset:39168
    s_waitcnt lgkmcnt(6)
    v_mfma_f32_32x32x16_bf16 v[32:47], v[28:31], v[252:255], v[32:47]
    s_branch Lffn_e_1022
Lffn_l_1021:
    s_waitcnt vmcnt(15)
    s_barrier
    s_add_u32 m0, s40, 86016
    s_add_u32 s37, s42, 384
    buffer_load_dwordx4 v6, s[20:23], s37 offen lds
    s_add_u32 m0, s40, 90112
    s_add_u32 s37, s42, 512
    buffer_load_dwordx4 v6, s[20:23], s37 offen lds
    s_add_u32 m0, s40, 94208
    s_add_u32 s37, s42, 640
    buffer_load_dwordx4 v6, s[20:23], s37 offen lds
    s_waitcnt vmcnt(15)
    s_barrier
    s_add_u32 m0, s40, 98304
    s_add_u32 s37, s42, 768
    buffer_load_dwordx4 v6, s[20:23], s37 offen lds
    s_add_u32 m0, s40, 102400
    s_add_u32 s37, s42, 896
    buffer_load_dwordx4 v6, s[20:23], s37 offen lds
    s_add_u32 m0, s40, 106496
    s_add_u32 s37, s42, 1024
    buffer_load_dwordx4 v6, s[20:23], s37 offen lds
    s_waitcnt vmcnt(15)
    s_barrier
    s_add_u32 m0, s40, 0
    s_nop 0
    buffer_load_dwordx4 v5, s[12:15], s33 offen lds
    s_add_u32 m0, s40, 4096
    s_add_u32 s37, s33, 589824
    buffer_load_dwordx4 v5, s[12:15], s37 offen lds
    s_add_u32 m0, s40, 8192
    s_add_u32 s37, s33, 1179648
    buffer_load_dwordx4 v5, s[12:15], s37 offen lds
    s_waitcnt lgkmcnt(0)
    v_lshlrev_b32 v12, 16, v64
    v_and_b32 v13, 0xffff0000, v64
    v_mul_f32 v12, v12, v48
    v_mul_f32 v13, v13, v49
    v_cvt_pk_bf16_f32 v72, v12, v13
    v_lshlrev_b32 v14, 16, v65
    v_and_b32 v15, 0xffff0000, v65
    v_mul_f32 v14, v14, v50
    v_mul_f32 v15, v15, v51
    v_cvt_pk_bf16_f32 v73, v14, v15
    v_lshlrev_b32 v12, 16, v66
    v_and_b32 v13, 0xffff0000, v66
    v_mul_f32 v12, v12, v52
    v_mul_f32 v13, v13, v53
    v_cvt_pk_bf16_f32 v74, v12, v13
    v_lshlrev_b32 v14, 16, v67
    v_and_b32 v15, 0xffff0000, v67
    v_mul_f32 v14, v14, v54
    v_mul_f32 v15, v15, v55
    v_cvt_pk_bf16_f32 v75, v14, v15
    v_lshlrev_b32 v12, 16, v68
    v_and_b32 v13, 0xffff0000, v68
    v_mul_f32 v12, v12, v56
    v_mul_f32 v13, v13, v57
    v_cvt_pk_bf16_f32 v76, v12, v13
    v_lshlrev_b32 v14, 16, v69
    v_and_b32 v15, 0xffff0000, v69
    v_mul_f32 v14, v14, v58
    v_mul_f32 v15, v15, v59
    v_cvt_pk_bf16_f32 v77, v14, v15
    v_lshlrev_b32 v12, 16, v70
    v_and_b32 v13, 0xffff0000, v70
    v_mul_f32 v12, v12, v60
    v_mul_f32 v13, v13, v61
    v_cvt_pk_bf16_f32 v78, v12, v13
    v_lshlrev_b32 v14, 16, v71
    v_and_b32 v15, 0xffff0000, v71
    v_mul_f32 v14, v14, v62
    v_mul_f32 v15, v15, v63
    v_cvt_pk_bf16_f32 v79, v14, v15
    ds_read_b64_tr_b16 v[16:17], v1 offset:36864
    ds_read_b64_tr_b16 v[18:19], v1 offset:37120
    ds_read_b64_tr_b16 v[20:21], v1 offset:37888
    ds_read_b64_tr_b16 v[22:23], v1 offset:38144
    ds_read_b64_tr_b16 v[24:25], v1 offset:38912
    ds_read_b64_tr_b16 v[26:27], v1 offset:39168
Lffn_e_1022:
    s_cmp_lt_u32 s34, s36
    s_cbranch_scc0 Lffn_l_1023
    s_waitcnt vmcnt(15)
    s_barrier
    s_add_u32 m0, s40, 12288
    s_add_u32 s37, s33, 1769472
    buffer_load_dwordx4 v5, s[12:15], s37 offen lds
    s_add_u32 m0, s40, 16384
    s_add_u32 s37, s33, 2359296
    buffer_load_dwordx4 v5, s[12:15], s37 offen lds
    s_add_u32 m0, s40, 20480
    s_add_u32 s37, s33, 2949120
    buffer_load_dwordx4 v5, s[12:15], s37 offen lds
    ds_read_b64_tr_b16 v[28:29], v1 offset:39936
    ds_read_b64_tr_b16 v[30:31], v1 offset:40192
    s_waitcnt lgkmcnt(6)
    v_mfma_f32_32x32x16_bf16 v[48:63], v[16:19], v[112:115], 0
    ds_read_b64_tr_b16 v[16:17], v1 offset:40960
    ds_read_b64_tr_b16 v[18:19], v1 offset:41216
    s_waitcnt lgkmcnt(6)
    v_mfma_f32_32x32x16_bf16 v[48:63], v[20:23], v[116:119], v[48:63]
    v_mul_f32 v12, v32, v32
    v_mul_f32 v13, v33, v33
    ds_read_b64_tr_b16 v[20:21], v1 offset:41984
    ds_read_b64_tr_b16 v[22:23], v1 offset:42240
    s_waitcnt lgkmcnt(6)
    v_mfma_f32_32x32x16_bf16 v[48:63], v[24:27], v[120:123], v[48:63]
    v_fma_f32 v12, v12, s56, v8
    v_fma_f32 v13, v13, s56, v8
    ds_read_b64_tr_b16 v[24:25], v1 offset:43008
    ds_read_b64_tr_b16 v[26:27], v1 offset:43264
    s_waitcnt lgkmcnt(6)
    v_mfma_f32_32x32x16_bf16 v[48:63], v[28:31], v[124:127], v[48:63]
    v_mul_f32 v12, v12, v32
    v_mul_f32 v13, v13, v33
    ds_read_b64_tr_b16 v[28:29], v1 offset:44032
    ds_read_b64_tr_b16 v[30:31], v1 offset:44288
    s_waitcnt lgkmcnt(6)
    v_mfma_f32_32x32x16_bf16 v[48:63], v[16:19], v[128:131], v[48:63]
    v_exp_f32 v12, v12
    v_exp_f32 v13, v13
    ds_read_b64_tr_b16 v[16:17], v1 offset:45056
    ds_read_b64_tr_b16 v[18:19], v1 offset:45312
    s_waitcnt lgkmcnt(6)
    v_mfma_f32_32x32x16_bf16 v[48:63], v[20:23], v[132:135], v[48:63]
    v_add_f32 v12, 1.0, v12
    v_add_f32 v13, 1.0, v13
    ds_read_b64_tr_b16 v[20:21], v1 offset:46080
    ds_read_b64_tr_b16 v[22:23], v1 offset:46336
    s_waitcnt lgkmcnt(6)
    v_mfma_f32_32x32x16_bf16 v[48:63], v[24:27], v[136:139], v[48:63]
    v_rcp_f32 v12, v12
    v_rcp_f32 v13, v13
    ds_read_b64_tr_b16 v[24:25], v1 offset:47104
    ds_read_b64_tr_b16 v[26:27], v1 offset:47360
    s_waitcnt lgkmcnt(6)
    v_mfma_f32_32x32x16_bf16 v[48:63], v[28:31], v[140:143], v[48:63]
    v_mul_f32 v12, v12, v32
    v_mul_f32 v13, v13, v33
    ds_read_b64_tr_b16 v[28:29], v1 offset:48128
    ds_read_b64_tr_b16 v[30:31], v1 offset:48384
    s_waitcnt lgkmcnt(6)
    v_mfma_f32_32x32x16_bf16 v[48:63], v[16:19], v[144:147], v[48:63]
    v_cvt_pk_bf16_f32 v64, v12, v13
    v_mul_f32 v14, v34, v34
    ds_read_b64_tr_b16 v[16:17], v1 offset:49152
    ds_read_b64_tr_b16 v[18:19], v1 offset:49408
    s_waitcnt lgkmcnt(6)
    v_mfma_f32_32x32x16_bf16 v[48:63], v[20:23], v[148:151], v[48:63]
    v_mul_f32 v15, v35, v35
    v_fma_f32 v14, v14, s56, v8
    ds_read_b64_tr_b16 v[20:21], v1 offset:50176
    ds_read_b64_tr_b16 v[22:23], v1 offset:50432
    s_waitcnt lgkmcnt(6)
    v_mfma_f32_32x32x16_bf16 v[48:63], v[24:27], v[152:155], v[48:63]
    v_fma_f32 v15, v15, s56, v8
    v_mul_f32 v14, v14, v34
    ds_read_b64_tr_b16 v[24:25], v1 offset:51200
    ds_read_b64_tr_b16 v[26:27], v1 offset:51456
    s_waitcnt lgkmcnt(6)
    v_mfma_f32_32x32x16_bf16 v[48:63], v[28:31], v[156:159], v[48:63]
    v_mul_f32 v15, v15, v35
    v_exp_f32 v14, v14
    s_waitcnt vmcnt(15)
    s_barrier
    s_add_u32 m0, s40, 24576
    s_add_u32 s37, s33, 3538944
    buffer_load_dwordx4 v5, s[12:15], s37 offen lds
    s_add_u32 m0, s40, 28672
    s_add_u32 s37, s33, 4128768
    buffer_load_dwordx4 v5, s[12:15], s37 offen lds
    s_add_u32 m0, s40, 32768
    s_add_u32 s37, s33, 4718592
    buffer_load_dwordx4 v5, s[12:15], s37 offen lds
    ds_read_b64_tr_b16 v[28:29], v1 offset:52224
    ds_read_b64_tr_b16 v[30:31], v1 offset:52480
    s_waitcnt lgkmcnt(6)
    v_mfma_f32_32x32x16_bf16 v[48:63], v[16:19], v[160:163], v[48:63]
    v_exp_f32 v15, v15
    v_add_f32 v14, 1.0, v14
    ds_read_b64_tr_b16 v[16:17], v1 offset:53248
    ds_read_b64_tr_b16 v[18:19], v1 offset:53504
    s_waitcnt lgkmcnt(6)
    v_mfma_f32_32x32x16_bf16 v[48:63], v[20:23], v[164:167], v[48:63]
    v_add_f32 v15, 1.0, v15
    v_rcp_f32 v14, v14
    ds_read_b64_tr_b16 v[20:21], v1 offset:54272
    ds_read_b64_tr_b16 v[22:23], v1 offset:54528
    s_waitcnt lgkmcnt(6)
    v_mfma_f32_32x32x16_bf16 v[48:63], v[24:27], v[168:171], v[48:63]
    v_rcp_f32 v15, v15
    v_mul_f32 v14, v14, v34
    ds_read_b64_tr_b16 v[24:25], v1 offset:55296
    ds_read_b64_tr_b16 v[26:27], v1 offset:55552
    s_waitcnt lgkmcnt(6)
    v_mfma_f32_32x32x16_bf16 v[48:63], v[28:31], v[172:175], v[48:63]
    v_mul_f32 v15, v15, v35
    v_cvt_pk_bf16_f32 v65, v14, v15
    ds_read_b64_tr_b16 v[28:29], v1 offset:56320
    ds_read_b64_tr_b16 v[30:31], v1 offset:56576
    s_waitcnt lgkmcnt(6)
    v_mfma_f32_32x32x16_bf16 v[48:63], v[16:19], v[176:179], v[48:63]
    v_mul_f32 v12, v36, v36
    v_mul_f32 v13, v37, v37
    ds_read_b64_tr_b16 v[16:17], v1 offset:57344
    ds_read_b64_tr_b16 v[18:19], v1 offset:57600
    s_waitcnt lgkmcnt(6)
    v_mfma_f32_32x32x16_bf16 v[48:63], v[20:23], v[180:183], v[48:63]
    v_fma_f32 v12, v12, s56, v8
    v_fma_f32 v13, v13, s56, v8
    ds_read_b64_tr_b16 v[20:21], v1 offset:58368
    ds_read_b64_tr_b16 v[22:23], v1 offset:58624
    s_waitcnt lgkmcnt(6)
    v_mfma_f32_32x32x16_bf16 v[48:63], v[24:27], v[184:187], v[48:63]
    v_mul_f32 v12, v12, v36
    v_mul_f32 v13, v13, v37
    ds_read_b64_tr_b16 v[24:25], v1 offset:59392
    ds_read_b64_tr_b16 v[26:27], v1 offset:59648
    s_waitcnt lgkmcnt(6)
    v_mfma_f32_32x32x16_bf16 v[48:63], v[28:31], v[188:191], v[48:63]
    v_exp_f32 v12, v12
    v_exp_f32 v13, v13
    ds_read_b64_tr_b16 v[28:29], v1 offset:60416
    ds_read_b64_tr_b16 v[30:31], v1 offset:60672
    s_waitcnt lgkmcnt(6)
    v_mfma_f32_32x32x16_bf16 v[48:63], v[16:19], v[192:195], v[48:63]
    v_add_f32 v12, 1.0, v12
    v_add_f32 v13, 1.0, v13
    ds_read_b64_tr_b16 v[16:17], v1 offset:61440
    ds_read_b64_tr_b16 v[18:19], v1 offset:61696
    s_waitcnt lgkmcnt(6)
    v_mfma_f32_32x32x16_bf16 v[48:63], v[20:23], v[196:199], v[48:63]
    v_rcp_f32 v12, v12
    v_rcp_f32 v13, v13
    ds_read_b64_tr_b16 v[20:21], v1 offset:62464
    ds_read_b64_tr_b16 v[22:23], v1 offset:62720
    s_waitcnt lgkmcnt(6)
    v_mfma_f32_32x32x16_bf16 v[48:63], v[24:27], v[200:203], v[48:63]
    v_mul_f32 v12, v12, v36
    v_mul_f32 v13, v13, v37
    ds_read_b64_tr_b16 v[24:25], v1 offset:63488
    ds_read_b64_tr_b16 v[26:27], v1 offset:63744
    s_waitcnt lgkmcnt(6)
    v_mfma_f32_32x32x16_bf16 v[48:63], v[28:31], v[204:207], v[48:63]
    v_cvt_pk_bf16_f32 v66, v12, v13
    v_mul_f32 v14, v38, v38
    s_waitcnt vmcnt(15)
    s_barrier
    s_add_u32 m0, s40, 36864
    s_nop 0
    buffer_load_dwordx4 v5, s[16:19], s33 offen lds
    s_add_u32 m0, s40, 40960
    s_add_u32 s37, s33, 589824
    buffer_load_dwordx4 v5, s[16:19], s37 offen lds
    s_add_u32 m0, s40, 45056
    s_add_u32 s37, s33, 1179648
    buffer_load_dwordx4 v5, s[16:19], s37 offen lds
    ds_read_b64_tr_b16 v[28:29], v1 offset:64512
    ds_read_b64_tr_b16 v[30:31], v1 offset:64768
    s_waitcnt lgkmcnt(6)
    v_mfma_f32_32x32x16_bf16 v[48:63], v[16:19], v[208:211], v[48:63]
    v_mul_f32 v15, v39, v39
    v_fma_f32 v14, v14, s56, v8
    ds_read_b64_tr_b16 v[16:17], v2 offset:0
    ds_read_b64_tr_b16 v[18:19], v2 offset:256
    s_waitcnt lgkmcnt(6)
    v_mfma_f32_32x32x16_bf16 v[48:63], v[20:23], v[212:215], v[48:63]
    v_fma_f32 v15, v15, s56, v8
    v_mul_f32 v14, v14, v38
    ds_read_b64_tr_b16 v[20:21], v2 offset:1024
    ds_read_b64_tr_b16 v[22:23], v2 offset:1280
    s_waitcnt lgkmcnt(6)
    v_mfma_f32_32x32x16_bf16 v[48:63], v[24:27], v[216:219], v[48:63]
    v_mul_f32 v15, v15, v39
    v_exp_f32 v14, v14
    ds_read_b64_tr_b16 v[24:25], v2 offset:2048
    ds_read_b64_tr_b16 v[26:27], v2 offset:2304
    s_waitcnt lgkmcnt(6)
    v_mfma_f32_32x32x16_bf16 v[48:63], v[28:31], v[220:223], v[48:63]
    v_exp_f32 v15, v15
    v_add_f32 v14, 1.0, v14
    ds_read_b64_tr_b16 v[28:29], v2 offset:3072
    ds_read_b64_tr_b16 v[30:31], v2 offset:3328
    s_waitcnt lgkmcnt(6)
    v_mfma_f32_32x32x16_bf16 v[48:63], v[16:19], v[224:227], v[48:63]
    v_add_f32 v15, 1.0, v15
    v_rcp_f32 v14, v14
    ds_read_b64_tr_b16 v[16:17], v2 offset:4096
    ds_read_b64_tr_b16 v[18:19], v2 offset:4352
    s_waitcnt lgkmcnt(6)
    v_mfma_f32_32x32x16_bf16 v[48:63], v[20:23], v[228:231], v[48:63]
    v_rcp_f32 v15, v15
    v_mul_f32 v14, v14, v38
    ds_read_b64_tr_b16 v[20:21], v2 offset:5120
    ds_read_b64_tr_b16 v[22:23], v2 offset:5376
    s_waitcnt lgkmcnt(6)
    v_mfma_f32_32x32x16_bf16 v[48:63], v[24:27], v[232:235], v[48:63]
    v_mul_f32 v15, v15, v39
    v_cvt_pk_bf16_f32 v67, v14, v15
    ds_read_b64_tr_b16 v[24:25], v2 offset:6144
    ds_read_b64_tr_b16 v[26:27], v2 offset:6400
    s_waitcnt lgkmcnt(6)
    v_mfma_f32_32x32x16_bf16 v[48:63], v[28:31], v[236:239], v[48:63]
    ds_read_b64_tr_b16 v[28:29], v2 offset:7168
    ds_read_b64_tr_b16 v[30:31], v2 offset:7424
    s_waitcnt lgkmcnt(6)
    v_mfma_f32_32x32x16_bf16 v[48:63], v[16:19], v[240:243], v[48:63]
    ds_read_b64_tr_b16 v[16:17], v2 offset:8192
    ds_read_b64_tr_b16 v[18:19], v2 offset:8448
    s_waitcnt lgkmcnt(6)
    v_mfma_f32_32x32x16_bf16 v[48:63], v[20:23], v[244:247], v[48:63]
    ds_read_b64_tr_b16 v[20:21], v2 offset:9216
    ds_read_b64_tr_b16 v[22:23], v2 offset:9472
    s_waitcnt lgkmcnt(6)
    v_mfma_f32_32x32x16_bf16 v[48:63], v[24:27], v[248:251], v[48:63]
    ds_read_b64_tr_b16 v[24:25], v2 offset:10240
    ds_read_b64_tr_b16 v[26:27], v2 offset:10496
    s_waitcnt lgkmcnt(6)
    v_mfma_f32_32x32x16_bf16 v[48:63], v[28:31], v[252:255], v[48:63]
    s_branch Lffn_e_1024
Lffn_l_1023:
    s_waitcnt vmcnt(15)
    s_barrier
    s_add_u32 m0, s40, 12288
    s_add_u32 s37, s33, 1769472
    buffer_load_dwordx4 v5, s[12:15], s37 offen lds
    s_add_u32 m0, s40, 16384
    s_add_u32 s37, s33, 2359296
    buffer_load_dwordx4 v5, s[12:15], s37 offen lds
    s_add_u32 m0, s40, 20480
    s_add_u32 s37, s33, 2949120
    buffer_load_dwordx4 v5, s[12:15], s37 offen lds
    s_waitcnt vmcnt(15)
    s_barrier
    s_add_u32 m0, s40, 24576
    s_add_u32 s37, s33, 3538944
    buffer_load_dwordx4 v5, s[12:15], s37 offen lds
    s_add_u32 m0, s40, 28672
    s_add_u32 s37, s33, 4128768
    buffer_load_dwordx4 v5, s[12:15], s37 offen lds
    s_add_u32 m0, s40, 32768
    s_add_u32 s37, s33, 4718592
    buffer_load_dwordx4 v5, s[12:15], s37 offen lds
    s_waitcnt vmcnt(15)
    s_barrier
    s_add_u32 m0, s40, 36864
    s_nop 0
    buffer_load_dwordx4 v5, s[16:19], s33 offen lds
    s_add_u32 m0, s40, 40960
    s_add_u32 s37, s33, 589824
    buffer_load_dwordx4 v5, s[16:19], s37 offen lds
    s_add_u32 m0, s40, 45056
    s_add_u32 s37, s33, 1179648
    buffer_load_dwordx4 v5, s[16:19], s37 offen lds
    s_waitcnt lgkmcnt(0)
    ds_read_b64_tr_b16 v[16:17], v2 offset:8192
    ds_read_b64_tr_b16 v[18:19], v2 offset:8448
    ds_read_b64_tr_b16 v[20:21], v2 offset:9216
    ds_read_b64_tr_b16 v[22:23], v2 offset:9472
    ds_read_b64_tr_b16 v[24:25], v2 offset:10240
    ds_read_b64_tr_b16 v[26:27], v2 offset:10496
Lffn_e_1024:
    s_cmp_gt_u32 s34, s57
    s_cbranch_scc0 Lffn_l_1025
    s_waitcnt vmcnt(15)
    s_barrier
    s_add_u32 m0, s40, 49152
    s_add_u32 s37, s33, 1769472
    buffer_load_dwordx4 v5, s[16:19], s37 offen lds
    s_add_u32 m0, s40, 53248
    s_add_u32 s37, s33, 2359296
    buffer_load_dwordx4 v5, s[16:19], s37 offen lds
    s_add_u32 m0, s40, 57344
    s_add_u32 s37, s33, 2949120
    buffer_load_dwordx4 v5, s[16:19], s37 offen lds
    ds_read_b64_tr_b16 v[28:29], v2 offset:11264
    ds_read_b64_tr_b16 v[30:31], v2 offset:11520
    s_waitcnt lgkmcnt(6)
    v_mfma_f32_32x32x16_bf16 a[0:15], v[16:19], v[72:75], a[0:15]
    ds_read_b64_tr_b16 v[16:17], v2 offset:12288
    ds_read_b64_tr_b16 v[18:19], v2 offset:12544
    s_waitcnt lgkmcnt(6)
    v_mfma_f32_32x32x16_bf16 a[0:15], v[20:23], v[76:79], a[0:15]
    v_mul_f32 v12, v40, v40
    v_mul_f32 v13, v41, v41
    ds_read_b64_tr_b16 v[20:21], v2 offset:13312
    ds_read_b64_tr_b16 v[22:23], v2 offset:13568
    s_waitcnt lgkmcnt(6)
    v_mfma_f32_32x32x16_bf16 a[16:31], v[24:27], v[72:75], a[16:31]
    v_fma_f32 v12, v12, s56, v8
    v_fma_f32 v13, v13, s56, v8
    ds_read_b64_tr_b16 v[24:25], v2 offset:14336
    ds_read_b64_tr_b16 v[26:27], v2 offset:14592
    s_waitcnt lgkmcnt(6)
    v_mfma_f32_32x32x16_bf16 a[16:31], v[28:31], v[76:79], a[16:31]
    v_mul_f32 v12, v12, v40
    v_mul_f32 v13, v13, v41
    ds_read_b64_tr_b16 v[28:29], v2 offset:15360
    ds_read_b64_tr_b16 v[30:31], v2 offset:15616
    s_waitcnt lgkmcnt(6)
    v_mfma_f32_32x32x16_bf16 a[32:47], v[16:19], v[72:75], a[32:47]
    v_exp_f32 v12, v12
    v_exp_f32 v13, v13
    ds_read_b64_tr_b16 v[16:17], v2 offset:16384
    ds_read_b64_tr_b16 v[18:19], v2 offset:16640
    s_waitcnt lgkmcnt(6)
    v_mfma_f32_32x32x16_bf16 a[32:47], v[20:23], v[76:79], a[32:47]
    v_add_f32 v12, 1.0, v12
    v_add_f32 v13, 1.0, v13
    ds_read_b64_tr_b16 v[20:21], v2 offset:17408
    ds_read_b64_tr_b16 v[22:23], v2 offset:17664
    s_waitcnt lgkmcnt(6)
    v_mfma_f32_32x32x16_bf16 a[48:63], v[24:27], v[72:75], a[48:63]
    v_rcp_f32 v12, v12
    v_rcp_f32 v13, v13
    ds_read_b64_tr_b16 v[24:25], v2 offset:18432
    ds_read_b64_tr_b16 v[26:27], v2 offset:18688
    s_waitcnt lgkmcnt(6)
    v_mfma_f32_32x32x16_bf16 a[48:63], v[28:31], v[76:79], a[48:63]
    v_mul_f32 v12, v12, v40
    v_mul_f32 v13, v13, v41
    ds_read_b64_tr_b16 v[28:29], v2 offset:19456
    ds_read_b64_tr_b16 v[30:31], v2 offset:19712
    s_waitcnt lgkmcnt(6)
    v_mfma_f32_32x32x16_bf16 a[64:79], v[16:19], v[72:75], a[64:79]
    v_cvt_pk_bf16_f32 v68, v12, v13
    v_mul_f32 v14, v42, v42
    ds_read_b64_tr_b16 v[16:17], v2 offset:20480
    ds_read_b64_tr_b16 v[18:19], v2 offset:20736
    s_waitcnt lgkmcnt(6)
    v_mfma_f32_32x32x16_bf16 a[64:79], v[20:23], v[76:79], a[64:79]
    v_mul_f32 v15, v43, v43
    v_fma_f32 v14, v14, s56, v8
    ds_read_b64_tr_b16 v[20:21], v2 offset:21504
    ds_read_b64_tr_b16 v[22:23], v2 offset:21760
    s_waitcnt lgkmcnt(6)
    v_mfma_f32_32x32x16_bf16 a[80:95], v[24:27], v[72:75], a[80:95]
    v_fma_f32 v15, v15, s56, v8
    v_mul_f32 v14, v14, v42
    ds_read_b64_tr_b16 v[24:25], v2 offset:22528
    ds_read_b64_tr_b16 v[26:27], v2 offset:22784
    s_waitcnt lgkmcnt(6)
    v_mfma_f32_32x32x16_bf16 a[80:95], v[28:31], v[76:79], a[80:95]
    v_mul_f32 v15, v15, v43
    v_exp_f32 v14, v14
    s_waitcnt vmcnt(15)
    s_barrier
    s_add_u32 m0, s40, 61440
    s_add_u32 s37, s33, 3538944
    buffer_load_dwordx4 v5, s[16:19], s37 offen lds
    s_add_u32 m0, s40, 65536
    s_add_u32 s37, s33, 4128768
    buffer_load_dwordx4 v5, s[16:19], s37 offen lds
    s_add_u32 m0, s40, 69632
    s_add_u32 s37, s33, 4718592
    buffer_load_dwordx4 v5, s[16:19], s37 offen lds
    ds_read_b64_tr_b16 v[28:29], v2 offset:23552
    ds_read_b64_tr_b16 v[30:31], v2 offset:23808
    s_waitcnt lgkmcnt(6)
    v_mfma_f32_32x32x16_bf16 a[96:111], v[16:19], v[72:75], a[96:111]
    v_exp_f32 v15, v15
    v_add_f32 v14, 1.0, v14
    ds_read_b64_tr_b16 v[16:17], v2 offset:24576
    ds_read_b64_tr_b16 v[18:19], v2 offset:24832
    s_waitcnt lgkmcnt(6)
    v_mfma_f32_32x32x16_bf16 a[96:111], v[20:23], v[76:79], a[96:111]
    v_add_f32 v15, 1.0, v15
    v_rcp_f32 v14, v14
    ds_read_b64_tr_b16 v[20:21], v2 offset:25600
    ds_read_b64_tr_b16 v[22:23], v2 offset:25856
    s_waitcnt lgkmcnt(6)
    v_mfma_f32_32x32x16_bf16 a[112:127], v[24:27], v[72:75], a[112:127]
    v_rcp_f32 v15, v15
    v_mul_f32 v14, v14, v42
    ds_read_b64_tr_b16 v[24:25], v2 offset:26624
    ds_read_b64_tr_b16 v[26:27], v2 offset:26880
    s_waitcnt lgkmcnt(6)
    v_mfma_f32_32x32x16_bf16 a[112:127], v[28:31], v[76:79], a[112:127]
    v_mul_f32 v15, v15, v43
    v_cvt_pk_bf16_f32 v69, v14, v15
    ds_read_b64_tr_b16 v[28:29], v2 offset:27648
    ds_read_b64_tr_b16 v[30:31], v2 offset:27904
    s_waitcnt lgkmcnt(6)
    v_mfma_f32_32x32x16_bf16 a[128:143], v[16:19], v[72:75], a[128:143]
    v_mul_f32 v12, v44, v44
    v_mul_f32 v13, v45, v45
    ds_read_b64_tr_b16 v[16:17], v2 offset:28672
    ds_read_b64_tr_b16 v[18:19], v2 offset:28928
    s_waitcnt lgkmcnt(6)
    v_mfma_f32_32x32x16_bf16 a[128:143], v[20:23], v[76:79], a[128:143]
    v_fma_f32 v12, v12, s56, v8
    v_fma_f32 v13, v13, s56, v8
    ds_read_b64_tr_b16 v[20:21], v2 offset:29696
    ds_read_b64_tr_b16 v[22:23], v2 offset:29952
    s_waitcnt lgkmcnt(6)
    v_mfma_f32_32x32x16_bf16 a[144:159], v[24:27], v[72:75], a[144:159]
    v_mul_f32 v12, v12, v44
    v_mul_f32 v13, v13, v45
    ds_read_b64_tr_b16 v[24:25], v2 offset:30720
    ds_read_b64_tr_b16 v[26:27], v2 offset:30976
    s_waitcnt lgkmcnt(6)
    v_mfma_f32_32x32x16_bf16 a[144:159], v[28:31], v[76:79], a[144:159]
    v_exp_f32 v12, v12
    v_exp_f32 v13, v13
    ds_read_b64_tr_b16 v[28:29], v2 offset:31744
    ds_read_b64_tr_b16 v[30:31], v2 offset:32000
    s_waitcnt lgkmcnt(6)
    v_mfma_f32_32x32x16_bf16 a[160:175], v[16:19], v[72:75], a[160:175]
    v_add_f32 v12, 1.0, v12
    v_add_f32 v13, 1.0, v13
    ds_read_b64_tr_b16 v[16:17], v2 offset:32768
    ds_read_b64_tr_b16 v[18:19], v2 offset:33024
    s_waitcnt lgkmcnt(6)
    v_mfma_f32_32x32x16_bf16 a[160:175], v[20:23], v[76:79], a[160:175]
    v_rcp_f32 v12, v12
    v_rcp_f32 v13, v13
    ds_read_b64_tr_b16 v[20:21], v2 offset:33792
    ds_read_b64_tr_b16 v[22:23], v2 offset:34048
    s_waitcnt lgkmcnt(6)
    v_mfma_f32_32x32x16_bf16 a[176:191], v[24:27], v[72:75], a[176:191]
    v_mul_f32 v12, v12, v44
    v_mul_f32 v13, v13, v45
    ds_read_b64_tr_b16 v[24:25], v2 offset:34816
    ds_read_b64_tr_b16 v[26:27], v2 offset:35072
    s_waitcnt lgkmcnt(6)
    v_mfma_f32_32x32x16_bf16 a[176:191], v[28:31], v[76:79], a[176:191]
    v_cvt_pk_bf16_f32 v70, v12, v13
    v_mul_f32 v14, v46, v46
    s_waitcnt vmcnt(15)
    s_barrier
    s_add_u32 m0, s40, 73728
    s_nop 0
    buffer_load_dwordx4 v6, s[20:23], s43 offen lds
    s_add_u32 m0, s40, 77824
    s_add_u32 s37, s43, 128
    buffer_load_dwordx4 v6, s[20:23], s37 offen lds
    s_add_u32 m0, s40, 81920
    s_add_u32 s37, s43, 256
    buffer_load_dwordx4 v6, s[20:23], s37 offen lds
    ds_read_b64_tr_b16 v[28:29], v2 offset:35840
    ds_read_b64_tr_b16 v[30:31], v2 offset:36096
    s_waitcnt lgkmcnt(6)
    v_mfma_f32_32x32x16_bf16 a[192:207], v[16:19], v[72:75], a[192:207]
    v_mul_f32 v15, v47, v47
    v_fma_f32 v14, v14, s56, v8
    ds_read_b64_tr_b16 v[16:17], v2 offset:36864
    ds_read_b64_tr_b16 v[18:19], v2 offset:37120
    s_waitcnt lgkmcnt(6)
    v_mfma_f32_32x32x16_bf16 a[192:207], v[20:23], v[76:79], a[192:207]
    v_fma_f32 v15, v15, s56, v8
    v_mul_f32 v14, v14, v46
    ds_read_b64_tr_b16 v[20:21], v2 offset:37888
    ds_read_b64_tr_b16 v[22:23], v2 offset:38144
    s_waitcnt lgkmcnt(6)
    v_mfma_f32_32x32x16_bf16 a[208:223], v[24:27], v[72:75], a[208:223]
    v_mul_f32 v15, v15, v47
    v_exp_f32 v14, v14
    ds_read_b64_tr_b16 v[24:25], v2 offset:38912
    ds_read_b64_tr_b16 v[26:27], v2 offset:39168
    s_waitcnt lgkmcnt(6)
    v_mfma_f32_32x32x16_bf16 a[208:223], v[28:31], v[76:79], a[208:223]
    v_exp_f32 v15, v15
    v_add_f32 v14, 1.0, v14
    ds_read_b64_tr_b16 v[28:29], v2 offset:39936
    ds_read_b64_tr_b16 v[30:31], v2 offset:40192
    s_waitcnt lgkmcnt(6)
    v_mfma_f32_32x32x16_bf16 a[224:239], v[16:19], v[72:75], a[224:239]
    v_add_f32 v15, 1.0, v15
    v_rcp_f32 v14, v14
    ds_read_b64_tr_b16 v[16:17], v2 offset:40960
    ds_read_b64_tr_b16 v[18:19], v2 offset:41216
    s_waitcnt lgkmcnt(6)
    v_mfma_f32_32x32x16_bf16 a[224:239], v[20:23], v[76:79], a[224:239]
    v_rcp_f32 v15, v15
    v_mul_f32 v14, v14, v46
    ds_read_b64_tr_b16 v[20:21], v2 offset:41984
    ds_read_b64_tr_b16 v[22:23], v2 offset:42240
    s_waitcnt lgkmcnt(6)
    v_mfma_f32_32x32x16_bf16 a[240:255], v[24:27], v[72:75], a[240:255]
    v_mul_f32 v15, v15, v47
    v_cvt_pk_bf16_f32 v71, v14, v15
    ds_read_b64_tr_b16 v[24:25], v2 offset:43008
    ds_read_b64_tr_b16 v[26:27], v2 offset:43264
    s_waitcnt lgkmcnt(6)
    v_mfma_f32_32x32x16_bf16 a[240:255], v[28:31], v[76:79], a[240:255]
    ds_read_b64_tr_b16 v[28:29], v2 offset:44032
    ds_read_b64_tr_b16 v[30:31], v2 offset:44288
    s_waitcnt lgkmcnt(6)
    v_mfma_f32_32x32x16_bf16 v[80:95], v[16:19], v[72:75], v[80:95]
    ds_read_b64_tr_b16 v[16:17], v1 offset:0
    ds_read_b64_tr_b16 v[18:19], v1 offset:256
    s_waitcnt lgkmcnt(6)
    v_mfma_f32_32x32x16_bf16 v[80:95], v[20:23], v[76:79], v[80:95]
    ds_read_b64_tr_b16 v[20:21], v1 offset:1024
    ds_read_b64_tr_b16 v[22:23], v1 offset:1280
    s_waitcnt lgkmcnt(6)
    v_mfma_f32_32x32x16_bf16 v[96:111], v[24:27], v[72:75], v[96:111]
    ds_read_b64_tr_b16 v[24:25], v1 offset:2048
    ds_read_b64_tr_b16 v[26:27], v1 offset:2304
    s_waitcnt lgkmcnt(6)
    v_mfma_f32_32x32x16_bf16 v[96:111], v[28:31], v[76:79], v[96:111]
    s_branch Lffn_e_1026
Lffn_l_1025:
    s_waitcnt vmcnt(15)
    s_barrier
    s_add_u32 m0, s40, 49152
    s_add_u32 s37, s33, 1769472
    buffer_load_dwordx4 v5, s[16:19], s37 offen lds
    s_add_u32 m0, s40, 53248
    s_add_u32 s37, s33, 2359296
    buffer_load_dwordx4 v5, s[16:19], s37 offen lds
    s_add_u32 m0, s40, 57344
    s_add_u32 s37, s33, 2949120
    buffer_load_dwordx4 v5, s[16:19], s37 offen lds
    s_waitcnt vmcnt(15)
    s_barrier
    s_add_u32 m0, s40, 61440
    s_add_u32 s37, s33, 3538944
    buffer_load_dwordx4 v5, s[16:19], s37 offen lds
    s_add_u32 m0, s40, 65536
    s_add_u32 s37, s33, 4128768
    buffer_load_dwordx4 v5, s[16:19], s37 offen lds
    s_add_u32 m0, s40, 69632
    s_add_u32 s37, s33, 4718592
    buffer_load_dwordx4 v5, s[16:19], s37 offen lds
    s_waitcnt vmcnt(15)
    s_barrier
    s_add_u32 m0, s40, 73728
    s_nop 0
    buffer_load_dwordx4 v6, s[20:23], s43 offen lds
    s_add_u32 m0, s40, 77824
    s_add_u32 s37, s43, 128
    buffer_load_dwordx4 v6, s[20:23], s37 offen lds
    s_add_u32 m0, s40, 81920
    s_add_u32 s37, s43, 256
    buffer_load_dwordx4 v6, s[20:23], s37 offen lds
    s_waitcnt lgkmcnt(0)
    v_mul_f32 v12, v40, v40
    v_mul_f32 v13, v41, v41
    v_fma_f32 v12, v12, s56, v8
    v_fma_f32 v13, v13, s56, v8
    v_mul_f32 v12, v12, v40
    v_mul_f32 v13, v13, v41
    v_exp_f32 v12, v12
    v_exp_f32 v13, v13
    v_add_f32 v12, 1.0, v12
    v_add_f32 v13, 1.0, v13
    v_rcp_f32 v12, v12
    v_rcp_f32 v13, v13
    v_mul_f32 v12, v12, v40
    v_mul_f32 v13, v13, v41
    v_cvt_pk_bf16_f32 v68, v12, v13
    v_mul_f32 v14, v42, v42
    v_mul_f32 v15, v43, v43
    v_fma_f32 v14, v14, s56, v8
    v_fma_f32 v15, v15, s56, v8
    v_mul_f32 v14, v14, v42
    v_mul_f32 v15, v15, v43
    v_exp_f32 v14, v14
    v_exp_f32 v15, v15
    v_add_f32 v14, 1.0, v14
    v_add_f32 v15, 1.0, v15
    v_rcp_f32 v14, v14
    v_rcp_f32 v15, v15
    v_mul_f32 v14, v14, v42
    v_mul_f32 v15, v15, v43
    v_cvt_pk_bf16_f32 v69, v14, v15
    v_mul_f32 v12, v44, v44
    v_mul_f32 v13, v45, v45
    v_fma_f32 v12, v12, s56, v8
    v_fma_f32 v13, v13, s56, v8
    v_mul_f32 v12, v12, v44
    v_mul_f32 v13, v13, v45
    v_exp_f32 v12, v12
    v_exp_f32 v13, v13
    v_add_f32 v12, 1.0, v12
    v_add_f32 v13, 1.0, v13
    v_rcp_f32 v12, v12
    v_rcp_f32 v13, v13
    v_mul_f32 v12, v12, v44
    v_mul_f32 v13, v13, v45
    v_cvt_pk_bf16_f32 v70, v12, v13
    v_mul_f32 v14, v46, v46
    v_mul_f32 v15, v47, v47
    v_fma_f32 v14, v14, s56, v8
    v_fma_f32 v15, v15, s56, v8
    v_mul_f32 v14, v14, v46
    v_mul_f32 v15, v15, v47
    v_exp_f32 v14, v14
    v_exp_f32 v15, v15
    v_add_f32 v14, 1.0, v14
    v_add_f32 v15, 1.0, v15
    v_rcp_f32 v14, v14
    v_rcp_f32 v15, v15
    v_mul_f32 v14, v14, v46
    v_mul_f32 v15, v15, v47
    v_cvt_pk_bf16_f32 v71, v14, v15
    ds_read_b64_tr_b16 v[16:17], v1 offset:0
    ds_read_b64_tr_b16 v[18:19], v1 offset:256
    ds_read_b64_tr_b16 v[20:21], v1 offset:1024
    ds_read_b64_tr_b16 v[22:23], v1 offset:1280
    ds_read_b64_tr_b16 v[24:25], v1 offset:2048
    ds_read_b64_tr_b16 v[26:27], v1 offset:2304
Lffn_e_1026:
    s_add_u32 s34, s34, 1
    s_lshl_b32 s32, s34, 6
    s_cmp_lt_u32 s34, s36
    s_cselect_b32 s32, s32, 2130706432
    s_add_u32 s37, s34, 1
    s_lshl_b32 s33, s37, 6
    s_cmp_lt_u32 s37, s36
    s_cselect_b32 s33, s33, 2130706432
    s_mul_i32 s43, s34, 36864
    s_sub_u32 s42, s43, 36864
    s_cmp_lt_u32 s34, s36
    s_cselect_b32 s43, s43, 2130706432
    s_cmp_gt_u32 s34, s57
    s_cselect_b32 s42, s42, 2130706432
    s_cmp_le_u32 s34, s36
    s_cbranch_scc1 Lffn_1020
    s_waitcnt vmcnt(0) lgkmcnt(0)
    s_barrier
    s_load_dwordx2 s[24:25], s[0:1], 40
    s_load_dwordx2 s[26:27], s[0:1], 0
    s_load_dwordx2 s[28:29], s[0:1], 88
    s_mov_b32 s56, 0x3e0293ee
    v_and_b32 v12, 31, v0
    v_lshrrev_b32 v13, 5, v0
    v_lshlrev_b32 v14, 2, v13
    v_sub_u32 v14, v12, v14
    v_cmp_ge_i32 s[64:65], v14, 0
    v_cmp_ge_i32 s[66:67], v14, 1
    v_cmp_ge_i32 s[68:69], v14, 2
    v_cmp_ge_i32 s[70:71], v14, 3
    v_cmp_ge_i32 s[72:73], v14, 8
    v_cmp_ge_i32 s[74:75], v14, 9
    v_cmp_ge_i32 s[76:77], v14, 10
    v_cmp_ge_i32 s[78:79], v14, 11
    v_cmp_ge_i32 s[80:81], v14, 16
    v_cmp_ge_i32 s[82:83], v14, 17
    v_cmp_ge_i32 s[84:85], v14, 18
    v_cmp_ge_i32 s[86:87], v14, 19
    v_cmp_ge_i32 s[88:89], v14, 24
    v_cmp_ge_i32 s[90:91], v14, 25
    v_cmp_ge_i32 s[92:93], v14, 26
    v_cmp_ge_i32 s[94:95], v14, 27
    v_and_b32 v10, 7, v0
    v_lshlrev_b32 v10, 5, v10
    v_lshl_add_u32 v10, v13, 4, v10
    v_lshlrev_b32 v11, 4, v12
    v_lshl_add_u32 v11, v13, 3, v11
    v_mul_u32_u24 v8, 1152, v12
    v_lshl_add_u32 v8, v13, 3, v8
    s_getpc_b64 s[62:63]
    s_add_u32 s62, s62, queue_table@rel32@lo+4
    s_addc_u32 s63, s63, queue_table@rel32@hi+12
    s_waitcnt lgkmcnt(0)
    s_mov_b32 s12, s24
    s_mov_b32 s13, s25
    s_mov_b32 s14, 4718592
    s_mov_b32 s15, 0x20000
    s_mov_b32 s16, s26
    s_mov_b32 s17, s27
    s_mov_b32 s18, 2359296
    s_mov_b32 s19, 0x20000
    s_mov_b32 s20, s28
    s_mov_b32 s21, s29
    s_mov_b32 s22, 2359296
    s_mov_b32 s23, 0x20000
    s_lshl_b32 s7, s5, 4
    s_add_u32 s7, s7, s3
    s_and_b32 s7, s7, 31
    s_lshl_b32 s7, s7, 7
    s_add_u32 s7, s7, 60817408
    v_mov_b32 v12, 0
    s_mov_b32 s44, 0
Lhs_1028:
    global_load_dword v14, v12, s[30:31] offset:44 sc1
    s_add_u32 s44, s44, 1
    s_cmp_gt_u32 s44, 0x40000
    s_cbranch_scc1 Lexit
    s_waitcnt vmcnt(0)
    v_readfirstlane_b32 s37, v14
    s_nop 0
    s_lshr_b32 s37, s37, 24
    s_cmp_ge_u32 s37, 32
    s_cbranch_scc1 Lhso_1029
    s_sleep 64
    s_branch Lhs_1028
Lhso_1029:
    s_mul_i32 s60, s3, 4128768
    s_sub_u32 s37, s3, 12
    s_max_i32 s37, s37, 0
    s_mul_i32 s37, s37, 4718592
    s_add_u32 s60, s60, s37
    s_sub_u32 s37, s3, 14
    s_max_i32 s37, s37, 0
    s_mul_i32 s37, s37, 4718592
    s_add_u32 s60, s60, s37
    s_add_u32 s60, s60, 67108864
    s_lshl_b32 s57, s3, 2
    s_add_u32 s57, s57, s4
    s_lshl_b32 s37, s57, 13
    v_and_b32 v12, 31, v0
    v_lshrrev_b32 v13, 5, v0
    v_lshlrev_b32 v7, 5, v12
    v_lshl_add_u32 v7, v13, 4, v7
    v_add_u32 v7, s37, v7
    s_cmp_ge_u32 s3, 12
    s_cbranch_scc1 Lnoown_1027
    s_mov_b32 s34, 0
    s_mul_i32 s32, s45, 147456
    s_mul_i32 s37, s34, 384
    s_add_u32 s32, s32, s37
    s_add_u32 s33, s32, 147456
    s_add_u32 s37, s45, 1
    s_cmp_lt_u32 s37, s47
    s_cselect_b32 s33, s33, 2130706432
    s_add_u32 m0, s40, 0
    s_nop 0
    buffer_load_dwordx4 v6, s[12:15], s32 offen lds
    s_add_u32 m0, s40, 4096
    s_add_u32 s37, s32, 128
    buffer_load_dwordx4 v6, s[12:15], s37 offen lds
    s_add_u32 m0, s40, 8192
    s_add_u32 s37, s32, 256
    buffer_load_dwordx4 v6, s[12:15], s37 offen lds
    s_add_u32 m0, s40, 12288
    s_add_u32 s37, s32, 384
    buffer_load_dwordx4 v6, s[12:15], s37 offen lds
    s_add_u32 m0, s40, 16384
    s_add_u32 s37, s32, 512
    buffer_load_dwordx4 v6, s[12:15], s37 offen lds
    s_add_u32 m0, s40, 20480
    s_add_u32 s37, s32, 640
    buffer_load_dwordx4 v6, s[12:15], s37 offen lds
    s_add_u32 m0, s40, 24576
    s_add_u32 s37, s32, 768
    buffer_load_dwordx4 v6, s[12:15], s37 offen lds
    s_add_u32 m0, s40, 28672
    s_add_u32 s37, s32, 896
    buffer_load_dwordx4 v6, s[12:15], s37 offen lds
    s_add_u32 m0, s40, 32768
    s_add_u32 s37, s32, 1024
    buffer_load_dwordx4 v6, s[12:15], s37 offen lds
    s_add_u32 m0, s40, 36864
    s_add_u32 s37, s32, 36864
    buffer_load_dwordx4 v6, s[12:15], s37 offen lds
    s_add_u32 m0, s40, 40960
    s_add_u32 s37, s32, 36992
    buffer_load_dwordx4 v6, s[12:15], s37 offen lds
    s_add_u32 m0, s40, 45056
    s_add_u32 s37, s32, 37120
    buffer_load_dwordx4 v6, s[12:15], s37 offen lds
    s_add_u32 m0, s40, 49152
    s_add_u32 s37, s32, 37248
    buffer_load_dwordx4 v6, s[12:15], s37 offen lds
    s_add_u32 m0, s40, 53248
    s_add_u32 s37, s32, 37376
    buffer_load_dwordx4 v6, s[12:15], s37 offen lds
    s_add_u32 m0, s40, 57344
    s_add_u32 s37, s32, 37504
    buffer_load_dwordx4 v6, s[12:15], s37 offen lds
    s_add_u32 m0, s40, 61440
    s_add_u32 s37, s32, 37632
    buffer_load_dwordx4 v6, s[12:15], s37 offen lds
    s_add_u32 m0, s40, 65536
    s_add_u32 s37, s32, 37760
    buffer_load_dwordx4 v6, s[12:15], s37 offen lds
    s_add_u32 m0, s40, 69632
    s_add_u32 s37, s32, 37888
    buffer_load_dwordx4 v6, s[12:15], s37 offen lds
    s_add_u32 m0, s40, 73728
    s_add_u32 s37, s32, 73728
    buffer_load_dwordx4 v6, s[12:15], s37 offen lds
    s_add_u32 m0, s40, 77824
    s_add_u32 s37, s32, 73856
    buffer_load_dwordx4 v6, s[12:15], s37 offen lds
    s_add_u32 m0, s40, 81920
    s_add_u32 s37, s32, 73984
    buffer_load_dwordx4 v6, s[12:15], s37 offen lds
    s_add_u32 m0, s40, 86016
    s_add_u32 s37, s32, 74112
    buffer_load_dwordx4 v6, s[12:15], s37 offen lds
    s_add_u32 m0, s40, 90112
    s_add_u32 s37, s32, 74240
    buffer_load_dwordx4 v6, s[12:15], s37 offen lds
    s_add_u32 m0, s40, 94208
    s_add_u32 s37, s32, 74368
    buffer_load_dwordx4 v6, s[12:15], s37 offen lds
    s_add_u32 m0, s40, 98304
    s_add_u32 s37, s32, 74496
    buffer_load_dwordx4 v6, s[12:15], s37 offen lds
    s_add_u32 m0, s40, 102400
    s_add_u32 s37, s32, 74624
    buffer_load_dwordx4 v6, s[12:15], s37 offen lds
    s_add_u32 m0, s40, 106496
    s_add_u32 s37, s32, 74752
    buffer_load_dwordx4 v6, s[12:15], s37 offen lds
    s_add_u32 m0, s40, 110592
    s_add_u32 s37, s32, 110592
    buffer_load_dwordx4 v6, s[12:15], s37 offen lds
    s_add_u32 m0, s40, 114688
    s_add_u32 s37, s32, 110720
    buffer_load_dwordx4 v6, s[12:15], s37 offen lds
    s_add_u32 m0, s40, 118784
    s_add_u32 s37, s32, 110848
    buffer_load_dwordx4 v6, s[12:15], s37 offen lds
    v_mov_b64 v[242:243], 0
    v_mov_b64 v[246:247], 0
    v_mov_b64 v[250:251], 0
    v_mov_b64 v[254:255], 0
    s_cmp_lg_u32 s4, 0
    s_cbranch_scc1 Lwh3_1032
    s_add_u32 s43, s57, 3
    s_lshl_b32 s37, s3, 2
    v_mov_b32 v12, s37
    s_mov_b32 s44, 0
Lwh1_1030:
    global_load_dword v14, v12, s[30:31] offset:128 sc1
    s_add_u32 s44, s44, 1
    s_cmp_gt_u32 s44, 0x40000
    s_cbranch_scc1 Lexit
    s_waitcnt vmcnt(0)
    v_readfirstlane_b32 s37, v14
    s_nop 0
    s_cmp_eq_u32 s37, 4194432
    s_cbranch_scc1 Lwh3_1032
    s_sleep 32
    s_branch Lwh1_1030
Lwh3_1032:
    s_barrier
    s_lshl_b32 s58, s45, 19
    s_add_u32 s59, s58, 16777216
    buffer_load_dwordx4 v[112:115], v7, s[8:11], s58 offen offset:0 sc1
    buffer_load_dwordx4 v[144:147], v7, s[8:11], s59 offen offset:0 sc1
    buffer_load_dwordx4 v[116:119], v7, s[8:11], s58 offen offset:1024 sc1
    buffer_load_dwordx4 v[148:151], v7, s[8:11], s59 offen offset:1024 sc1
    buffer_load_dwordx4 v[120:123], v7, s[8:11], s58 offen offset:2048 sc1
    buffer_load_dwordx4 v[152:155], v7, s[8:11], s59 offen offset:2048 sc1
    buffer_load_dwordx4 v[124:127], v7, s[8:11], s58 offen offset:3072 sc1
    buffer_load_dwordx4 v[156:159], v7, s[8:11], s59 offen offset:3072 sc1
    s_add_u32 s58, s58, 4096
    s_add_u32 s59, s59, 4096
    buffer_load_dwordx4 v[128:131], v7, s[8:11], s58 offen offset:0 sc1
    buffer_load_dwordx4 v[160:163], v7, s[8:11], s59 offen offset:0 sc1
    buffer_load_dwordx4 v[132:135], v7, s[8:11], s58 offen offset:1024 sc1
    buffer_load_dwordx4 v[164:167], v7, s[8:11], s59 offen offset:1024 sc1
    buffer_load_dwordx4 v[136:139], v7, s[8:11], s58 offen offset:2048 sc1
    buffer_load_dwordx4 v[168:171], v7, s[8:11], s59 offen offset:2048 sc1
    buffer_load_dwordx4 v[140:143], v7, s[8:11], s58 offen offset:3072 sc1
    buffer_load_dwordx4 v[172:175], v7, s[8:11], s59 offen offset:3072 sc1
    s_lshl_b32 s58, s45, 19
    s_add_u32 s58, s58, 33554432
    buffer_load_dwordx4 v[208:211], v7, s[8:11], s58 offen offset:0 sc1
    buffer_load_dwordx4 v[212:215], v7, s[8:11], s58 offen offset:1024 sc1
    buffer_load_dwordx4 v[216:219], v7, s[8:11], s58 offen offset:2048 sc1
    buffer_load_dwordx4 v[220:223], v7, s[8:11], s58 offen offset:3072 sc1
    s_add_u32 s58, s58, 4096
    buffer_load_dwordx4 v[224:227], v7, s[8:11], s58 offen offset:0 sc1
    buffer_load_dwordx4 v[228:231], v7, s[8:11], s58 offen offset:1024 sc1
    buffer_load_dwordx4 v[232:235], v7, s[8:11], s58 offen offset:2048 sc1
    buffer_load_dwordx4 v[236:239], v7, s[8:11], s58 offen offset:3072 sc1
    s_cmp_lg_u32 s4, 0
    s_cbranch_scc1 Lwh3_1035
    s_add_u32 s43, s57, 3
    v_mov_b32 v12, 0
    s_mov_b32 s44, 0
Lwh1_1033:
    buffer_load_ubyte v14, v12, s[8:11], s7 offen sc1
    s_add_u32 s44, s44, 1
    s_cmp_gt_u32 s44, 0x40000
    s_cbranch_scc1 Lexit
    s_waitcnt vmcnt(0)
    v_readfirstlane_b32 s37, v14
    s_nop 0
    s_cmp_gt_u32 s37, s43
    s_cbranch_scc1 Lwh3_1035
    s_add_u32 s37, s37, 2
    s_cmp_ge_u32 s37, s43
    s_cbranch_scc1 Lwh2_1034
    s_sleep 32
Lwh2_1034:
    s_sleep 2
    s_branch Lwh1_1033
Lwh3_1035:
    s_barrier
    s_lshl_b32 s58, s57, 5
    s_add_u32 s58, s58, s45
    s_lshl_b32 s58, s58, 11
    s_add_u32 s59, s58, 54525952
    s_add_u32 s58, s58, 50331648
    buffer_load_dwordx4 v[176:179], v10, s[8:11], s58 offen offset:0 sc1
    buffer_load_dwordx4 v[180:183], v10, s[8:11], s58 offen offset:256 sc1
    buffer_load_dwordx4 v[184:187], v10, s[8:11], s58 offen offset:512 sc1
    buffer_load_dwordx4 v[188:191], v10, s[8:11], s58 offen offset:768 sc1
    buffer_load_dwordx4 v[192:195], v10, s[8:11], s58 offen offset:1024 sc1
    buffer_load_dwordx4 v[196:199], v10, s[8:11], s58 offen offset:1280 sc1
    buffer_load_dwordx4 v[200:203], v10, s[8:11], s58 offen offset:1536 sc1
    buffer_load_dwordx4 v[204:207], v10, s[8:11], s58 offen offset:1792 sc1
    buffer_load_dwordx2 v[240:241], v11, s[8:11], s59 offen offset:0 sc1
    buffer_load_dwordx2 v[244:245], v11, s[8:11], s59 offen offset:512 sc1
    buffer_load_dwordx2 v[248:249], v11, s[8:11], s59 offen offset:1024 sc1
    buffer_load_dwordx2 v[252:253], v11, s[8:11], s59 offen offset:1536 sc1
Lattn_1036:
    s_waitcnt vmcnt(20)
    v_mfma_f32_32x32x16_bf16 v[32:47], v[144:147], v[112:115], 0
    v_mfma_f32_32x32x16_bf16 v[32:47], v[148:151], v[116:119], v[32:47]
    v_mfma_f32_32x32x16_bf16 v[32:47], v[152:155], v[120:123], v[32:47]
    v_mfma_f32_32x32x16_bf16 v[32:47], v[156:159], v[124:127], v[32:47]
    v_mfma_f32_32x32x16_bf16 v[32:47], v[160:163], v[128:131], v[32:47]
    v_mfma_f32_32x32x16_bf16 v[32:47], v[164:167], v[132:135], v[32:47]
    v_mfma_f32_32x32x16_bf16 v[32:47], v[168:171], v[136:139], v[32:47]
    v_mfma_f32_32x32x16_bf16 v[32:47], v[172:175], v[140:143], v[32:47]
    s_waitcnt vmcnt(11)
    v_mfma_f32_32x32x16_bf16 v[48:63], v[176:179], v[112:115], 0
    s_waitcnt vmcnt(10)
    v_mfma_f32_32x32x16_bf16 v[48:63], v[180:183], v[116:119], v[48:63]
    s_waitcnt vmcnt(9)
    v_mfma_f32_32x32x16_bf16 v[48:63], v[184:187], v[120:123], v[48:63]
    s_waitcnt vmcnt(8)
    v_mfma_f32_32x32x16_bf16 v[48:63], v[188:191], v[124:127], v[48:63]
    s_waitcnt vmcnt(7)
    v_mfma_f32_32x32x16_bf16 v[48:63], v[192:195], v[128:131], v[48:63]
    s_waitcnt vmcnt(6)
    v_mfma_f32_32x32x16_bf16 v[48:63], v[196:199], v[132:135], v[48:63]
    s_waitcnt vmcnt(5)
    v_mfma_f32_32x32x16_bf16 v[48:63], v[200:203], v[136:139], v[48:63]
    s_waitcnt vmcnt(4)
    v_mfma_f32_32x32x16_bf16 v[48:63], v[204:207], v[140:143], v[48:63]
    v_mov_b32 v12, 0xff800000
    v_cndmask_b32 v32, v12, v32, s[64:65]
    v_cndmask_b32 v33, v12, v33, s[66:67]
    v_cndmask_b32 v34, v12, v34, s[68:69]
    v_cndmask_b32 v35, v12, v35, s[70:71]
    v_cndmask_b32 v36, v12, v36, s[72:73]
    v_cndmask_b32 v37, v12, v37, s[74:75]
    v_cndmask_b32 v38, v12, v38, s[76:77]
    v_cndmask_b32 v39, v12, v39, s[78:79]
    v_cndmask_b32 v40, v12, v40, s[80:81]
    v_cndmask_b32 v41, v12, v41, s[82:83]
    v_cndmask_b32 v42, v12, v42, s[84:85]
    v_cndmask_b32 v43, v12, v43, s[86:87]
    v_cndmask_b32 v44, v12, v44, s[88:89]
    v_cndmask_b32 v45, v12, v45, s[90:91]
    v_cndmask_b32 v46, v12, v46, s[92:93]
    v_cndmask_b32 v47, v12, v47, s[94:95]
    v_max3_f32 v12, v32, v33, v34
    v_max3_f32 v12, v12, v35, v36
    v_max3_f32 v12, v12, v37, v38
    v_max3_f32 v12, v12, v39, v40
    v_max3_f32 v12, v12, v41, v42
    v_max3_f32 v12, v12, v43, v44
    v_max3_f32 v12, v12, v45, v46
    v_max_f32 v12, v12, v47
    v_max3_f32 v12, v12, v48, v49
    v_max3_f32 v12, v12, v50, v51
    v_mov_b32 v13, v12
    s_nop 1
    v_permlane32_swap_b32 v12, v13
    v_max_f32 v12, v12, v13
    v_mul_f32 v12, s56, v12
    v_fma_f32 v32, v32, s56, -v12
    v_fma_f32 v33, v33, s56, -v12
    v_fma_f32 v34, v34, s56, -v12
    v_fma_f32 v35, v35, s56, -v12
    v_fma_f32 v36, v36, s56, -v12
    v_fma_f32 v37, v37, s56, -v12
    v_fma_f32 v38, v38, s56, -v12
    v_fma_f32 v39, v39, s56, -v12
    v_fma_f32 v40, v40, s56, -v12
    v_fma_f32 v41, v41, s56, -v12
    v_fma_f32 v42, v42, s56, -v12
    v_fma_f32 v43, v43, s56, -v12
    v_fma_f32 v44, v44, s56, -v12
    v_fma_f32 v45, v45, s56, -v12
    v_fma_f32 v46, v46, s56, -v12
    v_fma_f32 v47, v47, s56, -v12
    v_fma_f32 v48, v48, s56, -v12
    v_fma_f32 v49, v49, s56, -v12
    v_fma_f32 v50, v50, s56, -v12
    v_fma_f32 v51, v51, s56, -v12
    v_exp_f32 v32, v32
    v_exp_f32 v33, v33
    v_exp_f32 v34, v34
    v_exp_f32 v35, v35
    v_exp_f32 v36, v36
    v_exp_f32 v37, v37
    v_exp_f32 v38, v38
    v_exp_f32 v39, v39
    v_exp_f32 v40, v40
    v_exp_f32 v41, v41
    v_exp_f32 v42, v42
    v_exp_f32 v43, v43
    v_exp_f32 v44, v44
    v_exp_f32 v45, v45
    v_exp_f32 v46, v46
    v_exp_f32 v47, v47
    v_exp_f32 v48, v48
    v_exp_f32 v49, v49
    v_exp_f32 v50, v50
    v_exp_f32 v51, v51
    v_add_f32 v12, v32, v33
    v_add_f32 v13, v34, v35
    v_add_f32 v12, v12, v36
    v_add_f32 v13, v13, v37
    v_add_f32 v12, v12, v38
    v_add_f32 v13, v13, v39
    v_add_f32 v12, v12, v40
    v_add_f32 v13, v13, v41
    v_add_f32 v12, v12, v42
    v_add_f32 v13, v13, v43
    v_add_f32 v12, v12, v44
    v_add_f32 v13, v13, v45
    v_add_f32 v12, v12, v46
    v_add_f32 v13, v13, v47
    v_add_f32 v12, v12, v48
    v_add_f32 v13, v13, v49
    v_add_f32 v12, v12, v50
    v_add_f32 v13, v13, v51
    v_add_f32 v12, v12, v13
    v_mov_b32 v13, v12
    s_nop 1
    v_permlane32_swap_b32 v12, v13
    v_add_f32 v12, v12, v13
    v_rcp_f32 v12, v12
    s_nop 0
    v_pk_mul_f32 v[32:33], v[32:33], v[12:13] op_sel_hi:[1,0]
    v_pk_mul_f32 v[34:35], v[34:35], v[12:13] op_sel_hi:[1,0]
    v_pk_mul_f32 v[36:37], v[36:37], v[12:13] op_sel_hi:[1,0]
    v_pk_mul_f32 v[38:39], v[38:39], v[12:13] op_sel_hi:[1,0]
    v_pk_mul_f32 v[40:41], v[40:41], v[12:13] op_sel_hi:[1,0]
    v_pk_mul_f32 v[42:43], v[42:43], v[12:13] op_sel_hi:[1,0]
    v_pk_mul_f32 v[44:45], v[44:45], v[12:13] op_sel_hi:[1,0]
    v_pk_mul_f32 v[46:47], v[46:47], v[12:13] op_sel_hi:[1,0]
    v_pk_mul_f32 v[48:49], v[48:49], v[12:13] op_sel_hi:[1,0]
    v_pk_mul_f32 v[50:51], v[50:51], v[12:13] op_sel_hi:[1,0]
    v_cvt_pk_bf16_f32 v64, v32, v33
    v_cvt_pk_bf16_f32 v65, v34, v35
    v_cvt_pk_bf16_f32 v66, v36, v37
    v_cvt_pk_bf16_f32 v67, v38, v39
    v_cvt_pk_bf16_f32 v68, v40, v41
    v_cvt_pk_bf16_f32 v69, v42, v43
    v_cvt_pk_bf16_f32 v70, v44, v45
    v_cvt_pk_bf16_f32 v71, v46, v47
    v_cvt_pk_bf16_f32 v72, v48, v49
    v_cvt_pk_bf16_f32 v73, v50, v51
    v_mov_b64 v[74:75], 0
    s_waitcnt vmcnt(0)
    s_nop 0
    v_mfma_f32_32x32x16_bf16 v[112:127], v[240:243], v[72:75], 0
    v_mfma_f32_32x32x16_bf16 v[112:127], v[208:211], v[64:67], v[112:127]
    v_mfma_f32_32x32x16_bf16 v[112:127], v[212:215], v[68:71], v[112:127]
    v_mfma_f32_32x32x16_bf16 v[128:143], v[244:247], v[72:75], 0
    v_mfma_f32_32x32x16_bf16 v[128:143], v[216:219], v[64:67], v[128:143]
    v_mfma_f32_32x32x16_bf16 v[128:143], v[220:223], v[68:71], v[128:143]
    v_mfma_f32_32x32x16_bf16 v[144:159], v[248:251], v[72:75], 0
    v_mfma_f32_32x32x16_bf16 v[144:159], v[224:227], v[64:67], v[144:159]
    v_mfma_f32_32x32x16_bf16 v[144:159], v[228:231], v[68:71], v[144:159]
    v_mfma_f32_32x32x16_bf16 v[160:175], v[252:255], v[72:75], 0
    v_mfma_f32_32x32x16_bf16 v[160:175], v[232:235], v[64:67], v[160:175]
    v_mfma_f32_32x32x16_bf16 v[160:175], v[236:239], v[68:71], v[160:175]
    s_barrier
    s_nop 1
    v_cvt_pk_bf16_f32 v32, v112, v113
    v_cvt_pk_bf16_f32 v33, v114, v115
    v_cvt_pk_bf16_f32 v34, v116, v117
    v_cvt_pk_bf16_f32 v35, v118, v119
    v_cvt_pk_bf16_f32 v36, v120, v121
    v_cvt_pk_bf16_f32 v37, v122, v123
    v_cvt_pk_bf16_f32 v38, v124, v125
    v_cvt_pk_bf16_f32 v39, v126, v127
    v_cvt_pk_bf16_f32 v40, v128, v129
    v_cvt_pk_bf16_f32 v41, v130, v131
    v_cvt_pk_bf16_f32 v42, v132, v133
    v_cvt_pk_bf16_f32 v43, v134, v135
    v_cvt_pk_bf16_f32 v44, v136, v137
    v_cvt_pk_bf16_f32 v45, v138, v139
    v_cvt_pk_bf16_f32 v46, v140, v141
    v_cvt_pk_bf16_f32 v47, v142, v143
    v_cvt_pk_bf16_f32 v48, v144, v145
    v_cvt_pk_bf16_f32 v49, v146, v147
    v_cvt_pk_bf16_f32 v50, v148, v149
    v_cvt_pk_bf16_f32 v51, v150, v151
    v_cvt_pk_bf16_f32 v52, v152, v153
    v_cvt_pk_bf16_f32 v53, v154, v155
    v_cvt_pk_bf16_f32 v54, v156, v157
    v_cvt_pk_bf16_f32 v55, v158, v159
    v_cvt_pk_bf16_f32 v56, v160, v161
    v_cvt_pk_bf16_f32 v57, v162, v163
    v_cvt_pk_bf16_f32 v58, v164, v165
    v_cvt_pk_bf16_f32 v59, v166, v167
    v_cvt_pk_bf16_f32 v60, v168, v169
    v_cvt_pk_bf16_f32 v61, v170, v171
    v_cvt_pk_bf16_f32 v62, v172, v173
    v_cvt_pk_bf16_f32 v63, v174, v175
    s_add_u32 s46, s45, 1
    s_sub_u32 s37, s47, 1
    s_min_u32 s46, s46, s37
    s_cmp_eq_u32 s46, s45
    s_cbranch_scc1 Lnl_1038
    s_lshl_b32 s58, s46, 19
    s_add_u32 s59, s58, 16777216
    buffer_load_dwordx4 v[112:115], v7, s[8:11], s58 offen offset:0 sc1
    buffer_load_dwordx4 v[144:147], v7, s[8:11], s59 offen offset:0 sc1
    buffer_load_dwordx4 v[116:119], v7, s[8:11], s58 offen offset:1024 sc1
    buffer_load_dwordx4 v[148:151], v7, s[8:11], s59 offen offset:1024 sc1
    buffer_load_dwordx4 v[120:123], v7, s[8:11], s58 offen offset:2048 sc1
    buffer_load_dwordx4 v[152:155], v7, s[8:11], s59 offen offset:2048 sc1
    buffer_load_dwordx4 v[124:127], v7, s[8:11], s58 offen offset:3072 sc1
    buffer_load_dwordx4 v[156:159], v7, s[8:11], s59 offen offset:3072 sc1
    s_add_u32 s58, s58, 4096
    s_add_u32 s59, s59, 4096
    buffer_load_dwordx4 v[128:131], v7, s[8:11], s58 offen offset:0 sc1
    buffer_load_dwordx4 v[160:163], v7, s[8:11], s59 offen offset:0 sc1
    buffer_load_dwordx4 v[132:135], v7, s[8:11], s58 offen offset:1024 sc1
    buffer_load_dwordx4 v[164:167], v7, s[8:11], s59 offen offset:1024 sc1
    buffer_load_dwordx4 v[136:139], v7, s[8:11], s58 offen offset:2048 sc1
    buffer_load_dwordx4 v[168:171], v7, s[8:11], s59 offen offset:2048 sc1
    buffer_load_dwordx4 v[140:143], v7, s[8:11], s58 offen offset:3072 sc1
    buffer_load_dwordx4 v[172:175], v7, s[8:11], s59 offen offset:3072 sc1
    s_lshl_b32 s58, s46, 19
    s_add_u32 s58, s58, 33554432
    buffer_load_dwordx4 v[208:211], v7, s[8:11], s58 offen offset:0 sc1
    buffer_load_dwordx4 v[212:215], v7, s[8:11], s58 offen offset:1024 sc1
    buffer_load_dwordx4 v[216:219], v7, s[8:11], s58 offen offset:2048 sc1
    buffer_load_dwordx4 v[220:223], v7, s[8:11], s58 offen offset:3072 sc1
    s_add_u32 s58, s58, 4096
    buffer_load_dwordx4 v[224:227], v7, s[8:11], s58 offen offset:0 sc1
    buffer_load_dwordx4 v[228:231], v7, s[8:11], s58 offen offset:1024 sc1
    buffer_load_dwordx4 v[232:235], v7, s[8:11], s58 offen offset:2048 sc1
    buffer_load_dwordx4 v[236:239], v7, s[8:11], s58 offen offset:3072 sc1
    s_lshl_b32 s58, s57, 5
    s_add_u32 s58, s58, s46
    s_lshl_b32 s58, s58, 11
    s_add_u32 s59, s58, 54525952
    s_add_u32 s58, s58, 50331648
    buffer_load_dwordx4 v[176:179], v10, s[8:11], s58 offen offset:0 sc1
    buffer_load_dwordx4 v[180:183], v10, s[8:11], s58 offen offset:256 sc1
    buffer_load_dwordx4 v[184:187], v10, s[8:11], s58 offen offset:512 sc1
    buffer_load_dwordx4 v[188:191], v10, s[8:11], s58 offen offset:768 sc1
    buffer_load_dwordx4 v[192:195], v10, s[8:11], s58 offen offset:1024 sc1
    buffer_load_dwordx4 v[196:199], v10, s[8:11], s58 offen offset:1280 sc1
    buffer_load_dwordx4 v[200:203], v10, s[8:11], s58 offen offset:1536 sc1
    buffer_load_dwordx4 v[204:207], v10, s[8:11], s58 offen offset:1792 sc1
    buffer_load_dwordx2 v[240:241], v11, s[8:11], s59 offen offset:0 sc1
    buffer_load_dwordx2 v[244:245], v11, s[8:11], s59 offen offset:512 sc1
    buffer_load_dwordx2 v[248:249], v11, s[8:11], s59 offen offset:1024 sc1
    buffer_load_dwordx2 v[252:253], v11, s[8:11], s59 offen offset:1536 sc1
Lnl_1038:
    ds_read_b64_tr_b16 v[16:17], v1 offset:0
    ds_read_b64_tr_b16 v[18:19], v1 offset:256
    ds_read_b64_tr_b16 v[20:21], v1 offset:1024
    ds_read_b64_tr_b16 v[22:23], v1 offset:1280
    ds_read_b64_tr_b16 v[24:25], v1 offset:2048
    ds_read_b64_tr_b16 v[26:27], v1 offset:2304
    s_add_u32 m0, s40, 122880
    s_add_u32 s37, s32, 110976
    buffer_load_dwordx4 v6, s[12:15], s37 offen lds
    s_add_u32 m0, s40, 126976
    s_add_u32 s37, s32, 111104
    buffer_load_dwordx4 v6, s[12:15], s37 offen lds
    s_add_u32 m0, s40, 131072
    s_add_u32 s37, s32, 111232
    buffer_load_dwordx4 v6, s[12:15], s37 offen lds
    ds_read_b64_tr_b16 v[28:29], v1 offset:3072
    ds_read_b64_tr_b16 v[30:31], v1 offset:3328
    s_waitcnt lgkmcnt(6)
    v_mfma_f32_32x32x16_bf16 a[0:15], v[16:19], v[32:35], a[0:15]
    ds_read_b64_tr_b16 v[16:17], v1 offset:4096
    ds_read_b64_tr_b16 v[18:19], v1 offset:4352
    s_waitcnt lgkmcnt(6)
    v_mfma_f32_32x32x16_bf16 a[0:15], v[20:23], v[36:39], a[0:15]
    ds_read_b64_tr_b16 v[20:21], v1 offset:5120
    ds_read_b64_tr_b16 v[22:23], v1 offset:5376
    s_waitcnt lgkmcnt(6)
    v_mfma_f32_32x32x16_bf16 a[16:31], v[24:27], v[32:35], a[16:31]
    ds_read_b64_tr_b16 v[24:25], v1 offset:6144
    ds_read_b64_tr_b16 v[26:27], v1 offset:6400
    s_waitcnt lgkmcnt(6)
    v_mfma_f32_32x32x16_bf16 a[16:31], v[28:31], v[36:39], a[16:31]
    ds_read_b64_tr_b16 v[28:29], v1 offset:7168
    ds_read_b64_tr_b16 v[30:31], v1 offset:7424
    s_waitcnt lgkmcnt(6)
    v_mfma_f32_32x32x16_bf16 a[32:47], v[16:19], v[32:35], a[32:47]
    ds_read_b64_tr_b16 v[16:17], v1 offset:8192
    ds_read_b64_tr_b16 v[18:19], v1 offset:8448
    s_waitcnt lgkmcnt(6)
    v_mfma_f32_32x32x16_bf16 a[32:47], v[20:23], v[36:39], a[32:47]
    ds_read_b64_tr_b16 v[20:21], v1 offset:9216
    ds_read_b64_tr_b16 v[22:23], v1 offset:9472
    s_waitcnt lgkmcnt(6)
    v_mfma_f32_32x32x16_bf16 a[48:63], v[24:27], v[32:35], a[48:63]
    ds_read_b64_tr_b16 v[24:25], v1 offset:10240
    ds_read_b64_tr_b16 v[26:27], v1 offset:10496
    s_waitcnt lgkmcnt(6)
    v_mfma_f32_32x32x16_bf16 a[48:63], v[28:31], v[36:39], a[48:63]
    ds_read_b64_tr_b16 v[28:29], v1 offset:11264
    ds_read_b64_tr_b16 v[30:31], v1 offset:11520
    s_waitcnt lgkmcnt(6)
    v_mfma_f32_32x32x16_bf16 a[64:79], v[16:19], v[32:35], a[64:79]
    ds_read_b64_tr_b16 v[16:17], v1 offset:12288
    ds_read_b64_tr_b16 v[18:19], v1 offset:12544
    s_waitcnt lgkmcnt(6)
    v_mfma_f32_32x32x16_bf16 a[64:79], v[20:23], v[36:39], a[64:79]
    ds_read_b64_tr_b16 v[20:21], v1 offset:13312
    ds_read_b64_tr_b16 v[22:23], v1 offset:13568
    s_waitcnt lgkmcnt(6)
    v_mfma_f32_32x32x16_bf16 a[80:95], v[24:27], v[32:35], a[80:95]
    ds_read_b64_tr_b16 v[24:25], v1 offset:14336
    ds_read_b64_tr_b16 v[26:27], v1 offset:14592
    s_waitcnt lgkmcnt(6)
    v_mfma_f32_32x32x16_bf16 a[80:95], v[28:31], v[36:39], a[80:95]
    s_barrier
    s_add_u32 m0, s40, 135168
    s_add_u32 s37, s32, 111360
    buffer_load_dwordx4 v6, s[12:15], s37 offen lds
    s_add_u32 m0, s40, 139264
    s_add_u32 s37, s32, 111488
    buffer_load_dwordx4 v6, s[12:15], s37 offen lds
    s_add_u32 m0, s40, 143360
    s_add_u32 s37, s32, 111616
    buffer_load_dwordx4 v6, s[12:15], s37 offen lds
    ds_read_b64_tr_b16 v[28:29], v1 offset:15360
    ds_read_b64_tr_b16 v[30:31], v1 offset:15616
    s_waitcnt lgkmcnt(6)
    v_mfma_f32_32x32x16_bf16 a[96:111], v[16:19], v[32:35], a[96:111]
    ds_read_b64_tr_b16 v[16:17], v1 offset:16384
    ds_read_b64_tr_b16 v[18:19], v1 offset:16640
    s_waitcnt lgkmcnt(6)
    v_mfma_f32_32x32x16_bf16 a[96:111], v[20:23], v[36:39], a[96:111]
    ds_read_b64_tr_b16 v[20:21], v1 offset:17408
    ds_read_b64_tr_b16 v[22:23], v1 offset:17664
    s_waitcnt lgkmcnt(6)
    v_mfma_f32_32x32x16_bf16 a[112:127], v[24:27], v[32:35], a[112:127]
    ds_read_b64_tr_b16 v[24:25], v1 offset:18432
    ds_read_b64_tr_b16 v[26:27], v1 offset:18688
    s_waitcnt lgkmcnt(6)
    v_mfma_f32_32x32x16_bf16 a[112:127], v[28:31], v[36:39], a[112:127]
    ds_read_b64_tr_b16 v[28:29], v1 offset:19456
    ds_read_b64_tr_b16 v[30:31], v1 offset:19712
    s_waitcnt lgkmcnt(6)
    v_mfma_f32_32x32x16_bf16 a[128:143], v[16:19], v[32:35], a[128:143]
    ds_read_b64_tr_b16 v[16:17], v1 offset:20480
    ds_read_b64_tr_b16 v[18:19], v1 offset:20736
    s_waitcnt lgkmcnt(6)
    v_mfma_f32_32x32x16_bf16 a[128:143], v[20:23], v[36:39], a[128:143]
    ds_read_b64_tr_b16 v[20:21], v1 offset:21504
    ds_read_b64_tr_b16 v[22:23], v1 offset:21760
    s_waitcnt lgkmcnt(6)
    v_mfma_f32_32x32x16_bf16 a[144:159], v[24:27], v[32:35], a[144:159]
    ds_read_b64_tr_b16 v[24:25], v1 offset:22528
    ds_read_b64_tr_b16 v[26:27], v1 offset:22784
    s_waitcnt lgkmcnt(6)
    v_mfma_f32_32x32x16_bf16 a[144:159], v[28:31], v[36:39], a[144:159]
    ds_read_b64_tr_b16 v[28:29], v1 offset:23552
    ds_read_b64_tr_b16 v[30:31], v1 offset:23808
    s_waitcnt lgkmcnt(6)
    v_mfma_f32_32x32x16_bf16 a[160:175], v[16:19], v[32:35], a[160:175]
    ds_read_b64_tr_b16 v[16:17], v1 offset:24576
    ds_read_b64_tr_b16 v[18:19], v1 offset:24832
    s_waitcnt lgkmcnt(6)
    v_mfma_f32_32x32x16_bf16 a[160:175], v[20:23], v[36:39], a[160:175]
    ds_read_b64_tr_b16 v[20:21], v1 offset:25600
    ds_read_b64_tr_b16 v[22:23], v1 offset:25856
    s_waitcnt lgkmcnt(6)
    v_mfma_f32_32x32x16_bf16 a[176:191], v[24:27], v[32:35], a[176:191]
    ds_read_b64_tr_b16 v[24:25], v1 offset:26624
    ds_read_b64_tr_b16 v[26:27], v1 offset:26880
    s_waitcnt lgkmcnt(6)
    v_mfma_f32_32x32x16_bf16 a[176:191], v[28:31], v[36:39], a[176:191]
    s_barrier
    s_add_u32 m0, s40, 0
    s_nop 0
    buffer_load_dwordx4 v6, s[12:15], s33 offen lds
    s_add_u32 m0, s40, 4096
    s_add_u32 s37, s33, 128
    buffer_load_dwordx4 v6, s[12:15], s37 offen lds
    s_add_u32 m0, s40, 8192
    s_add_u32 s37, s33, 256
    buffer_load_dwordx4 v6, s[12:15], s37 offen lds
    ds_read_b64_tr_b16 v[28:29], v1 offset:27648
    ds_read_b64_tr_b16 v[30:31], v1 offset:27904
    s_waitcnt lgkmcnt(6)
    v_mfma_f32_32x32x16_bf16 a[192:207], v[16:19], v[32:35], a[192:207]
    ds_read_b64_tr_b16 v[16:17], v1 offset:28672
    ds_read_b64_tr_b16 v[18:19], v1 offset:28928
    s_waitcnt lgkmcnt(6)
    v_mfma_f32_32x32x16_bf16 a[192:207], v[20:23], v[36:39], a[192:207]
    ds_read_b64_tr_b16 v[20:21], v1 offset:29696
    ds_read_b64_tr_b16 v[22:23], v1 offset:29952
    s_waitcnt lgkmcnt(6)
    v_mfma_f32_32x32x16_bf16 a[208:223], v[24:27], v[32:35], a[208:223]
    ds_read_b64_tr_b16 v[24:25], v1 offset:30720
    ds_read_b64_tr_b16 v[26:27], v1 offset:30976
    s_waitcnt lgkmcnt(6)
    v_mfma_f32_32x32x16_bf16 a[208:223], v[28:31], v[36:39], a[208:223]
    ds_read_b64_tr_b16 v[28:29], v1 offset:31744
    ds_read_b64_tr_b16 v[30:31], v1 offset:32000
    s_waitcnt lgkmcnt(6)
    v_mfma_f32_32x32x16_bf16 a[224:239], v[16:19], v[32:35], a[224:239]
    ds_read_b64_tr_b16 v[16:17], v1 offset:32768
    ds_read_b64_tr_b16 v[18:19], v1 offset:33024
    s_waitcnt lgkmcnt(6)
    v_mfma_f32_32x32x16_bf16 a[224:239], v[20:23], v[36:39], a[224:239]
    ds_read_b64_tr_b16 v[20:21], v1 offset:33792
    ds_read_b64_tr_b16 v[22:23], v1 offset:34048
    s_waitcnt lgkmcnt(6)
    v_mfma_f32_32x32x16_bf16 a[240:255], v[24:27], v[32:35], a[240:255]
    ds_read_b64_tr_b16 v[24:25], v1 offset:34816
    ds_read_b64_tr_b16 v[26:27], v1 offset:35072
    s_waitcnt lgkmcnt(6)
    v_mfma_f32_32x32x16_bf16 a[240:255], v[28:31], v[36:39], a[240:255]
    ds_read_b64_tr_b16 v[28:29], v1 offset:35840
    ds_read_b64_tr_b16 v[30:31], v1 offset:36096
    s_waitcnt lgkmcnt(6)
    v_mfma_f32_32x32x16_bf16 v[80:95], v[16:19], v[32:35], v[80:95]
    ds_read_b64_tr_b16 v[16:17], v1 offset:36864
    ds_read_b64_tr_b16 v[18:19], v1 offset:37120
    s_waitcnt lgkmcnt(6)
    v_mfma_f32_32x32x16_bf16 v[80:95], v[20:23], v[36:39], v[80:95]
    ds_read_b64_tr_b16 v[20:21], v1 offset:37888
    ds_read_b64_tr_b16 v[22:23], v1 offset:38144
    s_waitcnt lgkmcnt(6)
    v_mfma_f32_32x32x16_bf16 v[96:111], v[24:27], v[32:35], v[96:111]
    ds_read_b64_tr_b16 v[24:25], v1 offset:38912
    ds_read_b64_tr_b16 v[26:27], v1 offset:39168
    s_waitcnt lgkmcnt(6)
    v_mfma_f32_32x32x16_bf16 v[96:111], v[28:31], v[36:39], v[96:111]
    s_barrier
    s_add_u32 m0, s40, 12288
    s_add_u32 s37, s33, 384
    buffer_load_dwordx4 v6, s[12:15], s37 offen lds
    s_add_u32 m0, s40, 16384
    s_add_u32 s37, s33, 512
    buffer_load_dwordx4 v6, s[12:15], s37 offen lds
    s_add_u32 m0, s40, 20480
    s_add_u32 s37, s33, 640
    buffer_load_dwordx4 v6, s[12:15], s37 offen lds
    ds_read_b64_tr_b16 v[28:29], v1 offset:39936
    ds_read_b64_tr_b16 v[30:31], v1 offset:40192
    s_waitcnt lgkmcnt(6)
    v_mfma_f32_32x32x16_bf16 a[0:15], v[16:19], v[40:43], a[0:15]
    ds_read_b64_tr_b16 v[16:17], v1 offset:40960
    ds_read_b64_tr_b16 v[18:19], v1 offset:41216
    s_waitcnt lgkmcnt(6)
    v_mfma_f32_32x32x16_bf16 a[0:15], v[20:23], v[44:47], a[0:15]
    ds_read_b64_tr_b16 v[20:21], v1 offset:41984
    ds_read_b64_tr_b16 v[22:23], v1 offset:42240
    s_waitcnt lgkmcnt(6)
    v_mfma_f32_32x32x16_bf16 a[16:31], v[24:27], v[40:43], a[16:31]
    ds_read_b64_tr_b16 v[24:25], v1 offset:43008
    ds_read_b64_tr_b16 v[26:27], v1 offset:43264
    s_waitcnt lgkmcnt(6)
    v_mfma_f32_32x32x16_bf16 a[16:31], v[28:31], v[44:47], a[16:31]
    ds_read_b64_tr_b16 v[28:29], v1 offset:44032
    ds_read_b64_tr_b16 v[30:31], v1 offset:44288
    s_waitcnt lgkmcnt(6)
    v_mfma_f32_32x32x16_bf16 a[32:47], v[16:19], v[40:43], a[32:47]
    ds_read_b64_tr_b16 v[16:17], v1 offset:45056
    ds_read_b64_tr_b16 v[18:19], v1 offset:45312
    s_waitcnt lgkmcnt(6)
    v_mfma_f32_32x32x16_bf16 a[32:47], v[20:23], v[44:47], a[32:47]
    ds_read_b64_tr_b16 v[20:21], v1 offset:46080
    ds_read_b64_tr_b16 v[22:23], v1 offset:46336
    s_waitcnt lgkmcnt(6)
    v_mfma_f32_32x32x16_bf16 a[48:63], v[24:27], v[40:43], a[48:63]
    ds_read_b64_tr_b16 v[24:25], v1 offset:47104
    ds_read_b64_tr_b16 v[26:27], v1 offset:47360
    s_waitcnt lgkmcnt(6)
    v_mfma_f32_32x32x16_bf16 a[48:63], v[28:31], v[44:47], a[48:63]
    ds_read_b64_tr_b16 v[28:29], v1 offset:48128
    ds_read_b64_tr_b16 v[30:31], v1 offset:48384
    s_waitcnt lgkmcnt(6)
    v_mfma_f32_32x32x16_bf16 a[64:79], v[16:19], v[40:43], a[64:79]
    ds_read_b64_tr_b16 v[16:17], v1 offset:49152
    ds_read_b64_tr_b16 v[18:19], v1 offset:49408
    s_waitcnt lgkmcnt(6)
    v_mfma_f32_32x32x16_bf16 a[64:79], v[20:23], v[44:47], a[64:79]
    ds_read_b64_tr_b16 v[20:21], v1 offset:50176
    ds_read_b64_tr_b16 v[22:23], v1 offset:50432
    s_waitcnt lgkmcnt(6)
    v_mfma_f32_32x32x16_bf16 a[80:95], v[24:27], v[40:43], a[80:95]
    ds_read_b64_tr_b16 v[24:25], v1 offset:51200
    ds_read_b64_tr_b16 v[26:27], v1 offset:51456
    s_waitcnt lgkmcnt(6)
    v_mfma_f32_32x32x16_bf16 a[80:95], v[28:31], v[44:47], a[80:95]
    s_barrier
    s_add_u32 m0, s40, 24576
    s_add_u32 s37, s33, 768
    buffer_load_dwordx4 v6, s[12:15], s37 offen lds
    s_add_u32 m0, s40, 28672
    s_add_u32 s37, s33, 896
    buffer_load_dwordx4 v6, s[12:15], s37 offen lds
    s_add_u32 m0, s40, 32768
    s_add_u32 s37, s33, 1024
    buffer_load_dwordx4 v6, s[12:15], s37 offen lds
    ds_read_b64_tr_b16 v[28:29], v1 offset:52224
    ds_read_b64_tr_b16 v[30:31], v1 offset:52480
    s_waitcnt lgkmcnt(6)
    v_mfma_f32_32x32x16_bf16 a[96:111], v[16:19], v[40:43], a[96:111]
    ds_read_b64_tr_b16 v[16:17], v1 offset:53248
    ds_read_b64_tr_b16 v[18:19], v1 offset:53504
    s_waitcnt lgkmcnt(6)
    v_mfma_f32_32x32x16_bf16 a[96:111], v[20:23], v[44:47], a[96:111]
    ds_read_b64_tr_b16 v[20:21], v1 offset:54272
    ds_read_b64_tr_b16 v[22:23], v1 offset:54528
    s_waitcnt lgkmcnt(6)
    v_mfma_f32_32x32x16_bf16 a[112:127], v[24:27], v[40:43], a[112:127]
    ds_read_b64_tr_b16 v[24:25], v1 offset:55296
    ds_read_b64_tr_b16 v[26:27], v1 offset:55552
    s_waitcnt lgkmcnt(6)
    v_mfma_f32_32x32x16_bf16 a[112:127], v[28:31], v[44:47], a[112:127]
    ds_read_b64_tr_b16 v[28:29], v1 offset:56320
    ds_read_b64_tr_b16 v[30:31], v1 offset:56576
    s_waitcnt lgkmcnt(6)
    v_mfma_f32_32x32x16_bf16 a[128:143], v[16:19], v[40:43], a[128:143]
    ds_read_b64_tr_b16 v[16:17], v1 offset:57344
    ds_read_b64_tr_b16 v[18:19], v1 offset:57600
    s_waitcnt lgkmcnt(6)
    v_mfma_f32_32x32x16_bf16 a[128:143], v[20:23], v[44:47], a[128:143]
    ds_read_b64_tr_b16 v[20:21], v1 offset:58368
    ds_read_b64_tr_b16 v[22:23], v1 offset:58624
    s_waitcnt lgkmcnt(6)
    v_mfma_f32_32x32x16_bf16 a[144:159], v[24:27], v[40:43], a[144:159]
    ds_read_b64_tr_b16 v[24:25], v1 offset:59392
    ds_read_b64_tr_b16 v[26:27], v1 offset:59648
    s_waitcnt lgkmcnt(6)
    v_mfma_f32_32x32x16_bf16 a[144:159], v[28:31], v[44:47], a[144:159]
    ds_read_b64_tr_b16 v[28:29], v1 offset:60416
    ds_read_b64_tr_b16 v[30:31], v1 offset:60672
    s_waitcnt lgkmcnt(6)
    v_mfma_f32_32x32x16_bf16 a[160:175], v[16:19], v[40:43], a[160:175]
    ds_read_b64_tr_b16 v[16:17], v1 offset:61440
    ds_read_b64_tr_b16 v[18:19], v1 offset:61696
    s_waitcnt lgkmcnt(6)
    v_mfma_f32_32x32x16_bf16 a[160:175], v[20:23], v[44:47], a[160:175]
    ds_read_b64_tr_b16 v[20:21], v1 offset:62464
    ds_read_b64_tr_b16 v[22:23], v1 offset:62720
    s_waitcnt lgkmcnt(6)
    v_mfma_f32_32x32x16_bf16 a[176:191], v[24:27], v[40:43], a[176:191]
    ds_read_b64_tr_b16 v[24:25], v1 offset:63488
    ds_read_b64_tr_b16 v[26:27], v1 offset:63744
    s_waitcnt lgkmcnt(6)
    v_mfma_f32_32x32x16_bf16 a[176:191], v[28:31], v[44:47], a[176:191]
    s_barrier
    s_add_u32 m0, s40, 36864
    s_add_u32 s37, s33, 36864
    buffer_load_dwordx4 v6, s[12:15], s37 offen lds
    s_add_u32 m0, s40, 40960
    s_add_u32 s37, s33, 36992
    buffer_load_dwordx4 v6, s[12:15], s37 offen lds
    s_add_u32 m0, s40, 45056
    s_add_u32 s37, s33, 37120
    buffer_load_dwordx4 v6, s[12:15], s37 offen lds
    ds_read_b64_tr_b16 v[28:29], v1 offset:64512
    ds_read_b64_tr_b16 v[30:31], v1 offset:64768
    s_waitcnt lgkmcnt(6)
    v_mfma_f32_32x32x16_bf16 a[192:207], v[16:19], v[40:43], a[192:207]
    ds_read_b64_tr_b16 v[16:17], v2 offset:0
    ds_read_b64_tr_b16 v[18:19], v2 offset:256
    s_waitcnt lgkmcnt(6)
    v_mfma_f32_32x32x16_bf16 a[192:207], v[20:23], v[44:47], a[192:207]
    ds_read_b64_tr_b16 v[20:21], v2 offset:1024
    ds_read_b64_tr_b16 v[22:23], v2 offset:1280
    s_waitcnt lgkmcnt(6)
    v_mfma_f32_32x32x16_bf16 a[208:223], v[24:27], v[40:43], a[208:223]
    ds_read_b64_tr_b16 v[24:25], v2 offset:2048
    ds_read_b64_tr_b16 v[26:27], v2 offset:2304
    s_waitcnt lgkmcnt(6)
    v_mfma_f32_32x32x16_bf16 a[208:223], v[28:31], v[44:47], a[208:223]
    ds_read_b64_tr_b16 v[28:29], v2 offset:3072
    ds_read_b64_tr_b16 v[30:31], v2 offset:3328
    s_waitcnt lgkmcnt(6)
    v_mfma_f32_32x32x16_bf16 a[224:239], v[16:19], v[40:43], a[224:239]
    ds_read_b64_tr_b16 v[16:17], v2 offset:4096
    ds_read_b64_tr_b16 v[18:19], v2 offset:4352
    s_waitcnt lgkmcnt(6)
    v_mfma_f32_32x32x16_bf16 a[224:239], v[20:23], v[44:47], a[224:239]
    ds_read_b64_tr_b16 v[20:21], v2 offset:5120
    ds_read_b64_tr_b16 v[22:23], v2 offset:5376
    s_waitcnt lgkmcnt(6)
    v_mfma_f32_32x32x16_bf16 a[240:255], v[24:27], v[40:43], a[240:255]
    ds_read_b64_tr_b16 v[24:25], v2 offset:6144
    ds_read_b64_tr_b16 v[26:27], v2 offset:6400
    s_waitcnt lgkmcnt(6)
    v_mfma_f32_32x32x16_bf16 a[240:255], v[28:31], v[44:47], a[240:255]
    ds_read_b64_tr_b16 v[28:29], v2 offset:7168
    ds_read_b64_tr_b16 v[30:31], v2 offset:7424
    s_waitcnt lgkmcnt(6)
    v_mfma_f32_32x32x16_bf16 v[80:95], v[16:19], v[40:43], v[80:95]
    ds_read_b64_tr_b16 v[16:17], v2 offset:8192
    ds_read_b64_tr_b16 v[18:19], v2 offset:8448
    s_waitcnt lgkmcnt(6)
    v_mfma_f32_32x32x16_bf16 v[80:95], v[20:23], v[44:47], v[80:95]
    ds_read_b64_tr_b16 v[20:21], v2 offset:9216
    ds_read_b64_tr_b16 v[22:23], v2 offset:9472
    s_waitcnt lgkmcnt(6)
    v_mfma_f32_32x32x16_bf16 v[96:111], v[24:27], v[40:43], v[96:111]
    ds_read_b64_tr_b16 v[24:25], v2 offset:10240
    ds_read_b64_tr_b16 v[26:27], v2 offset:10496
    s_waitcnt lgkmcnt(6)
    v_mfma_f32_32x32x16_bf16 v[96:111], v[28:31], v[44:47], v[96:111]
    s_barrier
    s_add_u32 m0, s40, 49152
    s_add_u32 s37, s33, 37248
    buffer_load_dwordx4 v6, s[12:15], s37 offen lds
    s_add_u32 m0, s40, 53248
    s_add_u32 s37, s33, 37376
    buffer_load_dwordx4 v6, s[12:15], s37 offen lds
    s_add_u32 m0, s40, 57344
    s_add_u32 s37, s33, 37504
    buffer_load_dwordx4 v6, s[12:15], s37 offen lds
    ds_read_b64_tr_b16 v[28:29], v2 offset:11264
    ds_read_b64_tr_b16 v[30:31], v2 offset:11520
    s_waitcnt lgkmcnt(6)
    v_mfma_f32_32x32x16_bf16 a[0:15], v[16:19], v[48:51], a[0:15]
    ds_read_b64_tr_b16 v[16:17], v2 offset:12288
    ds_read_b64_tr_b16 v[18:19], v2 offset:12544
    s_waitcnt lgkmcnt(6)
    v_mfma_f32_32x32x16_bf16 a[0:15], v[20:23], v[52:55], a[0:15]
    ds_read_b64_tr_b16 v[20:21], v2 offset:13312
    ds_read_b64_tr_b16 v[22:23], v2 offset:13568
    s_waitcnt lgkmcnt(6)
    v_mfma_f32_32x32x16_bf16 a[16:31], v[24:27], v[48:51], a[16:31]
    ds_read_b64_tr_b16 v[24:25], v2 offset:14336
    ds_read_b64_tr_b16 v[26:27], v2 offset:14592
    s_waitcnt lgkmcnt(6)
    v_mfma_f32_32x32x16_bf16 a[16:31], v[28:31], v[52:55], a[16:31]
    ds_read_b64_tr_b16 v[28:29], v2 offset:15360
    ds_read_b64_tr_b16 v[30:31], v2 offset:15616
    s_waitcnt lgkmcnt(6)
    v_mfma_f32_32x32x16_bf16 a[32:47], v[16:19], v[48:51], a[32:47]
    ds_read_b64_tr_b16 v[16:17], v2 offset:16384
    ds_read_b64_tr_b16 v[18:19], v2 offset:16640
    s_waitcnt lgkmcnt(6)
    v_mfma_f32_32x32x16_bf16 a[32:47], v[20:23], v[52:55], a[32:47]
    ds_read_b64_tr_b16 v[20:21], v2 offset:17408
    ds_read_b64_tr_b16 v[22:23], v2 offset:17664
    s_waitcnt lgkmcnt(6)
    v_mfma_f32_32x32x16_bf16 a[48:63], v[24:27], v[48:51], a[48:63]
    ds_read_b64_tr_b16 v[24:25], v2 offset:18432
    ds_read_b64_tr_b16 v[26:27], v2 offset:18688
    s_waitcnt lgkmcnt(6)
    v_mfma_f32_32x32x16_bf16 a[48:63], v[28:31], v[52:55], a[48:63]
    ds_read_b64_tr_b16 v[28:29], v2 offset:19456
    ds_read_b64_tr_b16 v[30:31], v2 offset:19712
    s_waitcnt lgkmcnt(6)
    v_mfma_f32_32x32x16_bf16 a[64:79], v[16:19], v[48:51], a[64:79]
    ds_read_b64_tr_b16 v[16:17], v2 offset:20480
    ds_read_b64_tr_b16 v[18:19], v2 offset:20736
    s_waitcnt lgkmcnt(6)
    v_mfma_f32_32x32x16_bf16 a[64:79], v[20:23], v[52:55], a[64:79]
    ds_read_b64_tr_b16 v[20:21], v2 offset:21504
    ds_read_b64_tr_b16 v[22:23], v2 offset:21760
    s_waitcnt lgkmcnt(6)
    v_mfma_f32_32x32x16_bf16 a[80:95], v[24:27], v[48:51], a[80:95]
    ds_read_b64_tr_b16 v[24:25], v2 offset:22528
    ds_read_b64_tr_b16 v[26:27], v2 offset:22784
    s_waitcnt lgkmcnt(6)
    v_mfma_f32_32x32x16_bf16 a[80:95], v[28:31], v[52:55], a[80:95]
    s_barrier
    s_add_u32 m0, s40, 61440
    s_add_u32 s37, s33, 37632
    buffer_load_dwordx4 v6, s[12:15], s37 offen lds
    s_add_u32 m0, s40, 65536
    s_add_u32 s37, s33, 37760
    buffer_load_dwordx4 v6, s[12:15], s37 offen lds
    s_add_u32 m0, s40, 69632
    s_add_u32 s37, s33, 37888
    buffer_load_dwordx4 v6, s[12:15], s37 offen lds
    ds_read_b64_tr_b16 v[28:29], v2 offset:23552
    ds_read_b64_tr_b16 v[30:31], v2 offset:23808
    s_waitcnt lgkmcnt(6)
    v_mfma_f32_32x32x16_bf16 a[96:111], v[16:19], v[48:51], a[96:111]
    ds_read_b64_tr_b16 v[16:17], v2 offset:24576
    ds_read_b64_tr_b16 v[18:19], v2 offset:24832
    s_waitcnt lgkmcnt(6)
    v_mfma_f32_32x32x16_bf16 a[96:111], v[20:23], v[52:55], a[96:111]
    ds_read_b64_tr_b16 v[20:21], v2 offset:25600
    ds_read_b64_tr_b16 v[22:23], v2 offset:25856
    s_waitcnt lgkmcnt(6)
    v_mfma_f32_32x32x16_bf16 a[112:127], v[24:27], v[48:51], a[112:127]
    ds_read_b64_tr_b16 v[24:25], v2 offset:26624
    ds_read_b64_tr_b16 v[26:27], v2 offset:26880
    s_waitcnt lgkmcnt(6)
    v_mfma_f32_32x32x16_bf16 a[112:127], v[28:31], v[52:55], a[112:127]
    ds_read_b64_tr_b16 v[28:29], v2 offset:27648
    ds_read_b64_tr_b16 v[30:31], v2 offset:27904
    s_waitcnt lgkmcnt(6)
    v_mfma_f32_32x32x16_bf16 a[128:143], v[16:19], v[48:51], a[128:143]
    ds_read_b64_tr_b16 v[16:17], v2 offset:28672
    ds_read_b64_tr_b16 v[18:19], v2 offset:28928
    s_waitcnt lgkmcnt(6)
    v_mfma_f32_32x32x16_bf16 a[128:143], v[20:23], v[52:55], a[128:143]
    ds_read_b64_tr_b16 v[20:21], v2 offset:29696
    ds_read_b64_tr_b16 v[22:23], v2 offset:29952
    s_waitcnt lgkmcnt(6)
    v_mfma_f32_32x32x16_bf16 a[144:159], v[24:27], v[48:51], a[144:159]
    ds_read_b64_tr_b16 v[24:25], v2 offset:30720
    ds_read_b64_tr_b16 v[26:27], v2 offset:30976
    s_waitcnt lgkmcnt(6)
    v_mfma_f32_32x32x16_bf16 a[144:159], v[28:31], v[52:55], a[144:159]
    ds_read_b64_tr_b16 v[28:29], v2 offset:31744
    ds_read_b64_tr_b16 v[30:31], v2 offset:32000
    s_waitcnt lgkmcnt(6)
    v_mfma_f32_32x32x16_bf16 a[160:175], v[16:19], v[48:51], a[160:175]
    ds_read_b64_tr_b16 v[16:17], v2 offset:32768
    ds_read_b64_tr_b16 v[18:19], v2 offset:33024
    s_waitcnt lgkmcnt(6)
    v_mfma_f32_32x32x16_bf16 a[160:175], v[20:23], v[52:55], a[160:175]
    ds_read_b64_tr_b16 v[20:21], v2 offset:33792
    ds_read_b64_tr_b16 v[22:23], v2 offset:34048
    s_waitcnt lgkmcnt(6)
    v_mfma_f32_32x32x16_bf16 a[176:191], v[24:27], v[48:51], a[176:191]
    ds_read_b64_tr_b16 v[24:25], v2 offset:34816
    ds_read_b64_tr_b16 v[26:27], v2 offset:35072
    s_waitcnt lgkmcnt(6)
    v_mfma_f32_32x32x16_bf16 a[176:191], v[28:31], v[52:55], a[176:191]
    s_barrier
    s_add_u32 m0, s40, 73728
    s_add_u32 s37, s33, 73728
    buffer_load_dwordx4 v6, s[12:15], s37 offen lds
    s_add_u32 m0, s40, 77824
    s_add_u32 s37, s33, 73856
    buffer_load_dwordx4 v6, s[12:15], s37 offen lds
    s_add_u32 m0, s40, 81920
    s_add_u32 s37, s33, 73984
    buffer_load_dwordx4 v6, s[12:15], s37 offen lds
    ds_read_b64_tr_b16 v[28:29], v2 offset:35840
    ds_read_b64_tr_b16 v[30:31], v2 offset:36096
    s_waitcnt lgkmcnt(6)
    v_mfma_f32_32x32x16_bf16 a[192:207], v[16:19], v[48:51], a[192:207]
    ds_read_b64_tr_b16 v[16:17], v2 offset:36864
    ds_read_b64_tr_b16 v[18:19], v2 offset:37120
    s_waitcnt lgkmcnt(6)
    v_mfma_f32_32x32x16_bf16 a[192:207], v[20:23], v[52:55], a[192:207]
    ds_read_b64_tr_b16 v[20:21], v2 offset:37888
    ds_read_b64_tr_b16 v[22:23], v2 offset:38144
    s_waitcnt lgkmcnt(6)
    v_mfma_f32_32x32x16_bf16 a[208:223], v[24:27], v[48:51], a[208:223]
    ds_read_b64_tr_b16 v[24:25], v2 offset:38912
    ds_read_b64_tr_b16 v[26:27], v2 offset:39168
    s_waitcnt lgkmcnt(6)
    v_mfma_f32_32x32x16_bf16 a[208:223], v[28:31], v[52:55], a[208:223]
    ds_read_b64_tr_b16 v[28:29], v2 offset:39936
    ds_read_b64_tr_b16 v[30:31], v2 offset:40192
    s_waitcnt lgkmcnt(6)
    v_mfma_f32_32x32x16_bf16 a[224:239], v[16:19], v[48:51], a[224:239]
    ds_read_b64_tr_b16 v[16:17], v2 offset:40960
    ds_read_b64_tr_b16 v[18:19], v2 offset:41216
    s_waitcnt lgkmcnt(6)
    v_mfma_f32_32x32x16_bf16 a[224:239], v[20:23], v[52:55], a[224:239]
    ds_read_b64_tr_b16 v[20:21], v2 offset:41984
    ds_read_b64_tr_b16 v[22:23], v2 offset:42240
    s_waitcnt lgkmcnt(6)
    v_mfma_f32_32x32x16_bf16 a[240:255], v[24:27], v[48:51], a[240:255]
    ds_read_b64_tr_b16 v[24:25], v2 offset:43008
    ds_read_b64_tr_b16 v[26:27], v2 offset:43264
    s_waitcnt lgkmcnt(6)
    v_mfma_f32_32x32x16_bf16 a[240:255], v[28:31], v[52:55], a[240:255]
    ds_read_b64_tr_b16 v[28:29], v2 offset:44032
    ds_read_b64_tr_b16 v[30:31], v2 offset:44288
    s_waitcnt lgkmcnt(6)
    v_mfma_f32_32x32x16_bf16 v[80:95], v[16:19], v[48:51], v[80:95]
    ds_read_b64_tr_b16 v[16:17], v2 offset:45056
    ds_read_b64_tr_b16 v[18:19], v2 offset:45312
    s_waitcnt lgkmcnt(6)
    v_mfma_f32_32x32x16_bf16 v[80:95], v[20:23], v[52:55], v[80:95]
    ds_read_b64_tr_b16 v[20:21], v2 offset:46080
    ds_read_b64_tr_b16 v[22:23], v2 offset:46336
    s_waitcnt lgkmcnt(6)
    v_mfma_f32_32x32x16_bf16 v[96:111], v[24:27], v[48:51], v[96:111]
    ds_read_b64_tr_b16 v[24:25], v2 offset:47104
    ds_read_b64_tr_b16 v[26:27], v2 offset:47360
    s_waitcnt lgkmcnt(6)
    v_mfma_f32_32x32x16_bf16 v[96:111], v[28:31], v[52:55], v[96:111]
    s_waitcnt vmcnt(24)
    s_barrier
    s_add_u32 m0, s40, 86016
    s_add_u32 s37, s33, 74112
    buffer_load_dwordx4 v6, s[12:15], s37 offen lds
    s_add_u32 m0, s40, 90112
    s_add_u32 s37, s33, 74240
    buffer_load_dwordx4 v6, s[12:15], s37 offen lds
    s_add_u32 m0, s40, 94208
    s_add_u32 s37, s33, 74368
    buffer_load_dwordx4 v6, s[12:15], s37 offen lds
    ds_read_b64_tr_b16 v[28:29], v2 offset:48128
    ds_read_b64_tr_b16 v[30:31], v2 offset:48384
    s_waitcnt lgkmcnt(6)
    v_mfma_f32_32x32x16_bf16 a[0:15], v[16:19], v[56:59], a[0:15]
    ds_read_b64_tr_b16 v[16:17], v2 offset:49152
    ds_read_b64_tr_b16 v[18:19], v2 offset:49408
    s_waitcnt lgkmcnt(6)
    v_mfma_f32_32x32x16_bf16 a[0:15], v[20:23], v[60:63], a[0:15]
    ds_read_b64_tr_b16 v[20:21], v2 offset:50176
    ds_read_b64_tr_b16 v[22:23], v2 offset:50432
    s_waitcnt lgkmcnt(6)
    v_mfma_f32_32x32x16_bf16 a[16:31], v[24:27], v[56:59], a[16:31]
    ds_read_b64_tr_b16 v[24:25], v2 offset:51200
    ds_read_b64_tr_b16 v[26:27], v2 offset:51456
    s_waitcnt lgkmcnt(6)
    v_mfma_f32_32x32x16_bf16 a[16:31], v[28:31], v[60:63], a[16:31]
    ds_read_b64_tr_b16 v[28:29], v2 offset:52224
    ds_read_b64_tr_b16 v[30:31], v2 offset:52480
    s_waitcnt lgkmcnt(6)
    v_mfma_f32_32x32x16_bf16 a[32:47], v[16:19], v[56:59], a[32:47]
    ds_read_b64_tr_b16 v[16:17], v2 offset:53248
    ds_read_b64_tr_b16 v[18:19], v2 offset:53504
    s_waitcnt lgkmcnt(6)
    v_mfma_f32_32x32x16_bf16 a[32:47], v[20:23], v[60:63], a[32:47]
    ds_read_b64_tr_b16 v[20:21], v2 offset:54272
    ds_read_b64_tr_b16 v[22:23], v2 offset:54528
    s_waitcnt lgkmcnt(6)
    v_mfma_f32_32x32x16_bf16 a[48:63], v[24:27], v[56:59], a[48:63]
    ds_read_b64_tr_b16 v[24:25], v2 offset:55296
    ds_read_b64_tr_b16 v[26:27], v2 offset:55552
    s_waitcnt lgkmcnt(6)
    v_mfma_f32_32x32x16_bf16 a[48:63], v[28:31], v[60:63], a[48:63]
    ds_read_b64_tr_b16 v[28:29], v2 offset:56320
    ds_read_b64_tr_b16 v[30:31], v2 offset:56576
    s_waitcnt lgkmcnt(6)
    v_mfma_f32_32x32x16_bf16 a[64:79], v[16:19], v[56:59], a[64:79]
    ds_read_b64_tr_b16 v[16:17], v2 offset:57344
    ds_read_b64_tr_b16 v[18:19], v2 offset:57600
    s_waitcnt lgkmcnt(6)
    v_mfma_f32_32x32x16_bf16 a[64:79], v[20:23], v[60:63], a[64:79]
    ds_read_b64_tr_b16 v[20:21], v2 offset:58368
    ds_read_b64_tr_b16 v[22:23], v2 offset:58624
    s_waitcnt lgkmcnt(6)
    v_mfma_f32_32x32x16_bf16 a[80:95], v[24:27], v[56:59], a[80:95]
    ds_read_b64_tr_b16 v[24:25], v2 offset:59392
    ds_read_b64_tr_b16 v[26:27], v2 offset:59648
    s_waitcnt lgkmcnt(6)
    v_mfma_f32_32x32x16_bf16 a[80:95], v[28:31], v[60:63], a[80:95]
    s_waitcnt vmcnt(24)
    s_barrier
    s_add_u32 m0, s40, 98304
    s_add_u32 s37, s33, 74496
    buffer_load_dwordx4 v6, s[12:15], s37 offen lds
    s_add_u32 m0, s40, 102400
    s_add_u32 s37, s33, 74624
    buffer_load_dwordx4 v6, s[12:15], s37 offen lds
    s_add_u32 m0, s40, 106496
    s_add_u32 s37, s33, 74752
    buffer_load_dwordx4 v6, s[12:15], s37 offen lds
    ds_read_b64_tr_b16 v[28:29], v2 offset:60416
    ds_read_b64_tr_b16 v[30:31], v2 offset:60672
    s_waitcnt lgkmcnt(6)
    v_mfma_f32_32x32x16_bf16 a[96:111], v[16:19], v[56:59], a[96:111]
    ds_read_b64_tr_b16 v[16:17], v2 offset:61440
    ds_read_b64_tr_b16 v[18:19], v2 offset:61696
    s_waitcnt lgkmcnt(6)
    v_mfma_f32_32x32x16_bf16 a[96:111], v[20:23], v[60:63], a[96:111]
    ds_read_b64_tr_b16 v[20:21], v2 offset:62464
    ds_read_b64_tr_b16 v[22:23], v2 offset:62720
    s_waitcnt lgkmcnt(6)
    v_mfma_f32_32x32x16_bf16 a[112:127], v[24:27], v[56:59], a[112:127]
    ds_read_b64_tr_b16 v[24:25], v2 offset:63488
    ds_read_b64_tr_b16 v[26:27], v2 offset:63744
    s_waitcnt lgkmcnt(6)
    v_mfma_f32_32x32x16_bf16 a[112:127], v[28:31], v[60:63], a[112:127]
    ds_read_b64_tr_b16 v[28:29], v2 offset:64512
    ds_read_b64_tr_b16 v[30:31], v2 offset:64768
    s_waitcnt lgkmcnt(6)
    v_mfma_f32_32x32x16_bf16 a[128:143], v[16:19], v[56:59], a[128:143]
    ds_read_b64_tr_b16 v[16:17], v3 offset:0
    ds_read_b64_tr_b16 v[18:19], v3 offset:256
    s_waitcnt lgkmcnt(6)
    v_mfma_f32_32x32x16_bf16 a[128:143], v[20:23], v[60:63], a[128:143]
    ds_read_b64_tr_b16 v[20:21], v3 offset:1024
    ds_read_b64_tr_b16 v[22:23], v3 offset:1280
    s_waitcnt lgkmcnt(6)
    v_mfma_f32_32x32x16_bf16 a[144:159], v[24:27], v[56:59], a[144:159]
    ds_read_b64_tr_b16 v[24:25], v3 offset:2048
    ds_read_b64_tr_b16 v[26:27], v3 offset:2304
    s_waitcnt lgkmcnt(6)
    v_mfma_f32_32x32x16_bf16 a[144:159], v[28:31], v[60:63], a[144:159]
    ds_read_b64_tr_b16 v[28:29], v3 offset:3072
    ds_read_b64_tr_b16 v[30:31], v3 offset:3328
    s_waitcnt lgkmcnt(6)
    v_mfma_f32_32x32x16_bf16 a[160:175], v[16:19], v[56:59], a[160:175]
    ds_read_b64_tr_b16 v[16:17], v3 offset:4096
    ds_read_b64_tr_b16 v[18:19], v3 offset:4352
    s_waitcnt lgkmcnt(6)
    v_mfma_f32_32x32x16_bf16 a[160:175], v[20:23], v[60:63], a[160:175]
    ds_read_b64_tr_b16 v[20:21], v3 offset:5120
    ds_read_b64_tr_b16 v[22:23], v3 offset:5376
    s_waitcnt lgkmcnt(6)
    v_mfma_f32_32x32x16_bf16 a[176:191], v[24:27], v[56:59], a[176:191]
    ds_read_b64_tr_b16 v[24:25], v3 offset:6144
    ds_read_b64_tr_b16 v[26:27], v3 offset:6400
    s_waitcnt lgkmcnt(6)
    v_mfma_f32_32x32x16_bf16 a[176:191], v[28:31], v[60:63], a[176:191]
    s_waitcnt vmcnt(24)
    s_barrier
    s_add_u32 m0, s40, 110592
    s_add_u32 s37, s33, 110592
    buffer_load_dwordx4 v6, s[12:15], s37 offen lds
    s_add_u32 m0, s40, 114688
    s_add_u32 s37, s33, 110720
    buffer_load_dwordx4 v6, s[12:15], s37 offen lds
    s_add_u32 m0, s40, 118784
    s_add_u32 s37, s33, 110848
    buffer_load_dwordx4 v6, s[12:15], s37 offen lds
    ds_read_b64_tr_b16 v[28:29], v3 offset:7168
    ds_read_b64_tr_b16 v[30:31], v3 offset:7424
    s_waitcnt lgkmcnt(6)
    v_mfma_f32_32x32x16_bf16 a[192:207], v[16:19], v[56:59], a[192:207]
    ds_read_b64_tr_b16 v[16:17], v3 offset:8192
    ds_read_b64_tr_b16 v[18:19], v3 offset:8448
    s_waitcnt lgkmcnt(6)
    v_mfma_f32_32x32x16_bf16 a[192:207], v[20:23], v[60:63], a[192:207]
    ds_read_b64_tr_b16 v[20:21], v3 offset:9216
    ds_read_b64_tr_b16 v[22:23], v3 offset:9472
    s_waitcnt lgkmcnt(6)
    v_mfma_f32_32x32x16_bf16 a[208:223], v[24:27], v[56:59], a[208:223]
    ds_read_b64_tr_b16 v[24:25], v3 offset:10240
    ds_read_b64_tr_b16 v[26:27], v3 offset:10496
    s_waitcnt lgkmcnt(6)
    v_mfma_f32_32x32x16_bf16 a[208:223], v[28:31], v[60:63], a[208:223]
    ds_read_b64_tr_b16 v[28:29], v3 offset:11264
    ds_read_b64_tr_b16 v[30:31], v3 offset:11520
    s_waitcnt lgkmcnt(6)
    v_mfma_f32_32x32x16_bf16 a[224:239], v[16:19], v[56:59], a[224:239]
    ds_read_b64_tr_b16 v[16:17], v3 offset:12288
    ds_read_b64_tr_b16 v[18:19], v3 offset:12544
    s_waitcnt lgkmcnt(6)
    v_mfma_f32_32x32x16_bf16 a[224:239], v[20:23], v[60:63], a[224:239]
    ds_read_b64_tr_b16 v[20:21], v3 offset:13312
    ds_read_b64_tr_b16 v[22:23], v3 offset:13568
    s_waitcnt lgkmcnt(6)
    v_mfma_f32_32x32x16_bf16 a[240:255], v[24:27], v[56:59], a[240:255]
    ds_read_b64_tr_b16 v[24:25], v3 offset:14336
    ds_read_b64_tr_b16 v[26:27], v3 offset:14592
    s_waitcnt lgkmcnt(6)
    v_mfma_f32_32x32x16_bf16 a[240:255], v[28:31], v[60:63], a[240:255]
    ds_read_b64_tr_b16 v[28:29], v3 offset:15360
    ds_read_b64_tr_b16 v[30:31], v3 offset:15616
    s_waitcnt lgkmcnt(6)
    v_mfma_f32_32x32x16_bf16 v[80:95], v[16:19], v[56:59], v[80:95]
    s_waitcnt lgkmcnt(4)
    v_mfma_f32_32x32x16_bf16 v[80:95], v[20:23], v[60:63], v[80:95]
    s_waitcnt lgkmcnt(2)
    v_mfma_f32_32x32x16_bf16 v[96:111], v[24:27], v[56:59], v[96:111]
    s_waitcnt lgkmcnt(0)
    v_mfma_f32_32x32x16_bf16 v[96:111], v[28:31], v[60:63], v[96:111]
    s_add_u32 s45, s45, 1
    s_xor_b32 s42, s42, 49152
    s_mul_i32 s32, s45, 147456
    s_mul_i32 s37, s34, 384
    s_add_u32 s32, s32, s37
    s_add_u32 s33, s32, 147456
    s_add_u32 s37, s45, 1
    s_cmp_lt_u32 s37, s47
    s_cselect_b32 s33, s33, 2130706432
    s_cmp_lt_u32 s45, s47
    s_cbranch_scc1 Lattn_1036
Lnoown_1027:
    s_lshl_b32 s37, s5, 2
    s_add_u32 s37, s37, s4
    s_mul_i32 s37, s37, 73728
    s_add_u32 s37, s37, s60
    v_lshlrev_b32 v12, 4, v0
    s_nop 7
    buffer_store_dwordx4 a[0:3], v12, s[8:11], s37 offen offset:0 sc1
    buffer_store_dwordx4 a[4:7], v12, s[8:11], s37 offen offset:1024 sc1
    buffer_store_dwordx4 a[8:11], v12, s[8:11], s37 offen offset:2048 sc1
    buffer_store_dwordx4 a[12:15], v12, s[8:11], s37 offen offset:3072 sc1
    s_add_u32 s37, s37, 4096
    buffer_store_dwordx4 a[16:19], v12, s[8:11], s37 offen offset:0 sc1
    buffer_store_dwordx4 a[20:23], v12, s[8:11], s37 offen offset:1024 sc1
    buffer_store_dwordx4 a[24:27], v12, s[8:11], s37 offen offset:2048 sc1
    buffer_store_dwordx4 a[28:31], v12, s[8:11], s37 offen offset:3072 sc1
    s_add_u32 s37, s37, 4096
    buffer_store_dwordx4 a[32:35], v12, s[8:11], s37 offen offset:0 sc1
    buffer_store_dwordx4 a[36:39], v12, s[8:11], s37 offen offset:1024 sc1
    buffer_store_dwordx4 a[40:43], v12, s[8:11], s37 offen offset:2048 sc1
    buffer_store_dwordx4 a[44:47], v12, s[8:11], s37 offen offset:3072 sc1
    s_add_u32 s37, s37, 4096
    buffer_store_dwordx4 a[48:51], v12, s[8:11], s37 offen offset:0 sc1
    buffer_store_dwordx4 a[52:55], v12, s[8:11], s37 offen offset:1024 sc1
    buffer_store_dwordx4 a[56:59], v12, s[8:11], s37 offen offset:2048 sc1
    buffer_store_dwordx4 a[60:63], v12, s[8:11], s37 offen offset:3072 sc1
    s_add_u32 s37, s37, 4096
    buffer_store_dwordx4 a[64:67], v12, s[8:11], s37 offen offset:0 sc1
    buffer_store_dwordx4 a[68:71], v12, s[8:11], s37 offen offset:1024 sc1
    buffer_store_dwordx4 a[72:75], v12, s[8:11], s37 offen offset:2048 sc1
    buffer_store_dwordx4 a[76:79], v12, s[8:11], s37 offen offset:3072 sc1
    s_add_u32 s37, s37, 4096
    buffer_store_dwordx4 a[80:83], v12, s[8:11], s37 offen offset:0 sc1
    buffer_store_dwordx4 a[84:87], v12, s[8:11], s37 offen offset:1024 sc1
    buffer_store_dwordx4 a[88:91], v12, s[8:11], s37 offen offset:2048 sc1
    buffer_store_dwordx4 a[92:95], v12, s[8:11], s37 offen offset:3072 sc1
    s_add_u32 s37, s37, 4096
    buffer_store_dwordx4 a[96:99], v12, s[8:11], s37 offen offset:0 sc1
    buffer_store_dwordx4 a[100:103], v12, s[8:11], s37 offen offset:1024 sc1
    buffer_store_dwordx4 a[104:107], v12, s[8:11], s37 offen offset:2048 sc1
    buffer_store_dwordx4 a[108:111], v12, s[8:11], s37 offen offset:3072 sc1
    s_add_u32 s37, s37, 4096
    buffer_store_dwordx4 a[112:115], v12, s[8:11], s37 offen offset:0 sc1
    buffer_store_dwordx4 a[116:119], v12, s[8:11], s37 offen offset:1024 sc1
    buffer_store_dwordx4 a[120:123], v12, s[8:11], s37 offen offset:2048 sc1
    buffer_store_dwordx4 a[124:127], v12, s[8:11], s37 offen offset:3072 sc1
    s_add_u32 s37, s37, 4096
    buffer_store_dwordx4 a[128:131], v12, s[8:11], s37 offen offset:0 sc1
    buffer_store_dwordx4 a[132:135], v12, s[8:11], s37 offen offset:1024 sc1
    buffer_store_dwordx4 a[136:139], v12, s[8:11], s37 offen offset:2048 sc1
    buffer_store_dwordx4 a[140:143], v12, s[8:11], s37 offen offset:3072 sc1
    s_add_u32 s37, s37, 4096
    buffer_store_dwordx4 a[144:147], v12, s[8:11], s37 offen offset:0 sc1
    buffer_store_dwordx4 a[148:151], v12, s[8:11], s37 offen offset:1024 sc1
    buffer_store_dwordx4 a[152:155], v12, s[8:11], s37 offen offset:2048 sc1
    buffer_store_dwordx4 a[156:159], v12, s[8:11], s37 offen offset:3072 sc1
    s_add_u32 s37, s37, 4096
    buffer_store_dwordx4 a[160:163], v12, s[8:11], s37 offen offset:0 sc1
    buffer_store_dwordx4 a[164:167], v12, s[8:11], s37 offen offset:1024 sc1
    buffer_store_dwordx4 a[168:171], v12, s[8:11], s37 offen offset:2048 sc1
    buffer_store_dwordx4 a[172:175], v12, s[8:11], s37 offen offset:3072 sc1
    s_add_u32 s37, s37, 4096
    buffer_store_dwordx4 a[176:179], v12, s[8:11], s37 offen offset:0 sc1
    buffer_store_dwordx4 a[180:183], v12, s[8:11], s37 offen offset:1024 sc1
    buffer_store_dwordx4 a[184:187], v12, s[8:11], s37 offen offset:2048 sc1
    buffer_store_dwordx4 a[188:191], v12, s[8:11], s37 offen offset:3072 sc1
    s_add_u32 s37, s37, 4096
    buffer_store_dwordx4 a[192:195], v12, s[8:11], s37 offen offset:0 sc1
    buffer_store_dwordx4 a[196:199], v12, s[8:11], s37 offen offset:1024 sc1
    buffer_store_dwordx4 a[200:203], v12, s[8:11], s37 offen offset:2048 sc1
    buffer_store_dwordx4 a[204:207], v12, s[8:11], s37 offen offset:3072 sc1
    s_add_u32 s37, s37, 4096
    buffer_store_dwordx4 a[208:211], v12, s[8:11], s37 offen offset:0 sc1
    buffer_store_dwordx4 a[212:215], v12, s[8:11], s37 offen offset:1024 sc1
    buffer_store_dwordx4 a[216:219], v12, s[8:11], s37 offen offset:2048 sc1
    buffer_store_dwordx4 a[220:223], v12, s[8:11], s37 offen offset:3072 sc1
    s_add_u32 s37, s37, 4096
    buffer_store_dwordx4 a[224:227], v12, s[8:11], s37 offen offset:0 sc1
    buffer_store_dwordx4 a[228:231], v12, s[8:11], s37 offen offset:1024 sc1
    buffer_store_dwordx4 a[232:235], v12, s[8:11], s37 offen offset:2048 sc1
    buffer_store_dwordx4 a[236:239], v12, s[8:11], s37 offen offset:3072 sc1
    s_add_u32 s37, s37, 4096
    buffer_store_dwordx4 a[240:243], v12, s[8:11], s37 offen offset:0 sc1
    buffer_store_dwordx4 a[244:247], v12, s[8:11], s37 offen offset:1024 sc1
    buffer_store_dwordx4 a[248:251], v12, s[8:11], s37 offen offset:2048 sc1
    buffer_store_dwordx4 a[252:255], v12, s[8:11], s37 offen offset:3072 sc1
    s_add_u32 s37, s37, 4096
    buffer_store_dwordx4 v[80:83], v12, s[8:11], s37 offen offset:0 sc1
    buffer_store_dwordx4 v[84:87], v12, s[8:11], s37 offen offset:1024 sc1
    buffer_store_dwordx4 v[88:91], v12, s[8:11], s37 offen offset:2048 sc1
    buffer_store_dwordx4 v[92:95], v12, s[8:11], s37 offen offset:3072 sc1
    s_add_u32 s37, s37, 4096
    buffer_store_dwordx4 v[96:99], v12, s[8:11], s37 offen offset:0 sc1
    buffer_store_dwordx4 v[100:103], v12, s[8:11], s37 offen offset:1024 sc1
    buffer_store_dwordx4 v[104:107], v12, s[8:11], s37 offen offset:2048 sc1
    buffer_store_dwordx4 v[108:111], v12, s[8:11], s37 offen offset:3072 sc1
    s_add_u32 s37, s37, 4096
    s_waitcnt vmcnt(0)
    s_barrier
    s_cmp_lg_u32 s4, 0
    s_cbranch_scc1 Ldn_1039
    s_lshl_b32 s37, s3, 7
    s_add_u32 s37, s37, 60882944
    v_mov_b32 v12, 0
    v_mov_b32 v13, 1
    s_mov_b64 exec, 1
    buffer_atomic_add v13, v12, s[8:11], s37 offen sc0 sc1
    s_cmp_ge_u32 s3, 14
    s_cselect_b32 s39, 13, 13
    s_waitcnt vmcnt(0)
    v_readfirstlane_b32 s37, v13
    s_mov_b64 exec, -1
    s_and_b32 s37, s37, 0xffff
    s_cmp_lg_u32 s37, s39
    s_cbranch_scc1 Ldn_1039
    s_add_u32 s37, s3, 60817456
    v_lshlrev_b32 v12, 7, v0
    v_mov_b32 v13, 1
    s_mov_b32 exec_hi, 0
    buffer_store_byte v13, v12, s[8:11], s37 offen sc1
    s_mov_b64 exec, -1
Ldn_1039:
    s_mov_b32 s6, 0
Lqtop_1040:
    s_barrier
    v_mov_b32 v12, 0
    s_cmp_lg_u32 s4, 0
    s_cbranch_scc1 Lq_1042
    s_mov_b64 exec, 1
Lqng_1046:
    s_mov_b32 s37, -1
    s_cmp_ge_u32 s6, 20
    s_cbranch_scc1 Lqgot_1045
    s_lshl_b32 s37, s6, 4
    s_load_dwordx4 s[24:27], s[62:63], s37
    s_mov_b32 s44, 0
Lqpk_1043:
    buffer_load_ubyte v15, v12, s[8:11], s7 offen sc1
    s_add_u32 s44, s44, 1
    s_cmp_gt_u32 s44, 0x20000
    s_cbranch_scc1 Lqtk_1044
    s_waitcnt vmcnt(0) lgkmcnt(0)
    v_readfirstlane_b32 s38, v15
    s_nop 0
    s_cmp_ge_u32 s38, s24
    s_cbranch_scc1 Lqtk_1044
    s_sleep 16
    s_branch Lqpk_1043
Lqtk_1044:
    s_waitcnt vmcnt(0) lgkmcnt(0)
    v_mov_b32 v14, 1
    buffer_atomic_add v14, v12, s[8:11], s25 offen sc0 sc1
    s_waitcnt vmcnt(0)
    v_readfirstlane_b32 s37, v14
    s_nop 0
    s_cmp_lt_u32 s37, s27
    s_cselect_b32 s38, 0, 1
    s_add_u32 s6, s6, s38
    s_cmp_lg_u32 s38, 0
    s_cbranch_scc1 Lqng_1046
    s_add_u32 s37, s37, s26
Lqgot_1045:
    v_mov_b32 v14, s37
    ds_write_b32 v12, v14
    s_mov_b64 exec, -1
Lq_1042:
    s_waitcnt lgkmcnt(0)
    s_barrier
    ds_read_b32 v14, v12
    s_waitcnt lgkmcnt(0)
    v_readfirstlane_b32 s37, v14
    s_barrier
    s_cmp_eq_u32 s37, -1
    s_cbranch_scc1 Lwdone
    s_lshl_b32 s37, s37, 2
    s_add_u32 s38, s37, 320
    s_load_dword s61, s[62:63], s38
    s_waitcnt lgkmcnt(0)
    s_bfe_u32 s3, s61, 0x40018
    s_mov_b32 s101, s37
    s_mul_i32 s60, s3, 4128768
    s_sub_u32 s37, s3, 12
    s_max_i32 s37, s37, 0
    s_mul_i32 s37, s37, 4718592
    s_add_u32 s60, s60, s37
    s_sub_u32 s37, s3, 14
    s_max_i32 s37, s37, 0
    s_mul_i32 s37, s37, 4718592
    s_add_u32 s60, s60, s37
    s_add_u32 s60, s60, 67108864
    s_lshl_b32 s57, s3, 2
    s_add_u32 s57, s57, s4
    s_lshl_b32 s37, s57, 13
    v_and_b32 v12, 31, v0
    v_lshrrev_b32 v13, 5, v0
    v_lshlrev_b32 v7, 5, v12
    v_lshl_add_u32 v7, v13, 4, v7
    v_add_u32 v7, s37, v7
    s_bitcmp1_b32 s61, 31
    s_cbranch_scc1 Lqred_1041
    s_bfe_u32 s45, s61, 0x80010
    s_bfe_u32 s47, s61, 0x80008
    s_add_u32 s47, s47, s45
    s_and_b32 s34, s61, 3
    s_bfe_u32 s35, s61, 0x60002
    s_mul_i32 s32, s45, 147456
    s_mul_i32 s37, s34, 384
    s_add_u32 s32, s32, s37
    s_add_u32 s33, s32, 147456
    s_add_u32 s37, s45, 1
    s_cmp_lt_u32 s37, s47
    s_cselect_b32 s33, s33, 2130706432
    s_mov_b32 s42, 0
    s_add_u32 s38, s40, 0
    s_xor_b32 s39, s42, 0
    s_add_u32 m0, s38, s39
    s_add_u32 s37, s32, 0
    buffer_load_dwordx4 v6, s[12:15], s37 offen lds
    s_add_u32 s38, s40, 4096
    s_xor_b32 s39, s42, 0
    s_add_u32 m0, s38, s39
    s_add_u32 s37, s32, 128
    buffer_load_dwordx4 v6, s[12:15], s37 offen lds
    s_add_u32 s38, s40, 8192
    s_xor_b32 s39, s42, 0
    s_add_u32 m0, s38, s39
    s_add_u32 s37, s32, 256
    buffer_load_dwordx4 v6, s[12:15], s37 offen lds
    s_add_u32 s38, s40, 12288
    s_xor_b32 s39, s42, 0
    s_add_u32 m0, s38, s39
    s_add_u32 s37, s32, 36864
    buffer_load_dwordx4 v6, s[12:15], s37 offen lds
    s_add_u32 s38, s40, 16384
    s_xor_b32 s39, s42, 0
    s_add_u32 m0, s38, s39
    s_add_u32 s37, s32, 36992
    buffer_load_dwordx4 v6, s[12:15], s37 offen lds
    s_add_u32 s38, s40, 20480
    s_xor_b32 s39, s42, 0
    s_add_u32 m0, s38, s39
    s_add_u32 s37, s32, 37120
    buffer_load_dwordx4 v6, s[12:15], s37 offen lds
    s_add_u32 s38, s40, 24576
    s_xor_b32 s39, s42, 0
    s_add_u32 m0, s38, s39
    s_add_u32 s37, s32, 73728
    buffer_load_dwordx4 v6, s[12:15], s37 offen lds
    s_add_u32 s38, s40, 28672
    s_xor_b32 s39, s42, 0
    s_add_u32 m0, s38, s39
    s_add_u32 s37, s32, 73856
    buffer_load_dwordx4 v6, s[12:15], s37 offen lds
    s_add_u32 s38, s40, 32768
    s_xor_b32 s39, s42, 0
    s_add_u32 m0, s38, s39
    s_add_u32 s37, s32, 73984
    buffer_load_dwordx4 v6, s[12:15], s37 offen lds
    s_add_u32 s38, s40, 36864
    s_xor_b32 s39, s42, 0
    s_add_u32 m0, s38, s39
    s_add_u32 s37, s32, 110592
    buffer_load_dwordx4 v6, s[12:15], s37 offen lds
    s_add_u32 s38, s40, 40960
    s_xor_b32 s39, s42, 0
    s_add_u32 m0, s38, s39
    s_add_u32 s37, s32, 110720
    buffer_load_dwordx4 v6, s[12:15], s37 offen lds
    s_add_u32 s38, s40, 45056
    s_xor_b32 s39, s42, 0
    s_add_u32 m0, s38, s39
    s_add_u32 s37, s32, 110848
    buffer_load_dwordx4 v6, s[12:15], s37 offen lds
    v_accvgpr_write_b32 a0, 0
    v_accvgpr_write_b32 a1, 0
    v_accvgpr_write_b32 a2, 0
    v_accvgpr_write_b32 a3, 0
    v_accvgpr_write_b32 a4, 0
    v_accvgpr_write_b32 a5, 0
    v_accvgpr_write_b32 a6, 0
    v_accvgpr_write_b32 a7, 0
    v_accvgpr_write_b32 a8, 0
    v_accvgpr_write_b32 a9, 0
    v_accvgpr_write_b32 a10, 0
    v_accvgpr_write_b32 a11, 0
    v_accvgpr_write_b32 a12, 0
    v_accvgpr_write_b32 a13, 0
    v_accvgpr_write_b32 a14, 0
    v_accvgpr_write_b32 a15, 0
    v_accvgpr_write_b32 a16, 0
    v_accvgpr_write_b32 a17, 0
    v_accvgpr_write_b32 a18, 0
    v_accvgpr_write_b32 a19, 0
    v_accvgpr_write_b32 a20, 0
    v_accvgpr_write_b32 a21, 0
    v_accvgpr_write_b32 a22, 0
    v_accvgpr_write_b32 a23, 0
    v_accvgpr_write_b32 a24, 0
    v_accvgpr_write_b32 a25, 0
    v_accvgpr_write_b32 a26, 0
    v_accvgpr_write_b32 a27, 0
    v_accvgpr_write_b32 a28, 0
    v_accvgpr_write_b32 a29, 0
    v_accvgpr_write_b32 a30, 0
    v_accvgpr_write_b32 a31, 0
    v_accvgpr_write_b32 a32, 0
    v_accvgpr_write_b32 a33, 0
    v_accvgpr_write_b32 a34, 0
    v_accvgpr_write_b32 a35, 0
    v_accvgpr_write_b32 a36, 0
    v_accvgpr_write_b32 a37, 0
    v_accvgpr_write_b32 a38, 0
    v_accvgpr_write_b32 a39, 0
    v_accvgpr_write_b32 a40, 0
    v_accvgpr_write_b32 a41, 0
    v_accvgpr_write_b32 a42, 0
    v_accvgpr_write_b32 a43, 0
    v_accvgpr_write_b32 a44, 0
    v_accvgpr_write_b32 a45, 0
    v_accvgpr_write_b32 a46, 0
    v_accvgpr_write_b32 a47, 0
    v_accvgpr_write_b32 a48, 0
    v_accvgpr_write_b32 a49, 0
    v_accvgpr_write_b32 a50, 0
    v_accvgpr_write_b32 a51, 0
    v_accvgpr_write_b32 a52, 0
    v_accvgpr_write_b32 a53, 0
    v_accvgpr_write_b32 a54, 0
    v_accvgpr_write_b32 a55, 0
    v_accvgpr_write_b32 a56, 0
    v_accvgpr_write_b32 a57, 0
    v_accvgpr_write_b32 a58, 0
    v_accvgpr_write_b32 a59, 0
    v_accvgpr_write_b32 a60, 0
    v_accvgpr_write_b32 a61, 0
    v_accvgpr_write_b32 a62, 0
    v_accvgpr_write_b32 a63, 0
    v_accvgpr_write_b32 a64, 0
    v_accvgpr_write_b32 a65, 0
    v_accvgpr_write_b32 a66, 0
    v_accvgpr_write_b32 a67, 0
    v_accvgpr_write_b32 a68, 0
    v_accvgpr_write_b32 a69, 0
    v_accvgpr_write_b32 a70, 0
    v_accvgpr_write_b32 a71, 0
    v_accvgpr_write_b32 a72, 0
    v_accvgpr_write_b32 a73, 0
    v_accvgpr_write_b32 a74, 0
    v_accvgpr_write_b32 a75, 0
    v_accvgpr_write_b32 a76, 0
    v_accvgpr_write_b32 a77, 0
    v_accvgpr_write_b32 a78, 0
    v_accvgpr_write_b32 a79, 0
    v_accvgpr_write_b32 a80, 0
    v_accvgpr_write_b32 a81, 0
    v_accvgpr_write_b32 a82, 0
    v_accvgpr_write_b32 a83, 0
    v_accvgpr_write_b32 a84, 0
    v_accvgpr_write_b32 a85, 0
    v_accvgpr_write_b32 a86, 0
    v_accvgpr_write_b32 a87, 0
    v_accvgpr_write_b32 a88, 0
    v_accvgpr_write_b32 a89, 0
    v_accvgpr_write_b32 a90, 0
    v_accvgpr_write_b32 a91, 0
    v_accvgpr_write_b32 a92, 0
    v_accvgpr_write_b32 a93, 0
    v_accvgpr_write_b32 a94, 0
    v_accvgpr_write_b32 a95, 0
    v_mov_b64 v[242:243], 0
    v_mov_b64 v[246:247], 0
    v_mov_b64 v[250:251], 0
    v_mov_b64 v[254:255], 0
    s_cmp_lg_u32 s4, 0
    s_cbranch_scc1 Lwh3_1049
    s_add_u32 s43, s57, 3
    s_lshl_b32 s37, s3, 2
    v_mov_b32 v12, s37
    s_mov_b32 s44, 0
Lwh1_1047:
    global_load_dword v14, v12, s[30:31] offset:128 sc1
    s_add_u32 s44, s44, 1
    s_cmp_gt_u32 s44, 0x40000
    s_cbranch_scc1 Lwdone
    s_waitcnt vmcnt(0)
    v_readfirstlane_b32 s37, v14
    s_nop 0
    s_cmp_eq_u32 s37, 4194432
    s_cbranch_scc1 Lwh3_1049
    s_sleep 32
    s_branch Lwh1_1047
Lwh3_1049:
    s_barrier
    s_lshl_b32 s58, s45, 19
    s_add_u32 s59, s58, 16777216
    buffer_load_dwordx4 v[112:115], v7, s[8:11], s58 offen offset:0 sc1
    buffer_load_dwordx4 v[144:147], v7, s[8:11], s59 offen offset:0 sc1
    buffer_load_dwordx4 v[116:119], v7, s[8:11], s58 offen offset:1024 sc1
    buffer_load_dwordx4 v[148:151], v7, s[8:11], s59 offen offset:1024 sc1
    buffer_load_dwordx4 v[120:123], v7, s[8:11], s58 offen offset:2048 sc1
    buffer_load_dwordx4 v[152:155], v7, s[8:11], s59 offen offset:2048 sc1
    buffer_load_dwordx4 v[124:127], v7, s[8:11], s58 offen offset:3072 sc1
    buffer_load_dwordx4 v[156:159], v7, s[8:11], s59 offen offset:3072 sc1
    s_add_u32 s58, s58, 4096
    s_add_u32 s59, s59, 4096
    buffer_load_dwordx4 v[128:131], v7, s[8:11], s58 offen offset:0 sc1
    buffer_load_dwordx4 v[160:163], v7, s[8:11], s59 offen offset:0 sc1
    buffer_load_dwordx4 v[132:135], v7, s[8:11], s58 offen offset:1024 sc1
    buffer_load_dwordx4 v[164:167], v7, s[8:11], s59 offen offset:1024 sc1
    buffer_load_dwordx4 v[136:139], v7, s[8:11], s58 offen offset:2048 sc1
    buffer_load_dwordx4 v[168:171], v7, s[8:11], s59 offen offset:2048 sc1
    buffer_load_dwordx4 v[140:143], v7, s[8:11], s58 offen offset:3072 sc1
    buffer_load_dwordx4 v[172:175], v7, s[8:11], s59 offen offset:3072 sc1
    s_lshl_b32 s58, s45, 19
    s_add_u32 s58, s58, 33554432
    buffer_load_dwordx4 v[208:211], v7, s[8:11], s58 offen offset:0 sc1
    buffer_load_dwordx4 v[212:215], v7, s[8:11], s58 offen offset:1024 sc1
    buffer_load_dwordx4 v[216:219], v7, s[8:11], s58 offen offset:2048 sc1
    buffer_load_dwordx4 v[220:223], v7, s[8:11], s58 offen offset:3072 sc1
    s_add_u32 s58, s58, 4096
    buffer_load_dwordx4 v[224:227], v7, s[8:11], s58 offen offset:0 sc1
    buffer_load_dwordx4 v[228:231], v7, s[8:11], s58 offen offset:1024 sc1
    buffer_load_dwordx4 v[232:235], v7, s[8:11], s58 offen offset:2048 sc1
    buffer_load_dwordx4 v[236:239], v7, s[8:11], s58 offen offset:3072 sc1
    s_cmp_lg_u32 s4, 0
    s_cbranch_scc1 Lwh3_1052
    s_add_u32 s43, s57, 3
    s_lshl_b32 s37, s45, 7
    v_mov_b32 v12, s37
    s_lshl_b32 s37, s47, 7
    v_mov_b32 v13, s37
    s_mov_b32 s39, 60850176
    s_mov_b32 s38, 60850048
    s_mov_b32 s44, 0
Lwh1_1050:
    buffer_load_dword v14, v12, s[8:11], s39 offen sc1
    buffer_load_dword v15, v13, s[8:11], s38 offen sc1
    s_add_u32 s44, s44, 1
    s_cmp_gt_u32 s44, 0x40000
    s_cbranch_scc1 Lwdone
    s_waitcnt vmcnt(0)
    v_min_u32 v14, v14, v15
    s_nop 0
    v_readfirstlane_b32 s37, v14
    s_nop 0
    s_cmp_gt_u32 s37, s43
    s_cbranch_scc1 Lwh3_1052
    s_add_u32 s37, s37, 0
    s_cmp_ge_u32 s37, s43
    s_cbranch_scc1 Lwh2_1051
    s_sleep 32
Lwh2_1051:
    s_sleep 2
    s_branch Lwh1_1050
Lwh3_1052:
    s_barrier
    s_lshl_b32 s58, s57, 5
    s_add_u32 s58, s58, s45
    s_lshl_b32 s58, s58, 11
    s_add_u32 s59, s58, 54525952
    s_add_u32 s58, s58, 50331648
    buffer_load_dwordx4 v[176:179], v10, s[8:11], s58 offen offset:0 sc1
    buffer_load_dwordx4 v[180:183], v10, s[8:11], s58 offen offset:256 sc1
    buffer_load_dwordx4 v[184:187], v10, s[8:11], s58 offen offset:512 sc1
    buffer_load_dwordx4 v[188:191], v10, s[8:11], s58 offen offset:768 sc1
    buffer_load_dwordx4 v[192:195], v10, s[8:11], s58 offen offset:1024 sc1
    buffer_load_dwordx4 v[196:199], v10, s[8:11], s58 offen offset:1280 sc1
    buffer_load_dwordx4 v[200:203], v10, s[8:11], s58 offen offset:1536 sc1
    buffer_load_dwordx4 v[204:207], v10, s[8:11], s58 offen offset:1792 sc1
    buffer_load_dwordx2 v[240:241], v11, s[8:11], s59 offen offset:0 sc1
    buffer_load_dwordx2 v[244:245], v11, s[8:11], s59 offen offset:512 sc1
    buffer_load_dwordx2 v[248:249], v11, s[8:11], s59 offen offset:1024 sc1
    buffer_load_dwordx2 v[252:253], v11, s[8:11], s59 offen offset:1536 sc1
Lattn_1053:
    s_waitcnt vmcnt(20)
    v_mfma_f32_32x32x16_bf16 v[32:47], v[144:147], v[112:115], 0
    v_mfma_f32_32x32x16_bf16 v[32:47], v[148:151], v[116:119], v[32:47]
    v_mfma_f32_32x32x16_bf16 v[32:47], v[152:155], v[120:123], v[32:47]
    v_mfma_f32_32x32x16_bf16 v[32:47], v[156:159], v[124:127], v[32:47]
    v_mfma_f32_32x32x16_bf16 v[32:47], v[160:163], v[128:131], v[32:47]
    v_mfma_f32_32x32x16_bf16 v[32:47], v[164:167], v[132:135], v[32:47]
    v_mfma_f32_32x32x16_bf16 v[32:47], v[168:171], v[136:139], v[32:47]
    v_mfma_f32_32x32x16_bf16 v[32:47], v[172:175], v[140:143], v[32:47]
    s_waitcnt vmcnt(11)
    v_mfma_f32_32x32x16_bf16 v[48:63], v[176:179], v[112:115], 0
    s_waitcnt vmcnt(10)
    v_mfma_f32_32x32x16_bf16 v[48:63], v[180:183], v[116:119], v[48:63]
    s_waitcnt vmcnt(9)
    v_mfma_f32_32x32x16_bf16 v[48:63], v[184:187], v[120:123], v[48:63]
    s_waitcnt vmcnt(8)
    v_mfma_f32_32x32x16_bf16 v[48:63], v[188:191], v[124:127], v[48:63]
    s_waitcnt vmcnt(7)
    v_mfma_f32_32x32x16_bf16 v[48:63], v[192:195], v[128:131], v[48:63]
    s_waitcnt vmcnt(6)
    v_mfma_f32_32x32x16_bf16 v[48:63], v[196:199], v[132:135], v[48:63]
    s_waitcnt vmcnt(5)
    v_mfma_f32_32x32x16_bf16 v[48:63], v[200:203], v[136:139], v[48:63]
    s_waitcnt vmcnt(4)
    v_mfma_f32_32x32x16_bf16 v[48:63], v[204:207], v[140:143], v[48:63]
    v_mov_b32 v12, 0xff800000
    v_cndmask_b32 v32, v12, v32, s[64:65]
    v_cndmask_b32 v33, v12, v33, s[66:67]
    v_cndmask_b32 v34, v12, v34, s[68:69]
    v_cndmask_b32 v35, v12, v35, s[70:71]
    v_cndmask_b32 v36, v12, v36, s[72:73]
    v_cndmask_b32 v37, v12, v37, s[74:75]
    v_cndmask_b32 v38, v12, v38, s[76:77]
    v_cndmask_b32 v39, v12, v39, s[78:79]
    v_cndmask_b32 v40, v12, v40, s[80:81]
    v_cndmask_b32 v41, v12, v41, s[82:83]
    v_cndmask_b32 v42, v12, v42, s[84:85]
    v_cndmask_b32 v43, v12, v43, s[86:87]
    v_cndmask_b32 v44, v12, v44, s[88:89]
    v_cndmask_b32 v45, v12, v45, s[90:91]
    v_cndmask_b32 v46, v12, v46, s[92:93]
    v_cndmask_b32 v47, v12, v47, s[94:95]
    v_max3_f32 v12, v32, v33, v34
    v_max3_f32 v12, v12, v35, v36
    v_max3_f32 v12, v12, v37, v38
    v_max3_f32 v12, v12, v39, v40
    v_max3_f32 v12, v12, v41, v42
    v_max3_f32 v12, v12, v43, v44
    v_max3_f32 v12, v12, v45, v46
    v_max_f32 v12, v12, v47
    v_max3_f32 v12, v12, v48, v49
    v_max3_f32 v12, v12, v50, v51
    v_mov_b32 v13, v12
    s_nop 1
    v_permlane32_swap_b32 v12, v13
    v_max_f32 v12, v12, v13
    v_mul_f32 v12, s56, v12
    v_fma_f32 v32, v32, s56, -v12
    v_fma_f32 v33, v33, s56, -v12
    v_fma_f32 v34, v34, s56, -v12
    v_fma_f32 v35, v35, s56, -v12
    v_fma_f32 v36, v36, s56, -v12
    v_fma_f32 v37, v37, s56, -v12
    v_fma_f32 v38, v38, s56, -v12
    v_fma_f32 v39, v39, s56, -v12
    v_fma_f32 v40, v40, s56, -v12
    v_fma_f32 v41, v41, s56, -v12
    v_fma_f32 v42, v42, s56, -v12
    v_fma_f32 v43, v43, s56, -v12
    v_fma_f32 v44, v44, s56, -v12
    v_fma_f32 v45, v45, s56, -v12
    v_fma_f32 v46, v46, s56, -v12
    v_fma_f32 v47, v47, s56, -v12
    v_fma_f32 v48, v48, s56, -v12
    v_fma_f32 v49, v49, s56, -v12
    v_fma_f32 v50, v50, s56, -v12
    v_fma_f32 v51, v51, s56, -v12
    v_exp_f32 v32, v32
    v_exp_f32 v33, v33
    v_exp_f32 v34, v34
    v_exp_f32 v35, v35
    v_exp_f32 v36, v36
    v_exp_f32 v37, v37
    v_exp_f32 v38, v38
    v_exp_f32 v39, v39
    v_exp_f32 v40, v40
    v_exp_f32 v41, v41
    v_exp_f32 v42, v42
    v_exp_f32 v43, v43
    v_exp_f32 v44, v44
    v_exp_f32 v45, v45
    v_exp_f32 v46, v46
    v_exp_f32 v47, v47
    v_exp_f32 v48, v48
    v_exp_f32 v49, v49
    v_exp_f32 v50, v50
    v_exp_f32 v51, v51
    v_add_f32 v12, v32, v33
    v_add_f32 v13, v34, v35
    v_add_f32 v12, v12, v36
    v_add_f32 v13, v13, v37
    v_add_f32 v12, v12, v38
    v_add_f32 v13, v13, v39
    v_add_f32 v12, v12, v40
    v_add_f32 v13, v13, v41
    v_add_f32 v12, v12, v42
    v_add_f32 v13, v13, v43
    v_add_f32 v12, v12, v44
    v_add_f32 v13, v13, v45
    v_add_f32 v12, v12, v46
    v_add_f32 v13, v13, v47
    v_add_f32 v12, v12, v48
    v_add_f32 v13, v13, v49
    v_add_f32 v12, v12, v50
    v_add_f32 v13, v13, v51
    v_add_f32 v12, v12, v13
    v_mov_b32 v13, v12
    s_nop 1
    v_permlane32_swap_b32 v12, v13
    v_add_f32 v12, v12, v13
    v_rcp_f32 v12, v12
    s_nop 0
    v_pk_mul_f32 v[32:33], v[32:33], v[12:13] op_sel_hi:[1,0]
    v_pk_mul_f32 v[34:35], v[34:35], v[12:13] op_sel_hi:[1,0]
    v_pk_mul_f32 v[36:37], v[36:37], v[12:13] op_sel_hi:[1,0]
    v_pk_mul_f32 v[38:39], v[38:39], v[12:13] op_sel_hi:[1,0]
    v_pk_mul_f32 v[40:41], v[40:41], v[12:13] op_sel_hi:[1,0]
    v_pk_mul_f32 v[42:43], v[42:43], v[12:13] op_sel_hi:[1,0]
    v_pk_mul_f32 v[44:45], v[44:45], v[12:13] op_sel_hi:[1,0]
    v_pk_mul_f32 v[46:47], v[46:47], v[12:13] op_sel_hi:[1,0]
    v_pk_mul_f32 v[48:49], v[48:49], v[12:13] op_sel_hi:[1,0]
    v_pk_mul_f32 v[50:51], v[50:51], v[12:13] op_sel_hi:[1,0]
    v_cvt_pk_bf16_f32 v64, v32, v33
    v_cvt_pk_bf16_f32 v65, v34, v35
    v_cvt_pk_bf16_f32 v66, v36, v37
    v_cvt_pk_bf16_f32 v67, v38, v39
    v_cvt_pk_bf16_f32 v68, v40, v41
    v_cvt_pk_bf16_f32 v69, v42, v43
    v_cvt_pk_bf16_f32 v70, v44, v45
    v_cvt_pk_bf16_f32 v71, v46, v47
    v_cvt_pk_bf16_f32 v72, v48, v49
    v_cvt_pk_bf16_f32 v73, v50, v51
    v_mov_b64 v[74:75], 0
    s_waitcnt vmcnt(0)
    s_nop 0
    v_mfma_f32_32x32x16_bf16 v[112:127], v[240:243], v[72:75], 0
    v_mfma_f32_32x32x16_bf16 v[112:127], v[208:211], v[64:67], v[112:127]
    v_mfma_f32_32x32x16_bf16 v[112:127], v[212:215], v[68:71], v[112:127]
    v_mfma_f32_32x32x16_bf16 v[128:143], v[244:247], v[72:75], 0
    v_mfma_f32_32x32x16_bf16 v[128:143], v[216:219], v[64:67], v[128:143]
    v_mfma_f32_32x32x16_bf16 v[128:143], v[220:223], v[68:71], v[128:143]
    v_mfma_f32_32x32x16_bf16 v[144:159], v[248:251], v[72:75], 0
    v_mfma_f32_32x32x16_bf16 v[144:159], v[224:227], v[64:67], v[144:159]
    v_mfma_f32_32x32x16_bf16 v[144:159], v[228:231], v[68:71], v[144:159]
    v_mfma_f32_32x32x16_bf16 v[160:175], v[252:255], v[72:75], 0
    v_mfma_f32_32x32x16_bf16 v[160:175], v[232:235], v[64:67], v[160:175]
    v_mfma_f32_32x32x16_bf16 v[160:175], v[236:239], v[68:71], v[160:175]
    v_add_u32 v14, s42, v1
    s_barrier
    s_add_u32 s38, s40, 0
    s_xor_b32 s39, s42, 49152
    s_add_u32 m0, s38, s39
    s_add_u32 s37, s33, 0
    buffer_load_dwordx4 v6, s[12:15], s37 offen lds
    s_add_u32 s38, s40, 4096
    s_xor_b32 s39, s42, 49152
    s_add_u32 m0, s38, s39
    s_add_u32 s37, s33, 128
    buffer_load_dwordx4 v6, s[12:15], s37 offen lds
    s_add_u32 s38, s40, 8192
    s_xor_b32 s39, s42, 49152
    s_add_u32 m0, s38, s39
    s_add_u32 s37, s33, 256
    buffer_load_dwordx4 v6, s[12:15], s37 offen lds
    s_add_u32 s38, s40, 12288
    s_xor_b32 s39, s42, 49152
    s_add_u32 m0, s38, s39
    s_add_u32 s37, s33, 36864
    buffer_load_dwordx4 v6, s[12:15], s37 offen lds
    s_add_u32 s38, s40, 16384
    s_xor_b32 s39, s42, 49152
    s_add_u32 m0, s38, s39
    s_add_u32 s37, s33, 36992
    buffer_load_dwordx4 v6, s[12:15], s37 offen lds
    s_add_u32 s38, s40, 20480
    s_xor_b32 s39, s42, 49152
    s_add_u32 m0, s38, s39
    s_add_u32 s37, s33, 37120
    buffer_load_dwordx4 v6, s[12:15], s37 offen lds
    s_add_u32 s38, s40, 24576
    s_xor_b32 s39, s42, 49152
    s_add_u32 m0, s38, s39
    s_add_u32 s37, s33, 73728
    buffer_load_dwordx4 v6, s[12:15], s37 offen lds
    s_add_u32 s38, s40, 28672
    s_xor_b32 s39, s42, 49152
    s_add_u32 m0, s38, s39
    s_add_u32 s37, s33, 73856
    buffer_load_dwordx4 v6, s[12:15], s37 offen lds
    s_add_u32 s38, s40, 32768
    s_xor_b32 s39, s42, 49152
    s_add_u32 m0, s38, s39
    s_add_u32 s37, s33, 73984
    buffer_load_dwordx4 v6, s[12:15], s37 offen lds
    s_add_u32 s38, s40, 36864
    s_xor_b32 s39, s42, 49152
    s_add_u32 m0, s38, s39
    s_add_u32 s37, s33, 110592
    buffer_load_dwordx4 v6, s[12:15], s37 offen lds
    s_add_u32 s38, s40, 40960
    s_xor_b32 s39, s42, 49152
    s_add_u32 m0, s38, s39
    s_add_u32 s37, s33, 110720
    buffer_load_dwordx4 v6, s[12:15], s37 offen lds
    s_add_u32 s38, s40, 45056
    s_xor_b32 s39, s42, 49152
    s_add_u32 m0, s38, s39
    s_add_u32 s37, s33, 110848
    buffer_load_dwordx4 v6, s[12:15], s37 offen lds
    v_cvt_pk_bf16_f32 v32, v112, v113
    v_cvt_pk_bf16_f32 v33, v114, v115
    v_cvt_pk_bf16_f32 v34, v116, v117
    v_cvt_pk_bf16_f32 v35, v118, v119
    v_cvt_pk_bf16_f32 v36, v120, v121
    v_cvt_pk_bf16_f32 v37, v122, v123
    v_cvt_pk_bf16_f32 v38, v124, v125
    v_cvt_pk_bf16_f32 v39, v126, v127
    v_cvt_pk_bf16_f32 v40, v128, v129
    v_cvt_pk_bf16_f32 v41, v130, v131
    v_cvt_pk_bf16_f32 v42, v132, v133
    v_cvt_pk_bf16_f32 v43, v134, v135
    v_cvt_pk_bf16_f32 v44, v136, v137
    v_cvt_pk_bf16_f32 v45, v138, v139
    v_cvt_pk_bf16_f32 v46, v140, v141
    v_cvt_pk_bf16_f32 v47, v142, v143
    v_cvt_pk_bf16_f32 v48, v144, v145
    v_cvt_pk_bf16_f32 v49, v146, v147
    v_cvt_pk_bf16_f32 v50, v148, v149
    v_cvt_pk_bf16_f32 v51, v150, v151
    v_cvt_pk_bf16_f32 v52, v152, v153
    v_cvt_pk_bf16_f32 v53, v154, v155
    v_cvt_pk_bf16_f32 v54, v156, v157
    v_cvt_pk_bf16_f32 v55, v158, v159
    v_cvt_pk_bf16_f32 v56, v160, v161
    v_cvt_pk_bf16_f32 v57, v162, v163
    v_cvt_pk_bf16_f32 v58, v164, v165
    v_cvt_pk_bf16_f32 v59, v166, v167
    v_cvt_pk_bf16_f32 v60, v168, v169
    v_cvt_pk_bf16_f32 v61, v170, v171
    v_cvt_pk_bf16_f32 v62, v172, v173
    v_cvt_pk_bf16_f32 v63, v174, v175
    s_add_u32 s46, s45, 1
    s_sub_u32 s37, s47, 1
    s_min_u32 s46, s46, s37
    s_cmp_eq_u32 s46, s45
    s_cbranch_scc1 Lnl_1055
    s_lshl_b32 s58, s46, 19
    s_add_u32 s59, s58, 16777216
    buffer_load_dwordx4 v[112:115], v7, s[8:11], s58 offen offset:0 sc1
    buffer_load_dwordx4 v[144:147], v7, s[8:11], s59 offen offset:0 sc1
    buffer_load_dwordx4 v[116:119], v7, s[8:11], s58 offen offset:1024 sc1
    buffer_load_dwordx4 v[148:151], v7, s[8:11], s59 offen offset:1024 sc1
    buffer_load_dwordx4 v[120:123], v7, s[8:11], s58 offen offset:2048 sc1
    buffer_load_dwordx4 v[152:155], v7, s[8:11], s59 offen offset:2048 sc1
    buffer_load_dwordx4 v[124:127], v7, s[8:11], s58 offen offset:3072 sc1
    buffer_load_dwordx4 v[156:159], v7, s[8:11], s59 offen offset:3072 sc1
    s_add_u32 s58, s58, 4096
    s_add_u32 s59, s59, 4096
    buffer_load_dwordx4 v[128:131], v7, s[8:11], s58 offen offset:0 sc1
    buffer_load_dwordx4 v[160:163], v7, s[8:11], s59 offen offset:0 sc1
    buffer_load_dwordx4 v[132:135], v7, s[8:11], s58 offen offset:1024 sc1
    buffer_load_dwordx4 v[164:167], v7, s[8:11], s59 offen offset:1024 sc1
    buffer_load_dwordx4 v[136:139], v7, s[8:11], s58 offen offset:2048 sc1
    buffer_load_dwordx4 v[168:171], v7, s[8:11], s59 offen offset:2048 sc1
    buffer_load_dwordx4 v[140:143], v7, s[8:11], s58 offen offset:3072 sc1
    buffer_load_dwordx4 v[172:175], v7, s[8:11], s59 offen offset:3072 sc1
    s_lshl_b32 s58, s46, 19
    s_add_u32 s58, s58, 33554432
    buffer_load_dwordx4 v[208:211], v7, s[8:11], s58 offen offset:0 sc1
    buffer_load_dwordx4 v[212:215], v7, s[8:11], s58 offen offset:1024 sc1
    buffer_load_dwordx4 v[216:219], v7, s[8:11], s58 offen offset:2048 sc1
    buffer_load_dwordx4 v[220:223], v7, s[8:11], s58 offen offset:3072 sc1
    s_add_u32 s58, s58, 4096
    buffer_load_dwordx4 v[224:227], v7, s[8:11], s58 offen offset:0 sc1
    buffer_load_dwordx4 v[228:231], v7, s[8:11], s58 offen offset:1024 sc1
    buffer_load_dwordx4 v[232:235], v7, s[8:11], s58 offen offset:2048 sc1
    buffer_load_dwordx4 v[236:239], v7, s[8:11], s58 offen offset:3072 sc1
    s_lshl_b32 s58, s57, 5
    s_add_u32 s58, s58, s46
    s_lshl_b32 s58, s58, 11
    s_add_u32 s59, s58, 54525952
    s_add_u32 s58, s58, 50331648
    buffer_load_dwordx4 v[176:179], v10, s[8:11], s58 offen offset:0 sc1
    buffer_load_dwordx4 v[180:183], v10, s[8:11], s58 offen offset:256 sc1
    buffer_load_dwordx4 v[184:187], v10, s[8:11], s58 offen offset:512 sc1
    buffer_load_dwordx4 v[188:191], v10, s[8:11], s58 offen offset:768 sc1
    buffer_load_dwordx4 v[192:195], v10, s[8:11], s58 offen offset:1024 sc1
    buffer_load_dwordx4 v[196:199], v10, s[8:11], s58 offen offset:1280 sc1
    buffer_load_dwordx4 v[200:203], v10, s[8:11], s58 offen offset:1536 sc1
    buffer_load_dwordx4 v[204:207], v10, s[8:11], s58 offen offset:1792 sc1
    buffer_load_dwordx2 v[240:241], v11, s[8:11], s59 offen offset:0 sc1
    buffer_load_dwordx2 v[244:245], v11, s[8:11], s59 offen offset:512 sc1
    buffer_load_dwordx2 v[248:249], v11, s[8:11], s59 offen offset:1024 sc1
    buffer_load_dwordx2 v[252:253], v11, s[8:11], s59 offen offset:1536 sc1
Lnl_1055:
    ds_read_b64_tr_b16 v[16:17], v14 offset:0
    ds_read_b64_tr_b16 v[18:19], v14 offset:256
    ds_read_b64_tr_b16 v[20:21], v14 offset:1024
    ds_read_b64_tr_b16 v[22:23], v14 offset:1280
    ds_read_b64_tr_b16 v[24:25], v14 offset:2048
    ds_read_b64_tr_b16 v[26:27], v14 offset:2304
    ds_read_b64_tr_b16 v[28:29], v14 offset:3072
    ds_read_b64_tr_b16 v[30:31], v14 offset:3328
    s_waitcnt lgkmcnt(6)
    v_mfma_f32_32x32x16_bf16 a[0:15], v[16:19], v[32:35], a[0:15]
    ds_read_b64_tr_b16 v[16:17], v14 offset:4096
    ds_read_b64_tr_b16 v[18:19], v14 offset:4352
    s_waitcnt lgkmcnt(6)
    v_mfma_f32_32x32x16_bf16 a[0:15], v[20:23], v[36:39], a[0:15]
    ds_read_b64_tr_b16 v[20:21], v14 offset:5120
    ds_read_b64_tr_b16 v[22:23], v14 offset:5376
    s_waitcnt lgkmcnt(6)
    v_mfma_f32_32x32x16_bf16 a[16:31], v[24:27], v[32:35], a[16:31]
    ds_read_b64_tr_b16 v[24:25], v14 offset:6144
    ds_read_b64_tr_b16 v[26:27], v14 offset:6400
    s_waitcnt lgkmcnt(6)
    v_mfma_f32_32x32x16_bf16 a[16:31], v[28:31], v[36:39], a[16:31]
    ds_read_b64_tr_b16 v[28:29], v14 offset:7168
    ds_read_b64_tr_b16 v[30:31], v14 offset:7424
    s_waitcnt lgkmcnt(6)
    v_mfma_f32_32x32x16_bf16 a[32:47], v[16:19], v[32:35], a[32:47]
    ds_read_b64_tr_b16 v[16:17], v14 offset:8192
    ds_read_b64_tr_b16 v[18:19], v14 offset:8448
    s_waitcnt lgkmcnt(6)
    v_mfma_f32_32x32x16_bf16 a[32:47], v[20:23], v[36:39], a[32:47]
    ds_read_b64_tr_b16 v[20:21], v14 offset:9216
    ds_read_b64_tr_b16 v[22:23], v14 offset:9472
    s_waitcnt lgkmcnt(6)
    v_mfma_f32_32x32x16_bf16 a[48:63], v[24:27], v[32:35], a[48:63]
    ds_read_b64_tr_b16 v[24:25], v14 offset:10240
    ds_read_b64_tr_b16 v[26:27], v14 offset:10496
    s_waitcnt lgkmcnt(6)
    v_mfma_f32_32x32x16_bf16 a[48:63], v[28:31], v[36:39], a[48:63]
    ds_read_b64_tr_b16 v[28:29], v14 offset:11264
    ds_read_b64_tr_b16 v[30:31], v14 offset:11520
    s_waitcnt lgkmcnt(6)
    v_mfma_f32_32x32x16_bf16 a[64:79], v[16:19], v[32:35], a[64:79]
    ds_read_b64_tr_b16 v[16:17], v14 offset:12288
    ds_read_b64_tr_b16 v[18:19], v14 offset:12544
    s_waitcnt lgkmcnt(6)
    v_mfma_f32_32x32x16_bf16 a[64:79], v[20:23], v[36:39], a[64:79]
    ds_read_b64_tr_b16 v[20:21], v14 offset:13312
    ds_read_b64_tr_b16 v[22:23], v14 offset:13568
    s_waitcnt lgkmcnt(6)
    v_mfma_f32_32x32x16_bf16 a[80:95], v[24:27], v[32:35], a[80:95]
    ds_read_b64_tr_b16 v[24:25], v14 offset:14336
    ds_read_b64_tr_b16 v[26:27], v14 offset:14592
    s_waitcnt lgkmcnt(6)
    v_mfma_f32_32x32x16_bf16 a[80:95], v[28:31], v[36:39], a[80:95]
    ds_read_b64_tr_b16 v[28:29], v14 offset:15360
    ds_read_b64_tr_b16 v[30:31], v14 offset:15616
    s_waitcnt lgkmcnt(6)
    v_mfma_f32_32x32x16_bf16 a[0:15], v[16:19], v[40:43], a[0:15]
    ds_read_b64_tr_b16 v[16:17], v14 offset:16384
    ds_read_b64_tr_b16 v[18:19], v14 offset:16640
    s_waitcnt lgkmcnt(6)
    v_mfma_f32_32x32x16_bf16 a[0:15], v[20:23], v[44:47], a[0:15]
    ds_read_b64_tr_b16 v[20:21], v14 offset:17408
    ds_read_b64_tr_b16 v[22:23], v14 offset:17664
    s_waitcnt lgkmcnt(6)
    v_mfma_f32_32x32x16_bf16 a[16:31], v[24:27], v[40:43], a[16:31]
    ds_read_b64_tr_b16 v[24:25], v14 offset:18432
    ds_read_b64_tr_b16 v[26:27], v14 offset:18688
    s_waitcnt lgkmcnt(6)
    v_mfma_f32_32x32x16_bf16 a[16:31], v[28:31], v[44:47], a[16:31]
    ds_read_b64_tr_b16 v[28:29], v14 offset:19456
    ds_read_b64_tr_b16 v[30:31], v14 offset:19712
    s_waitcnt lgkmcnt(6)
    v_mfma_f32_32x32x16_bf16 a[32:47], v[16:19], v[40:43], a[32:47]
    ds_read_b64_tr_b16 v[16:17], v14 offset:20480
    ds_read_b64_tr_b16 v[18:19], v14 offset:20736
    s_waitcnt lgkmcnt(6)
    v_mfma_f32_32x32x16_bf16 a[32:47], v[20:23], v[44:47], a[32:47]
    ds_read_b64_tr_b16 v[20:21], v14 offset:21504
    ds_read_b64_tr_b16 v[22:23], v14 offset:21760
    s_waitcnt lgkmcnt(6)
    v_mfma_f32_32x32x16_bf16 a[48:63], v[24:27], v[40:43], a[48:63]
    ds_read_b64_tr_b16 v[24:25], v14 offset:22528
    ds_read_b64_tr_b16 v[26:27], v14 offset:22784
    s_waitcnt lgkmcnt(6)
    v_mfma_f32_32x32x16_bf16 a[48:63], v[28:31], v[44:47], a[48:63]
    ds_read_b64_tr_b16 v[28:29], v14 offset:23552
    ds_read_b64_tr_b16 v[30:31], v14 offset:23808
    s_waitcnt lgkmcnt(6)
    v_mfma_f32_32x32x16_bf16 a[64:79], v[16:19], v[40:43], a[64:79]
    ds_read_b64_tr_b16 v[16:17], v14 offset:24576
    ds_read_b64_tr_b16 v[18:19], v14 offset:24832
    s_waitcnt lgkmcnt(6)
    v_mfma_f32_32x32x16_bf16 a[64:79], v[20:23], v[44:47], a[64:79]
    ds_read_b64_tr_b16 v[20:21], v14 offset:25600
    ds_read_b64_tr_b16 v[22:23], v14 offset:25856
    s_waitcnt lgkmcnt(6)
    v_mfma_f32_32x32x16_bf16 a[80:95], v[24:27], v[40:43], a[80:95]
    ds_read_b64_tr_b16 v[24:25], v14 offset:26624
    ds_read_b64_tr_b16 v[26:27], v14 offset:26880
    s_waitcnt lgkmcnt(6)
    v_mfma_f32_32x32x16_bf16 a[80:95], v[28:31], v[44:47], a[80:95]
    ds_read_b64_tr_b16 v[28:29], v14 offset:27648
    ds_read_b64_tr_b16 v[30:31], v14 offset:27904
    s_waitcnt lgkmcnt(6)
    v_mfma_f32_32x32x16_bf16 a[0:15], v[16:19], v[48:51], a[0:15]
    ds_read_b64_tr_b16 v[16:17], v14 offset:28672
    ds_read_b64_tr_b16 v[18:19], v14 offset:28928
    s_waitcnt lgkmcnt(6)
    v_mfma_f32_32x32x16_bf16 a[0:15], v[20:23], v[52:55], a[0:15]
    ds_read_b64_tr_b16 v[20:21], v14 offset:29696
    ds_read_b64_tr_b16 v[22:23], v14 offset:29952
    s_waitcnt lgkmcnt(6)
    v_mfma_f32_32x32x16_bf16 a[16:31], v[24:27], v[48:51], a[16:31]
    ds_read_b64_tr_b16 v[24:25], v14 offset:30720
    ds_read_b64_tr_b16 v[26:27], v14 offset:30976
    s_waitcnt lgkmcnt(6)
    v_mfma_f32_32x32x16_bf16 a[16:31], v[28:31], v[52:55], a[16:31]
    ds_read_b64_tr_b16 v[28:29], v14 offset:31744
    ds_read_b64_tr_b16 v[30:31], v14 offset:32000
    s_waitcnt lgkmcnt(6)
    v_mfma_f32_32x32x16_bf16 a[32:47], v[16:19], v[48:51], a[32:47]
    ds_read_b64_tr_b16 v[16:17], v14 offset:32768
    ds_read_b64_tr_b16 v[18:19], v14 offset:33024
    s_waitcnt lgkmcnt(6)
    v_mfma_f32_32x32x16_bf16 a[32:47], v[20:23], v[52:55], a[32:47]
    ds_read_b64_tr_b16 v[20:21], v14 offset:33792
    ds_read_b64_tr_b16 v[22:23], v14 offset:34048
    s_waitcnt lgkmcnt(6)
    v_mfma_f32_32x32x16_bf16 a[48:63], v[24:27], v[48:51], a[48:63]
    ds_read_b64_tr_b16 v[24:25], v14 offset:34816
    ds_read_b64_tr_b16 v[26:27], v14 offset:35072
    s_waitcnt lgkmcnt(6)
    v_mfma_f32_32x32x16_bf16 a[48:63], v[28:31], v[52:55], a[48:63]
    ds_read_b64_tr_b16 v[28:29], v14 offset:35840
    ds_read_b64_tr_b16 v[30:31], v14 offset:36096
    s_waitcnt lgkmcnt(6)
    v_mfma_f32_32x32x16_bf16 a[64:79], v[16:19], v[48:51], a[64:79]
    ds_read_b64_tr_b16 v[16:17], v14 offset:36864
    ds_read_b64_tr_b16 v[18:19], v14 offset:37120
    s_waitcnt lgkmcnt(6)
    v_mfma_f32_32x32x16_bf16 a[64:79], v[20:23], v[52:55], a[64:79]
    ds_read_b64_tr_b16 v[20:21], v14 offset:37888
    ds_read_b64_tr_b16 v[22:23], v14 offset:38144
    s_waitcnt lgkmcnt(6)
    v_mfma_f32_32x32x16_bf16 a[80:95], v[24:27], v[48:51], a[80:95]
    ds_read_b64_tr_b16 v[24:25], v14 offset:38912
    ds_read_b64_tr_b16 v[26:27], v14 offset:39168
    s_waitcnt lgkmcnt(6)
    v_mfma_f32_32x32x16_bf16 a[80:95], v[28:31], v[52:55], a[80:95]
    ds_read_b64_tr_b16 v[28:29], v14 offset:39936
    ds_read_b64_tr_b16 v[30:31], v14 offset:40192
    s_waitcnt lgkmcnt(6)
    v_mfma_f32_32x32x16_bf16 a[0:15], v[16:19], v[56:59], a[0:15]
    ds_read_b64_tr_b16 v[16:17], v14 offset:40960
    ds_read_b64_tr_b16 v[18:19], v14 offset:41216
    s_waitcnt lgkmcnt(6)
    v_mfma_f32_32x32x16_bf16 a[0:15], v[20:23], v[60:63], a[0:15]
    ds_read_b64_tr_b16 v[20:21], v14 offset:41984
    ds_read_b64_tr_b16 v[22:23], v14 offset:42240
    s_waitcnt lgkmcnt(6)
    v_mfma_f32_32x32x16_bf16 a[16:31], v[24:27], v[56:59], a[16:31]
    ds_read_b64_tr_b16 v[24:25], v14 offset:43008
    ds_read_b64_tr_b16 v[26:27], v14 offset:43264
    s_waitcnt lgkmcnt(6)
    v_mfma_f32_32x32x16_bf16 a[16:31], v[28:31], v[60:63], a[16:31]
    ds_read_b64_tr_b16 v[28:29], v14 offset:44032
    ds_read_b64_tr_b16 v[30:31], v14 offset:44288
    s_waitcnt lgkmcnt(6)
    v_mfma_f32_32x32x16_bf16 a[32:47], v[16:19], v[56:59], a[32:47]
    ds_read_b64_tr_b16 v[16:17], v14 offset:45056
    ds_read_b64_tr_b16 v[18:19], v14 offset:45312
    s_waitcnt lgkmcnt(6)
    v_mfma_f32_32x32x16_bf16 a[32:47], v[20:23], v[60:63], a[32:47]
    ds_read_b64_tr_b16 v[20:21], v14 offset:46080
    ds_read_b64_tr_b16 v[22:23], v14 offset:46336
    s_waitcnt lgkmcnt(6)
    v_mfma_f32_32x32x16_bf16 a[48:63], v[24:27], v[56:59], a[48:63]
    ds_read_b64_tr_b16 v[24:25], v14 offset:47104
    ds_read_b64_tr_b16 v[26:27], v14 offset:47360
    s_waitcnt lgkmcnt(6)
    v_mfma_f32_32x32x16_bf16 a[48:63], v[28:31], v[60:63], a[48:63]
    ds_read_b64_tr_b16 v[28:29], v14 offset:48128
    ds_read_b64_tr_b16 v[30:31], v14 offset:48384
    s_waitcnt lgkmcnt(6)
    v_mfma_f32_32x32x16_bf16 a[64:79], v[16:19], v[56:59], a[64:79]
    s_waitcnt lgkmcnt(4)
    v_mfma_f32_32x32x16_bf16 a[64:79], v[20:23], v[60:63], a[64:79]
    s_waitcnt lgkmcnt(2)
    v_mfma_f32_32x32x16_bf16 a[80:95], v[24:27], v[56:59], a[80:95]
    s_waitcnt lgkmcnt(0)
    v_mfma_f32_32x32x16_bf16 a[80:95], v[28:31], v[60:63], a[80:95]
    s_add_u32 s45, s45, 1
    s_xor_b32 s42, s42, 49152
    s_mul_i32 s32, s45, 147456
    s_mul_i32 s37, s34, 384
    s_add_u32 s32, s32, s37
    s_add_u32 s33, s32, 147456
    s_add_u32 s37, s45, 1
    s_cmp_lt_u32 s37, s47
    s_cselect_b32 s33, s33, 2130706432
    s_cmp_lt_u32 s45, s47
    s_cbranch_scc1 Lattn_1053
    s_mul_i32 s34, s34, 6
    s_lshl_b32 s37, s35, 2
    s_add_u32 s37, s37, s4
    s_mul_i32 s37, s37, 73728
    s_add_u32 s37, s37, s60
    s_lshl_b32 s38, s34, 11
    s_add_u32 s37, s37, s38
    v_lshlrev_b32 v12, 4, v0
    s_nop 7
    v_accvgpr_read_b32 v112, a0
    v_accvgpr_read_b32 v113, a1
    v_accvgpr_read_b32 v114, a2
    v_accvgpr_read_b32 v115, a3
    v_accvgpr_read_b32 v116, a4
    v_accvgpr_read_b32 v117, a5
    v_accvgpr_read_b32 v118, a6
    v_accvgpr_read_b32 v119, a7
    v_accvgpr_read_b32 v120, a8
    v_accvgpr_read_b32 v121, a9
    v_accvgpr_read_b32 v122, a10
    v_accvgpr_read_b32 v123, a11
    v_accvgpr_read_b32 v124, a12
    v_accvgpr_read_b32 v125, a13
    v_accvgpr_read_b32 v126, a14
    v_accvgpr_read_b32 v127, a15
    v_cvt_pk_bf16_f32 v128, v112, v113
    v_cvt_pk_bf16_f32 v129, v114, v115
    v_cvt_pk_bf16_f32 v130, v116, v117
    v_cvt_pk_bf16_f32 v131, v118, v119
    v_cvt_pk_bf16_f32 v132, v120, v121
    v_cvt_pk_bf16_f32 v133, v122, v123
    v_cvt_pk_bf16_f32 v134, v124, v125
    v_cvt_pk_bf16_f32 v135, v126, v127
    buffer_store_dwordx4 v[128:131], v12, s[8:11], s37 offen offset:0 sc1
    buffer_store_dwordx4 v[132:135], v12, s[8:11], s37 offen offset:1024 sc1
    v_accvgpr_read_b32 v136, a16
    v_accvgpr_read_b32 v137, a17
    v_accvgpr_read_b32 v138, a18
    v_accvgpr_read_b32 v139, a19
    v_accvgpr_read_b32 v140, a20
    v_accvgpr_read_b32 v141, a21
    v_accvgpr_read_b32 v142, a22
    v_accvgpr_read_b32 v143, a23
    v_accvgpr_read_b32 v144, a24
    v_accvgpr_read_b32 v145, a25
    v_accvgpr_read_b32 v146, a26
    v_accvgpr_read_b32 v147, a27
    v_accvgpr_read_b32 v148, a28
    v_accvgpr_read_b32 v149, a29
    v_accvgpr_read_b32 v150, a30
    v_accvgpr_read_b32 v151, a31
    v_cvt_pk_bf16_f32 v152, v136, v137
    v_cvt_pk_bf16_f32 v153, v138, v139
    v_cvt_pk_bf16_f32 v154, v140, v141
    v_cvt_pk_bf16_f32 v155, v142, v143
    v_cvt_pk_bf16_f32 v156, v144, v145
    v_cvt_pk_bf16_f32 v157, v146, v147
    v_cvt_pk_bf16_f32 v158, v148, v149
    v_cvt_pk_bf16_f32 v159, v150, v151
    buffer_store_dwordx4 v[152:155], v12, s[8:11], s37 offen offset:2048 sc1
    buffer_store_dwordx4 v[156:159], v12, s[8:11], s37 offen offset:3072 sc1
    s_add_u32 s37, s37, 4096
    v_accvgpr_read_b32 v160, a32
    v_accvgpr_read_b32 v161, a33
    v_accvgpr_read_b32 v162, a34
    v_accvgpr_read_b32 v163, a35
    v_accvgpr_read_b32 v164, a36
    v_accvgpr_read_b32 v165, a37
    v_accvgpr_read_b32 v166, a38
    v_accvgpr_read_b32 v167, a39
    v_accvgpr_read_b32 v168, a40
    v_accvgpr_read_b32 v169, a41
    v_accvgpr_read_b32 v170, a42
    v_accvgpr_read_b32 v171, a43
    v_accvgpr_read_b32 v172, a44
    v_accvgpr_read_b32 v173, a45
    v_accvgpr_read_b32 v174, a46
    v_accvgpr_read_b32 v175, a47
    v_cvt_pk_bf16_f32 v176, v160, v161
    v_cvt_pk_bf16_f32 v177, v162, v163
    v_cvt_pk_bf16_f32 v178, v164, v165
    v_cvt_pk_bf16_f32 v179, v166, v167
    v_cvt_pk_bf16_f32 v180, v168, v169
    v_cvt_pk_bf16_f32 v181, v170, v171
    v_cvt_pk_bf16_f32 v182, v172, v173
    v_cvt_pk_bf16_f32 v183, v174, v175
    buffer_store_dwordx4 v[176:179], v12, s[8:11], s37 offen offset:0 sc1
    buffer_store_dwordx4 v[180:183], v12, s[8:11], s37 offen offset:1024 sc1
    v_accvgpr_read_b32 v184, a48
    v_accvgpr_read_b32 v185, a49
    v_accvgpr_read_b32 v186, a50
    v_accvgpr_read_b32 v187, a51
    v_accvgpr_read_b32 v188, a52
    v_accvgpr_read_b32 v189, a53
    v_accvgpr_read_b32 v190, a54
    v_accvgpr_read_b32 v191, a55
    v_accvgpr_read_b32 v192, a56
    v_accvgpr_read_b32 v193, a57
    v_accvgpr_read_b32 v194, a58
    v_accvgpr_read_b32 v195, a59
    v_accvgpr_read_b32 v196, a60
    v_accvgpr_read_b32 v197, a61
    v_accvgpr_read_b32 v198, a62
    v_accvgpr_read_b32 v199, a63
    v_cvt_pk_bf16_f32 v200, v184, v185
    v_cvt_pk_bf16_f32 v201, v186, v187
    v_cvt_pk_bf16_f32 v202, v188, v189
    v_cvt_pk_bf16_f32 v203, v190, v191
    v_cvt_pk_bf16_f32 v204, v192, v193
    v_cvt_pk_bf16_f32 v205, v194, v195
    v_cvt_pk_bf16_f32 v206, v196, v197
    v_cvt_pk_bf16_f32 v207, v198, v199
    buffer_store_dwordx4 v[200:203], v12, s[8:11], s37 offen offset:2048 sc1
    buffer_store_dwordx4 v[204:207], v12, s[8:11], s37 offen offset:3072 sc1
    s_add_u32 s37, s37, 4096
    v_accvgpr_read_b32 v208, a64
    v_accvgpr_read_b32 v209, a65
    v_accvgpr_read_b32 v210, a66
    v_accvgpr_read_b32 v211, a67
    v_accvgpr_read_b32 v212, a68
    v_accvgpr_read_b32 v213, a69
    v_accvgpr_read_b32 v214, a70
    v_accvgpr_read_b32 v215, a71
    v_accvgpr_read_b32 v216, a72
    v_accvgpr_read_b32 v217, a73
    v_accvgpr_read_b32 v218, a74
    v_accvgpr_read_b32 v219, a75
    v_accvgpr_read_b32 v220, a76
    v_accvgpr_read_b32 v221, a77
    v_accvgpr_read_b32 v222, a78
    v_accvgpr_read_b32 v223, a79
    v_cvt_pk_bf16_f32 v224, v208, v209
    v_cvt_pk_bf16_f32 v225, v210, v211
    v_cvt_pk_bf16_f32 v226, v212, v213
    v_cvt_pk_bf16_f32 v227, v214, v215
    v_cvt_pk_bf16_f32 v228, v216, v217
    v_cvt_pk_bf16_f32 v229, v218, v219
    v_cvt_pk_bf16_f32 v230, v220, v221
    v_cvt_pk_bf16_f32 v231, v222, v223
    buffer_store_dwordx4 v[224:227], v12, s[8:11], s37 offen offset:0 sc1
    buffer_store_dwordx4 v[228:231], v12, s[8:11], s37 offen offset:1024 sc1
    v_accvgpr_read_b32 v232, a80
    v_accvgpr_read_b32 v233, a81
    v_accvgpr_read_b32 v234, a82
    v_accvgpr_read_b32 v235, a83
    v_accvgpr_read_b32 v236, a84
    v_accvgpr_read_b32 v237, a85
    v_accvgpr_read_b32 v238, a86
    v_accvgpr_read_b32 v239, a87
    v_accvgpr_read_b32 v240, a88
    v_accvgpr_read_b32 v241, a89
    v_accvgpr_read_b32 v242, a90
    v_accvgpr_read_b32 v243, a91
    v_accvgpr_read_b32 v244, a92
    v_accvgpr_read_b32 v245, a93
    v_accvgpr_read_b32 v246, a94
    v_accvgpr_read_b32 v247, a95
    v_cvt_pk_bf16_f32 v248, v232, v233
    v_cvt_pk_bf16_f32 v249, v234, v235
    v_cvt_pk_bf16_f32 v250, v236, v237
    v_cvt_pk_bf16_f32 v251, v238, v239
    v_cvt_pk_bf16_f32 v252, v240, v241
    v_cvt_pk_bf16_f32 v253, v242, v243
    v_cvt_pk_bf16_f32 v254, v244, v245
    v_cvt_pk_bf16_f32 v255, v246, v247
    buffer_store_dwordx4 v[248:251], v12, s[8:11], s37 offen offset:2048 sc1
    buffer_store_dwordx4 v[252:255], v12, s[8:11], s37 offen offset:3072 sc1
    s_add_u32 s37, s37, 4096
    s_waitcnt vmcnt(0)
    s_barrier
    s_cmp_lg_u32 s4, 0
    s_cbranch_scc1 Ldn_1056
    s_lshl_b32 s37, s3, 7
    s_add_u32 s37, s37, 60882944
    v_mov_b32 v12, 0
    v_mov_b32 v13, 65536
    s_mov_b64 exec, 1
    buffer_atomic_add v13, v12, s[8:11], s37 offen sc0 sc1
    s_cmp_ge_u32 s3, 14
    s_cselect_b32 s39, 95, 47
    s_waitcnt vmcnt(0)
    v_readfirstlane_b32 s37, v13
    s_mov_b64 exec, -1
    s_lshr_b32 s37, s37, 16
    s_cmp_lg_u32 s37, s39
    s_cbranch_scc1 Ldn_1056
    s_add_u32 s37, s3, 60817440
    v_lshlrev_b32 v12, 7, v0
    v_mov_b32 v13, 1
    s_mov_b32 exec_hi, 0
    buffer_store_byte v13, v12, s[8:11], s37 offen sc1
    s_mov_b64 exec, -1
Ldn_1056:
    s_branch Lqtop_1040
Lqred_1041:
    s_bfe_u32 s34, s61, 0x80010
    s_bfe_u32 s35, s61, 0x80008
    s_and_b32 s45, s61, 0xff
    s_cmp_lg_u32 s4, 0
    s_cbranch_scc1 Lrw2_1061
    v_mov_b32 v14, s3
    s_mov_b32 s44, 0
Lrw_1060:
    buffer_load_ubyte v20, v14, s[8:11], s7 offen offset:48 sc1
    s_add_u32 s44, s44, 1
    s_cmp_gt_u32 s44, 0x100000
    s_cbranch_scc1 Lwdone
    s_waitcnt vmcnt(0)
    v_readfirstlane_b32 s38, v20
    s_nop 0
    s_cmp_lg_u32 s38, 0
    s_cbranch_scc1 Lrw2_1061
    s_sleep 3
    s_branch Lrw_1060
Lrw2_1061:
    s_barrier
    v_lshlrev_b32 v15, 4, v0
Lrq_1057:
    s_mul_i32 s39, s4, 73728
    s_add_u32 s39, s39, s60
    s_lshl_b32 s38, s34, 12
    s_add_u32 s46, s39, s38
    s_lshl_b32 s38, s35, 11
    s_add_u32 s46, s46, s38
    s_mul_i32 s47, s57, 36864
    s_lshl_b32 s38, s34, 6
    s_add_u32 s47, s47, s38
    s_lshl_b32 s38, s35, 5
    s_add_u32 s47, s47, s38
    buffer_load_dwordx2 v[16:17], v8, s[16:19], s47 offen
    buffer_load_dwordx2 v[18:19], v8, s[16:19], s47 offen offset:16
    buffer_load_dwordx4 v[32:35], v15, s[8:11], s46 offen offset:0 sc1
    buffer_load_dwordx4 v[36:39], v15, s[8:11], s46 offen offset:1024 sc1
    s_add_u32 s46, s46, 294912
    buffer_load_dwordx4 v[40:43], v15, s[8:11], s46 offen offset:0 sc1
    buffer_load_dwordx4 v[44:47], v15, s[8:11], s46 offen offset:1024 sc1
    s_add_u32 s46, s46, 294912
    buffer_load_dwordx4 v[48:51], v15, s[8:11], s46 offen offset:0 sc1
    buffer_load_dwordx4 v[52:55], v15, s[8:11], s46 offen offset:1024 sc1
    s_add_u32 s46, s46, 294912
    buffer_load_dwordx4 v[56:59], v15, s[8:11], s46 offen offset:0 sc1
    buffer_load_dwordx4 v[60:63], v15, s[8:11], s46 offen offset:1024 sc1
    s_add_u32 s46, s46, 294912
    buffer_load_dwordx4 v[64:67], v15, s[8:11], s46 offen offset:0 sc1
    buffer_load_dwordx4 v[68:71], v15, s[8:11], s46 offen offset:1024 sc1
    s_add_u32 s46, s46, 294912
    buffer_load_dwordx4 v[72:75], v15, s[8:11], s46 offen offset:0 sc1
    buffer_load_dwordx4 v[76:79], v15, s[8:11], s46 offen offset:1024 sc1
    s_add_u32 s46, s46, 294912
    buffer_load_dwordx4 v[80:83], v15, s[8:11], s46 offen offset:0 sc1
    buffer_load_dwordx4 v[84:87], v15, s[8:11], s46 offen offset:1024 sc1
    s_add_u32 s46, s46, 294912
    buffer_load_dwordx4 v[88:91], v15, s[8:11], s46 offen offset:0 sc1
    buffer_load_dwordx4 v[92:95], v15, s[8:11], s46 offen offset:1024 sc1
    s_add_u32 s46, s46, 294912
    buffer_load_dwordx4 v[96:99], v15, s[8:11], s46 offen offset:0 sc1
    buffer_load_dwordx4 v[100:103], v15, s[8:11], s46 offen offset:1024 sc1
    s_add_u32 s46, s46, 294912
    buffer_load_dwordx4 v[104:107], v15, s[8:11], s46 offen offset:0 sc1
    buffer_load_dwordx4 v[108:111], v15, s[8:11], s46 offen offset:1024 sc1
    s_add_u32 s46, s46, 294912
    buffer_load_dwordx4 v[112:115], v15, s[8:11], s46 offen offset:0 sc1
    buffer_load_dwordx4 v[116:119], v15, s[8:11], s46 offen offset:1024 sc1
    s_add_u32 s46, s46, 294912
    buffer_load_dwordx4 v[120:123], v15, s[8:11], s46 offen offset:0 sc1
    buffer_load_dwordx4 v[124:127], v15, s[8:11], s46 offen offset:1024 sc1
    s_add_u32 s46, s46, 294912
    buffer_load_dwordx4 v[128:131], v15, s[8:11], s46 offen offset:0 sc1
    buffer_load_dwordx4 v[132:135], v15, s[8:11], s46 offen offset:1024 sc1
    s_add_u32 s46, s46, 294912
    buffer_load_dwordx4 v[136:139], v15, s[8:11], s46 offen offset:0 sc1
    buffer_load_dwordx4 v[140:143], v15, s[8:11], s46 offen offset:1024 sc1
    s_add_u32 s46, s46, 294912
    s_waitcnt vmcnt(28)
    v_lshlrev_b32 v24, 16, v16
    v_and_b32 v25, 0xffff0000, v16
    v_lshlrev_b32 v26, 16, v17
    v_and_b32 v27, 0xffff0000, v17
    v_lshlrev_b32 v28, 16, v18
    v_and_b32 v29, 0xffff0000, v18
    v_lshlrev_b32 v30, 16, v19
    v_and_b32 v31, 0xffff0000, v19
    s_waitcnt vmcnt(26)
    v_pk_add_f32 v[24:25], v[24:25], v[32:33]
    v_pk_add_f32 v[26:27], v[26:27], v[34:35]
    v_pk_add_f32 v[28:29], v[28:29], v[36:37]
    v_pk_add_f32 v[30:31], v[30:31], v[38:39]
    s_waitcnt vmcnt(24)
    v_pk_add_f32 v[24:25], v[24:25], v[40:41]
    v_pk_add_f32 v[26:27], v[26:27], v[42:43]
    v_pk_add_f32 v[28:29], v[28:29], v[44:45]
    v_pk_add_f32 v[30:31], v[30:31], v[46:47]
    s_waitcnt vmcnt(22)
    v_pk_add_f32 v[24:25], v[24:25], v[48:49]
    v_pk_add_f32 v[26:27], v[26:27], v[50:51]
    v_pk_add_f32 v[28:29], v[28:29], v[52:53]
    v_pk_add_f32 v[30:31], v[30:31], v[54:55]
    s_waitcnt vmcnt(20)
    v_pk_add_f32 v[24:25], v[24:25], v[56:57]
    v_pk_add_f32 v[26:27], v[26:27], v[58:59]
    v_pk_add_f32 v[28:29], v[28:29], v[60:61]
    v_pk_add_f32 v[30:31], v[30:31], v[62:63]
    s_waitcnt vmcnt(18)
    v_pk_add_f32 v[24:25], v[24:25], v[64:65]
    v_pk_add_f32 v[26:27], v[26:27], v[66:67]
    v_pk_add_f32 v[28:29], v[28:29], v[68:69]
    v_pk_add_f32 v[30:31], v[30:31], v[70:71]
    s_waitcnt vmcnt(16)
    v_pk_add_f32 v[24:25], v[24:25], v[72:73]
    v_pk_add_f32 v[26:27], v[26:27], v[74:75]
    v_pk_add_f32 v[28:29], v[28:29], v[76:77]
    v_pk_add_f32 v[30:31], v[30:31], v[78:79]
    s_waitcnt vmcnt(14)
    v_pk_add_f32 v[24:25], v[24:25], v[80:81]
    v_pk_add_f32 v[26:27], v[26:27], v[82:83]
    v_pk_add_f32 v[28:29], v[28:29], v[84:85]
    v_pk_add_f32 v[30:31], v[30:31], v[86:87]
    s_waitcnt vmcnt(12)
    v_pk_add_f32 v[24:25], v[24:25], v[88:89]
    v_pk_add_f32 v[26:27], v[26:27], v[90:91]
    v_pk_add_f32 v[28:29], v[28:29], v[92:93]
    v_pk_add_f32 v[30:31], v[30:31], v[94:95]
    s_waitcnt vmcnt(10)
    v_pk_add_f32 v[24:25], v[24:25], v[96:97]
    v_pk_add_f32 v[26:27], v[26:27], v[98:99]
    v_pk_add_f32 v[28:29], v[28:29], v[100:101]
    v_pk_add_f32 v[30:31], v[30:31], v[102:103]
    s_waitcnt vmcnt(8)
    v_pk_add_f32 v[24:25], v[24:25], v[104:105]
    v_pk_add_f32 v[26:27], v[26:27], v[106:107]
    v_pk_add_f32 v[28:29], v[28:29], v[108:109]
    v_pk_add_f32 v[30:31], v[30:31], v[110:111]
    s_waitcnt vmcnt(6)
    v_pk_add_f32 v[24:25], v[24:25], v[112:113]
    v_pk_add_f32 v[26:27], v[26:27], v[114:115]
    v_pk_add_f32 v[28:29], v[28:29], v[116:117]
    v_pk_add_f32 v[30:31], v[30:31], v[118:119]
    s_waitcnt vmcnt(4)
    v_pk_add_f32 v[24:25], v[24:25], v[120:121]
    v_pk_add_f32 v[26:27], v[26:27], v[122:123]
    v_pk_add_f32 v[28:29], v[28:29], v[124:125]
    v_pk_add_f32 v[30:31], v[30:31], v[126:127]
    s_waitcnt vmcnt(2)
    v_pk_add_f32 v[24:25], v[24:25], v[128:129]
    v_pk_add_f32 v[26:27], v[26:27], v[130:131]
    v_pk_add_f32 v[28:29], v[28:29], v[132:133]
    v_pk_add_f32 v[30:31], v[30:31], v[134:135]
    s_waitcnt vmcnt(0)
    v_pk_add_f32 v[24:25], v[24:25], v[136:137]
    v_pk_add_f32 v[26:27], v[26:27], v[138:139]
    v_pk_add_f32 v[28:29], v[28:29], v[140:141]
    v_pk_add_f32 v[30:31], v[30:31], v[142:143]
    s_cmp_lt_u32 s3, 12
    s_cbranch_scc1 Lrfin_1059
    s_lshl_b32 s38, s34, 11
    s_add_u32 s46, s39, s38
    s_lshl_b32 s38, s35, 10
    s_add_u32 s46, s46, s38
    s_add_u32 s46, s46, 4128768
    s_cmp_lg_u32 s4, 0
    s_cbranch_scc1 Lrw2_1063
    v_mov_b32 v14, s3
    s_mov_b32 s44, 0
Lrw_1062:
    buffer_load_ubyte v20, v14, s[8:11], s7 offen offset:32 sc1
    s_add_u32 s44, s44, 1
    s_cmp_gt_u32 s44, 0x100000
    s_cbranch_scc1 Lwdone
    s_waitcnt vmcnt(0)
    v_readfirstlane_b32 s38, v20
    s_nop 0
    s_cmp_lg_u32 s38, 0
    s_cbranch_scc1 Lrw2_1063
    s_sleep 3
    s_branch Lrw_1062
Lrw2_1063:
    s_barrier
    v_mov_b32 v20, 0x00003f80
    v_mov_b32 v21, 0x3f800000
    s_cmp_ge_u32 s3, 14
    s_cbranch_scc1 Lrbig_1058
    buffer_load_dwordx4 v[32:35], v15, s[8:11], s46 offen sc1
    s_add_u32 s46, s46, 294912
    buffer_load_dwordx4 v[36:39], v15, s[8:11], s46 offen sc1
    s_add_u32 s46, s46, 294912
    buffer_load_dwordx4 v[40:43], v15, s[8:11], s46 offen sc1
    s_add_u32 s46, s46, 294912
    buffer_load_dwordx4 v[44:47], v15, s[8:11], s46 offen sc1
    s_add_u32 s46, s46, 294912
    buffer_load_dwordx4 v[48:51], v15, s[8:11], s46 offen sc1
    s_add_u32 s46, s46, 294912
    buffer_load_dwordx4 v[52:55], v15, s[8:11], s46 offen sc1
    s_add_u32 s46, s46, 294912
    buffer_load_dwordx4 v[56:59], v15, s[8:11], s46 offen sc1
    s_add_u32 s46, s46, 294912
    buffer_load_dwordx4 v[60:63], v15, s[8:11], s46 offen sc1
    s_add_u32 s46, s46, 294912
    buffer_load_dwordx4 v[64:67], v15, s[8:11], s46 offen sc1
    s_add_u32 s46, s46, 294912
    buffer_load_dwordx4 v[68:71], v15, s[8:11], s46 offen sc1
    s_add_u32 s46, s46, 294912
    buffer_load_dwordx4 v[72:75], v15, s[8:11], s46 offen sc1
    s_add_u32 s46, s46, 294912
    buffer_load_dwordx4 v[76:79], v15, s[8:11], s46 offen sc1
    s_add_u32 s46, s46, 294912
    buffer_load_dwordx4 v[80:83], v15, s[8:11], s46 offen sc1
    s_add_u32 s46, s46, 294912
    buffer_load_dwordx4 v[84:87], v15, s[8:11], s46 offen sc1
    s_add_u32 s46, s46, 294912
    buffer_load_dwordx4 v[88:91], v15, s[8:11], s46 offen sc1
    s_add_u32 s46, s46, 294912
    buffer_load_dwordx4 v[92:95], v15, s[8:11], s46 offen sc1
    s_add_u32 s46, s46, 294912
    s_waitcnt vmcnt(15)
    v_dot2c_f32_bf16 v24, v32, v20
    v_dot2c_f32_bf16 v25, v32, v21
    v_dot2c_f32_bf16 v26, v33, v20
    v_dot2c_f32_bf16 v27, v33, v21
    v_dot2c_f32_bf16 v28, v34, v20
    v_dot2c_f32_bf16 v29, v34, v21
    v_dot2c_f32_bf16 v30, v35, v20
    v_dot2c_f32_bf16 v31, v35, v21
    s_waitcnt vmcnt(14)
    v_dot2c_f32_bf16 v24, v36, v20
    v_dot2c_f32_bf16 v25, v36, v21
    v_dot2c_f32_bf16 v26, v37, v20
    v_dot2c_f32_bf16 v27, v37, v21
    v_dot2c_f32_bf16 v28, v38, v20
    v_dot2c_f32_bf16 v29, v38, v21
    v_dot2c_f32_bf16 v30, v39, v20
    v_dot2c_f32_bf16 v31, v39, v21
    s_waitcnt vmcnt(13)
    v_dot2c_f32_bf16 v24, v40, v20
    v_dot2c_f32_bf16 v25, v40, v21
    v_dot2c_f32_bf16 v26, v41, v20
    v_dot2c_f32_bf16 v27, v41, v21
    v_dot2c_f32_bf16 v28, v42, v20
    v_dot2c_f32_bf16 v29, v42, v21
    v_dot2c_f32_bf16 v30, v43, v20
    v_dot2c_f32_bf16 v31, v43, v21
    s_waitcnt vmcnt(12)
    v_dot2c_f32_bf16 v24, v44, v20
    v_dot2c_f32_bf16 v25, v44, v21
    v_dot2c_f32_bf16 v26, v45, v20
    v_dot2c_f32_bf16 v27, v45, v21
    v_dot2c_f32_bf16 v28, v46, v20
    v_dot2c_f32_bf16 v29, v46, v21
    v_dot2c_f32_bf16 v30, v47, v20
    v_dot2c_f32_bf16 v31, v47, v21
    s_waitcnt vmcnt(11)
    v_dot2c_f32_bf16 v24, v48, v20
    v_dot2c_f32_bf16 v25, v48, v21
    v_dot2c_f32_bf16 v26, v49, v20
    v_dot2c_f32_bf16 v27, v49, v21
    v_dot2c_f32_bf16 v28, v50, v20
    v_dot2c_f32_bf16 v29, v50, v21
    v_dot2c_f32_bf16 v30, v51, v20
    v_dot2c_f32_bf16 v31, v51, v21
    s_waitcnt vmcnt(10)
    v_dot2c_f32_bf16 v24, v52, v20
    v_dot2c_f32_bf16 v25, v52, v21
    v_dot2c_f32_bf16 v26, v53, v20
    v_dot2c_f32_bf16 v27, v53, v21
    v_dot2c_f32_bf16 v28, v54, v20
    v_dot2c_f32_bf16 v29, v54, v21
    v_dot2c_f32_bf16 v30, v55, v20
    v_dot2c_f32_bf16 v31, v55, v21
    s_waitcnt vmcnt(9)
    v_dot2c_f32_bf16 v24, v56, v20
    v_dot2c_f32_bf16 v25, v56, v21
    v_dot2c_f32_bf16 v26, v57, v20
    v_dot2c_f32_bf16 v27, v57, v21
    v_dot2c_f32_bf16 v28, v58, v20
    v_dot2c_f32_bf16 v29, v58, v21
    v_dot2c_f32_bf16 v30, v59, v20
    v_dot2c_f32_bf16 v31, v59, v21
    s_waitcnt vmcnt(8)
    v_dot2c_f32_bf16 v24, v60, v20
    v_dot2c_f32_bf16 v25, v60, v21
    v_dot2c_f32_bf16 v26, v61, v20
    v_dot2c_f32_bf16 v27, v61, v21
    v_dot2c_f32_bf16 v28, v62, v20
    v_dot2c_f32_bf16 v29, v62, v21
    v_dot2c_f32_bf16 v30, v63, v20
    v_dot2c_f32_bf16 v31, v63, v21
    s_waitcnt vmcnt(7)
    v_dot2c_f32_bf16 v24, v64, v20
    v_dot2c_f32_bf16 v25, v64, v21
    v_dot2c_f32_bf16 v26, v65, v20
    v_dot2c_f32_bf16 v27, v65, v21
    v_dot2c_f32_bf16 v28, v66, v20
    v_dot2c_f32_bf16 v29, v66, v21
    v_dot2c_f32_bf16 v30, v67, v20
    v_dot2c_f32_bf16 v31, v67, v21
    s_waitcnt vmcnt(6)
    v_dot2c_f32_bf16 v24, v68, v20
    v_dot2c_f32_bf16 v25, v68, v21
    v_dot2c_f32_bf16 v26, v69, v20
    v_dot2c_f32_bf16 v27, v69, v21
    v_dot2c_f32_bf16 v28, v70, v20
    v_dot2c_f32_bf16 v29, v70, v21
    v_dot2c_f32_bf16 v30, v71, v20
    v_dot2c_f32_bf16 v31, v71, v21
    s_waitcnt vmcnt(5)
    v_dot2c_f32_bf16 v24, v72, v20
    v_dot2c_f32_bf16 v25, v72, v21
    v_dot2c_f32_bf16 v26, v73, v20
    v_dot2c_f32_bf16 v27, v73, v21
    v_dot2c_f32_bf16 v28, v74, v20
    v_dot2c_f32_bf16 v29, v74, v21
    v_dot2c_f32_bf16 v30, v75, v20
    v_dot2c_f32_bf16 v31, v75, v21
    s_waitcnt vmcnt(4)
    v_dot2c_f32_bf16 v24, v76, v20
    v_dot2c_f32_bf16 v25, v76, v21
    v_dot2c_f32_bf16 v26, v77, v20
    v_dot2c_f32_bf16 v27, v77, v21
    v_dot2c_f32_bf16 v28, v78, v20
    v_dot2c_f32_bf16 v29, v78, v21
    v_dot2c_f32_bf16 v30, v79, v20
    v_dot2c_f32_bf16 v31, v79, v21
    s_waitcnt vmcnt(3)
    v_dot2c_f32_bf16 v24, v80, v20
    v_dot2c_f32_bf16 v25, v80, v21
    v_dot2c_f32_bf16 v26, v81, v20
    v_dot2c_f32_bf16 v27, v81, v21
    v_dot2c_f32_bf16 v28, v82, v20
    v_dot2c_f32_bf16 v29, v82, v21
    v_dot2c_f32_bf16 v30, v83, v20
    v_dot2c_f32_bf16 v31, v83, v21
    s_waitcnt vmcnt(2)
    v_dot2c_f32_bf16 v24, v84, v20
    v_dot2c_f32_bf16 v25, v84, v21
    v_dot2c_f32_bf16 v26, v85, v20
    v_dot2c_f32_bf16 v27, v85, v21
    v_dot2c_f32_bf16 v28, v86, v20
    v_dot2c_f32_bf16 v29, v86, v21
    v_dot2c_f32_bf16 v30, v87, v20
    v_dot2c_f32_bf16 v31, v87, v21
    s_waitcnt vmcnt(1)
    v_dot2c_f32_bf16 v24, v88, v20
    v_dot2c_f32_bf16 v25, v88, v21
    v_dot2c_f32_bf16 v26, v89, v20
    v_dot2c_f32_bf16 v27, v89, v21
    v_dot2c_f32_bf16 v28, v90, v20
    v_dot2c_f32_bf16 v29, v90, v21
    v_dot2c_f32_bf16 v30, v91, v20
    v_dot2c_f32_bf16 v31, v91, v21
    s_waitcnt vmcnt(0)
    v_dot2c_f32_bf16 v24, v92, v20
    v_dot2c_f32_bf16 v25, v92, v21
    v_dot2c_f32_bf16 v26, v93, v20
    v_dot2c_f32_bf16 v27, v93, v21
    v_dot2c_f32_bf16 v28, v94, v20
    v_dot2c_f32_bf16 v29, v94, v21
    v_dot2c_f32_bf16 v30, v95, v20
    v_dot2c_f32_bf16 v31, v95, v21
    s_nop 2
    s_branch Lrfin_1059
Lrbig_1058:
    buffer_load_dwordx4 v[32:35], v15, s[8:11], s46 offen sc1
    s_add_u32 s46, s46, 294912
    buffer_load_dwordx4 v[36:39], v15, s[8:11], s46 offen sc1
    s_add_u32 s46, s46, 294912
    buffer_load_dwordx4 v[40:43], v15, s[8:11], s46 offen sc1
    s_add_u32 s46, s46, 294912
    buffer_load_dwordx4 v[44:47], v15, s[8:11], s46 offen sc1
    s_add_u32 s46, s46, 294912
    buffer_load_dwordx4 v[48:51], v15, s[8:11], s46 offen sc1
    s_add_u32 s46, s46, 294912
    buffer_load_dwordx4 v[52:55], v15, s[8:11], s46 offen sc1
    s_add_u32 s46, s46, 294912
    buffer_load_dwordx4 v[56:59], v15, s[8:11], s46 offen sc1
    s_add_u32 s46, s46, 294912
    buffer_load_dwordx4 v[60:63], v15, s[8:11], s46 offen sc1
    s_add_u32 s46, s46, 294912
    buffer_load_dwordx4 v[64:67], v15, s[8:11], s46 offen sc1
    s_add_u32 s46, s46, 294912
    buffer_load_dwordx4 v[68:71], v15, s[8:11], s46 offen sc1
    s_add_u32 s46, s46, 294912
    buffer_load_dwordx4 v[72:75], v15, s[8:11], s46 offen sc1
    s_add_u32 s46, s46, 294912
    buffer_load_dwordx4 v[76:79], v15, s[8:11], s46 offen sc1
    s_add_u32 s46, s46, 294912
    buffer_load_dwordx4 v[80:83], v15, s[8:11], s46 offen sc1
    s_add_u32 s46, s46, 294912
    buffer_load_dwordx4 v[84:87], v15, s[8:11], s46 offen sc1
    s_add_u32 s46, s46, 294912
    buffer_load_dwordx4 v[88:91], v15, s[8:11], s46 offen sc1
    s_add_u32 s46, s46, 294912
    buffer_load_dwordx4 v[92:95], v15, s[8:11], s46 offen sc1
    s_add_u32 s46, s46, 294912
    buffer_load_dwordx4 v[96:99], v15, s[8:11], s46 offen sc1
    s_add_u32 s46, s46, 294912
    buffer_load_dwordx4 v[100:103], v15, s[8:11], s46 offen sc1
    s_add_u32 s46, s46, 294912
    buffer_load_dwordx4 v[104:107], v15, s[8:11], s46 offen sc1
    s_add_u32 s46, s46, 294912
    buffer_load_dwordx4 v[108:111], v15, s[8:11], s46 offen sc1
    s_add_u32 s46, s46, 294912
    buffer_load_dwordx4 v[112:115], v15, s[8:11], s46 offen sc1
    s_add_u32 s46, s46, 294912
    buffer_load_dwordx4 v[116:119], v15, s[8:11], s46 offen sc1
    s_add_u32 s46, s46, 294912
    buffer_load_dwordx4 v[120:123], v15, s[8:11], s46 offen sc1
    s_add_u32 s46, s46, 294912
    buffer_load_dwordx4 v[124:127], v15, s[8:11], s46 offen sc1
    s_add_u32 s46, s46, 294912
    buffer_load_dwordx4 v[128:131], v15, s[8:11], s46 offen sc1
    s_add_u32 s46, s46, 294912
    buffer_load_dwordx4 v[132:135], v15, s[8:11], s46 offen sc1
    s_add_u32 s46, s46, 294912
    buffer_load_dwordx4 v[136:139], v15, s[8:11], s46 offen sc1
    s_add_u32 s46, s46, 294912
    buffer_load_dwordx4 v[140:143], v15, s[8:11], s46 offen sc1
    s_add_u32 s46, s46, 294912
    buffer_load_dwordx4 v[144:147], v15, s[8:11], s46 offen sc1
    s_add_u32 s46, s46, 294912
    buffer_load_dwordx4 v[148:151], v15, s[8:11], s46 offen sc1
    s_add_u32 s46, s46, 294912
    buffer_load_dwordx4 v[152:155], v15, s[8:11], s46 offen sc1
    s_add_u32 s46, s46, 294912
    buffer_load_dwordx4 v[156:159], v15, s[8:11], s46 offen sc1
    s_add_u32 s46, s46, 294912
    s_waitcnt vmcnt(31)
    v_dot2c_f32_bf16 v24, v32, v20
    v_dot2c_f32_bf16 v25, v32, v21
    v_dot2c_f32_bf16 v26, v33, v20
    v_dot2c_f32_bf16 v27, v33, v21
    v_dot2c_f32_bf16 v28, v34, v20
    v_dot2c_f32_bf16 v29, v34, v21
    v_dot2c_f32_bf16 v30, v35, v20
    v_dot2c_f32_bf16 v31, v35, v21
    s_waitcnt vmcnt(30)
    v_dot2c_f32_bf16 v24, v36, v20
    v_dot2c_f32_bf16 v25, v36, v21
    v_dot2c_f32_bf16 v26, v37, v20
    v_dot2c_f32_bf16 v27, v37, v21
    v_dot2c_f32_bf16 v28, v38, v20
    v_dot2c_f32_bf16 v29, v38, v21
    v_dot2c_f32_bf16 v30, v39, v20
    v_dot2c_f32_bf16 v31, v39, v21
    s_waitcnt vmcnt(29)
    v_dot2c_f32_bf16 v24, v40, v20
    v_dot2c_f32_bf16 v25, v40, v21
    v_dot2c_f32_bf16 v26, v41, v20
    v_dot2c_f32_bf16 v27, v41, v21
    v_dot2c_f32_bf16 v28, v42, v20
    v_dot2c_f32_bf16 v29, v42, v21
    v_dot2c_f32_bf16 v30, v43, v20
    v_dot2c_f32_bf16 v31, v43, v21
    s_waitcnt vmcnt(28)
    v_dot2c_f32_bf16 v24, v44, v20
    v_dot2c_f32_bf16 v25, v44, v21
    v_dot2c_f32_bf16 v26, v45, v20
    v_dot2c_f32_bf16 v27, v45, v21
    v_dot2c_f32_bf16 v28, v46, v20
    v_dot2c_f32_bf16 v29, v46, v21
    v_dot2c_f32_bf16 v30, v47, v20
    v_dot2c_f32_bf16 v31, v47, v21
    s_waitcnt vmcnt(27)
    v_dot2c_f32_bf16 v24, v48, v20
    v_dot2c_f32_bf16 v25, v48, v21
    v_dot2c_f32_bf16 v26, v49, v20
    v_dot2c_f32_bf16 v27, v49, v21
    v_dot2c_f32_bf16 v28, v50, v20
    v_dot2c_f32_bf16 v29, v50, v21
    v_dot2c_f32_bf16 v30, v51, v20
    v_dot2c_f32_bf16 v31, v51, v21
    s_waitcnt vmcnt(26)
    v_dot2c_f32_bf16 v24, v52, v20
    v_dot2c_f32_bf16 v25, v52, v21
    v_dot2c_f32_bf16 v26, v53, v20
    v_dot2c_f32_bf16 v27, v53, v21
    v_dot2c_f32_bf16 v28, v54, v20
    v_dot2c_f32_bf16 v29, v54, v21
    v_dot2c_f32_bf16 v30, v55, v20
    v_dot2c_f32_bf16 v31, v55, v21
    s_waitcnt vmcnt(25)
    v_dot2c_f32_bf16 v24, v56, v20
    v_dot2c_f32_bf16 v25, v56, v21
    v_dot2c_f32_bf16 v26, v57, v20
    v_dot2c_f32_bf16 v27, v57, v21
    v_dot2c_f32_bf16 v28, v58, v20
    v_dot2c_f32_bf16 v29, v58, v21
    v_dot2c_f32_bf16 v30, v59, v20
    v_dot2c_f32_bf16 v31, v59, v21
    s_waitcnt vmcnt(24)
    v_dot2c_f32_bf16 v24, v60, v20
    v_dot2c_f32_bf16 v25, v60, v21
    v_dot2c_f32_bf16 v26, v61, v20
    v_dot2c_f32_bf16 v27, v61, v21
    v_dot2c_f32_bf16 v28, v62, v20
    v_dot2c_f32_bf16 v29, v62, v21
    v_dot2c_f32_bf16 v30, v63, v20
    v_dot2c_f32_bf16 v31, v63, v21
    s_waitcnt vmcnt(23)
    v_dot2c_f32_bf16 v24, v64, v20
    v_dot2c_f32_bf16 v25, v64, v21
    v_dot2c_f32_bf16 v26, v65, v20
    v_dot2c_f32_bf16 v27, v65, v21
    v_dot2c_f32_bf16 v28, v66, v20
    v_dot2c_f32_bf16 v29, v66, v21
    v_dot2c_f32_bf16 v30, v67, v20
    v_dot2c_f32_bf16 v31, v67, v21
    s_waitcnt vmcnt(22)
    v_dot2c_f32_bf16 v24, v68, v20
    v_dot2c_f32_bf16 v25, v68, v21
    v_dot2c_f32_bf16 v26, v69, v20
    v_dot2c_f32_bf16 v27, v69, v21
    v_dot2c_f32_bf16 v28, v70, v20
    v_dot2c_f32_bf16 v29, v70, v21
    v_dot2c_f32_bf16 v30, v71, v20
    v_dot2c_f32_bf16 v31, v71, v21
    s_waitcnt vmcnt(21)
    v_dot2c_f32_bf16 v24, v72, v20
    v_dot2c_f32_bf16 v25, v72, v21
    v_dot2c_f32_bf16 v26, v73, v20
    v_dot2c_f32_bf16 v27, v73, v21
    v_dot2c_f32_bf16 v28, v74, v20
    v_dot2c_f32_bf16 v29, v74, v21
    v_dot2c_f32_bf16 v30, v75, v20
    v_dot2c_f32_bf16 v31, v75, v21
    s_waitcnt vmcnt(20)
    v_dot2c_f32_bf16 v24, v76, v20
    v_dot2c_f32_bf16 v25, v76, v21
    v_dot2c_f32_bf16 v26, v77, v20
    v_dot2c_f32_bf16 v27, v77, v21
    v_dot2c_f32_bf16 v28, v78, v20
    v_dot2c_f32_bf16 v29, v78, v21
    v_dot2c_f32_bf16 v30, v79, v20
    v_dot2c_f32_bf16 v31, v79, v21
    s_waitcnt vmcnt(19)
    v_dot2c_f32_bf16 v24, v80, v20
    v_dot2c_f32_bf16 v25, v80, v21
    v_dot2c_f32_bf16 v26, v81, v20
    v_dot2c_f32_bf16 v27, v81, v21
    v_dot2c_f32_bf16 v28, v82, v20
    v_dot2c_f32_bf16 v29, v82, v21
    v_dot2c_f32_bf16 v30, v83, v20
    v_dot2c_f32_bf16 v31, v83, v21
    s_waitcnt vmcnt(18)
    v_dot2c_f32_bf16 v24, v84, v20
    v_dot2c_f32_bf16 v25, v84, v21
    v_dot2c_f32_bf16 v26, v85, v20
    v_dot2c_f32_bf16 v27, v85, v21
    v_dot2c_f32_bf16 v28, v86, v20
    v_dot2c_f32_bf16 v29, v86, v21
    v_dot2c_f32_bf16 v30, v87, v20
    v_dot2c_f32_bf16 v31, v87, v21
    s_waitcnt vmcnt(17)
    v_dot2c_f32_bf16 v24, v88, v20
    v_dot2c_f32_bf16 v25, v88, v21
    v_dot2c_f32_bf16 v26, v89, v20
    v_dot2c_f32_bf16 v27, v89, v21
    v_dot2c_f32_bf16 v28, v90, v20
    v_dot2c_f32_bf16 v29, v90, v21
    v_dot2c_f32_bf16 v30, v91, v20
    v_dot2c_f32_bf16 v31, v91, v21
    s_waitcnt vmcnt(16)
    v_dot2c_f32_bf16 v24, v92, v20
    v_dot2c_f32_bf16 v25, v92, v21
    v_dot2c_f32_bf16 v26, v93, v20
    v_dot2c_f32_bf16 v27, v93, v21
    v_dot2c_f32_bf16 v28, v94, v20
    v_dot2c_f32_bf16 v29, v94, v21
    v_dot2c_f32_bf16 v30, v95, v20
    v_dot2c_f32_bf16 v31, v95, v21
    s_waitcnt vmcnt(15)
    v_dot2c_f32_bf16 v24, v96, v20
    v_dot2c_f32_bf16 v25, v96, v21
    v_dot2c_f32_bf16 v26, v97, v20
    v_dot2c_f32_bf16 v27, v97, v21
    v_dot2c_f32_bf16 v28, v98, v20
    v_dot2c_f32_bf16 v29, v98, v21
    v_dot2c_f32_bf16 v30, v99, v20
    v_dot2c_f32_bf16 v31, v99, v21
    s_waitcnt vmcnt(14)
    v_dot2c_f32_bf16 v24, v100, v20
    v_dot2c_f32_bf16 v25, v100, v21
    v_dot2c_f32_bf16 v26, v101, v20
    v_dot2c_f32_bf16 v27, v101, v21
    v_dot2c_f32_bf16 v28, v102, v20
    v_dot2c_f32_bf16 v29, v102, v21
    v_dot2c_f32_bf16 v30, v103, v20
    v_dot2c_f32_bf16 v31, v103, v21
    s_waitcnt vmcnt(13)
    v_dot2c_f32_bf16 v24, v104, v20
    v_dot2c_f32_bf16 v25, v104, v21
    v_dot2c_f32_bf16 v26, v105, v20
    v_dot2c_f32_bf16 v27, v105, v21
    v_dot2c_f32_bf16 v28, v106, v20
    v_dot2c_f32_bf16 v29, v106, v21
    v_dot2c_f32_bf16 v30, v107, v20
    v_dot2c_f32_bf16 v31, v107, v21
    s_waitcnt vmcnt(12)
    v_dot2c_f32_bf16 v24, v108, v20
    v_dot2c_f32_bf16 v25, v108, v21
    v_dot2c_f32_bf16 v26, v109, v20
    v_dot2c_f32_bf16 v27, v109, v21
    v_dot2c_f32_bf16 v28, v110, v20
    v_dot2c_f32_bf16 v29, v110, v21
    v_dot2c_f32_bf16 v30, v111, v20
    v_dot2c_f32_bf16 v31, v111, v21
    s_waitcnt vmcnt(11)
    v_dot2c_f32_bf16 v24, v112, v20
    v_dot2c_f32_bf16 v25, v112, v21
    v_dot2c_f32_bf16 v26, v113, v20
    v_dot2c_f32_bf16 v27, v113, v21
    v_dot2c_f32_bf16 v28, v114, v20
    v_dot2c_f32_bf16 v29, v114, v21
    v_dot2c_f32_bf16 v30, v115, v20
    v_dot2c_f32_bf16 v31, v115, v21
    s_waitcnt vmcnt(10)
    v_dot2c_f32_bf16 v24, v116, v20
    v_dot2c_f32_bf16 v25, v116, v21
    v_dot2c_f32_bf16 v26, v117, v20
    v_dot2c_f32_bf16 v27, v117, v21
    v_dot2c_f32_bf16 v28, v118, v20
    v_dot2c_f32_bf16 v29, v118, v21
    v_dot2c_f32_bf16 v30, v119, v20
    v_dot2c_f32_bf16 v31, v119, v21
    s_waitcnt vmcnt(9)
    v_dot2c_f32_bf16 v24, v120, v20
    v_dot2c_f32_bf16 v25, v120, v21
    v_dot2c_f32_bf16 v26, v121, v20
    v_dot2c_f32_bf16 v27, v121, v21
    v_dot2c_f32_bf16 v28, v122, v20
    v_dot2c_f32_bf16 v29, v122, v21
    v_dot2c_f32_bf16 v30, v123, v20
    v_dot2c_f32_bf16 v31, v123, v21
    s_waitcnt vmcnt(8)
    v_dot2c_f32_bf16 v24, v124, v20
    v_dot2c_f32_bf16 v25, v124, v21
    v_dot2c_f32_bf16 v26, v125, v20
    v_dot2c_f32_bf16 v27, v125, v21
    v_dot2c_f32_bf16 v28, v126, v20
    v_dot2c_f32_bf16 v29, v126, v21
    v_dot2c_f32_bf16 v30, v127, v20
    v_dot2c_f32_bf16 v31, v127, v21
    s_waitcnt vmcnt(7)
    v_dot2c_f32_bf16 v24, v128, v20
    v_dot2c_f32_bf16 v25, v128, v21
    v_dot2c_f32_bf16 v26, v129, v20
    v_dot2c_f32_bf16 v27, v129, v21
    v_dot2c_f32_bf16 v28, v130, v20
    v_dot2c_f32_bf16 v29, v130, v21
    v_dot2c_f32_bf16 v30, v131, v20
    v_dot2c_f32_bf16 v31, v131, v21
    s_waitcnt vmcnt(6)
    v_dot2c_f32_bf16 v24, v132, v20
    v_dot2c_f32_bf16 v25, v132, v21
    v_dot2c_f32_bf16 v26, v133, v20
    v_dot2c_f32_bf16 v27, v133, v21
    v_dot2c_f32_bf16 v28, v134, v20
    v_dot2c_f32_bf16 v29, v134, v21
    v_dot2c_f32_bf16 v30, v135, v20
    v_dot2c_f32_bf16 v31, v135, v21
    s_waitcnt vmcnt(5)
    v_dot2c_f32_bf16 v24, v136, v20
    v_dot2c_f32_bf16 v25, v136, v21
    v_dot2c_f32_bf16 v26, v137, v20
    v_dot2c_f32_bf16 v27, v137, v21
    v_dot2c_f32_bf16 v28, v138, v20
    v_dot2c_f32_bf16 v29, v138, v21
    v_dot2c_f32_bf16 v30, v139, v20
    v_dot2c_f32_bf16 v31, v139, v21
    s_waitcnt vmcnt(4)
    v_dot2c_f32_bf16 v24, v140, v20
    v_dot2c_f32_bf16 v25, v140, v21
    v_dot2c_f32_bf16 v26, v141, v20
    v_dot2c_f32_bf16 v27, v141, v21
    v_dot2c_f32_bf16 v28, v142, v20
    v_dot2c_f32_bf16 v29, v142, v21
    v_dot2c_f32_bf16 v30, v143, v20
    v_dot2c_f32_bf16 v31, v143, v21
    s_waitcnt vmcnt(3)
    v_dot2c_f32_bf16 v24, v144, v20
    v_dot2c_f32_bf16 v25, v144, v21
    v_dot2c_f32_bf16 v26, v145, v20
    v_dot2c_f32_bf16 v27, v145, v21
    v_dot2c_f32_bf16 v28, v146, v20
    v_dot2c_f32_bf16 v29, v146, v21
    v_dot2c_f32_bf16 v30, v147, v20
    v_dot2c_f32_bf16 v31, v147, v21
    s_waitcnt vmcnt(2)
    v_dot2c_f32_bf16 v24, v148, v20
    v_dot2c_f32_bf16 v25, v148, v21
    v_dot2c_f32_bf16 v26, v149, v20
    v_dot2c_f32_bf16 v27, v149, v21
    v_dot2c_f32_bf16 v28, v150, v20
    v_dot2c_f32_bf16 v29, v150, v21
    v_dot2c_f32_bf16 v30, v151, v20
    v_dot2c_f32_bf16 v31, v151, v21
    s_waitcnt vmcnt(1)
    v_dot2c_f32_bf16 v24, v152, v20
    v_dot2c_f32_bf16 v25, v152, v21
    v_dot2c_f32_bf16 v26, v153, v20
    v_dot2c_f32_bf16 v27, v153, v21
    v_dot2c_f32_bf16 v28, v154, v20
    v_dot2c_f32_bf16 v29, v154, v21
    v_dot2c_f32_bf16 v30, v155, v20
    v_dot2c_f32_bf16 v31, v155, v21
    s_waitcnt vmcnt(0)
    v_dot2c_f32_bf16 v24, v156, v20
    v_dot2c_f32_bf16 v25, v156, v21
    v_dot2c_f32_bf16 v26, v157, v20
    v_dot2c_f32_bf16 v27, v157, v21
    v_dot2c_f32_bf16 v28, v158, v20
    v_dot2c_f32_bf16 v29, v158, v21
    v_dot2c_f32_bf16 v30, v159, v20
    v_dot2c_f32_bf16 v31, v159, v21
    s_nop 2
Lrfin_1059:
    v_cvt_pk_bf16_f32 v16, v24, v25
    v_cvt_pk_bf16_f32 v17, v26, v27
    v_cvt_pk_bf16_f32 v18, v28, v29
    v_cvt_pk_bf16_f32 v19, v30, v31
    buffer_store_dwordx2 v[16:17], v8, s[20:23], s47 offen
    buffer_store_dwordx2 v[18:19], v8, s[20:23], s47 offen offset:16
    s_add_u32 s35, s35, 1
    s_sub_u32 s45, s45, 1
    s_cmp_lg_u32 s45, 0
    s_cbranch_scc1 Lrq_1057
    s_branch Lqtop_1040
Lwdone:
    s_waitcnt vmcnt(0)
    s_endpgm
Lrec:
    s_mov_b32 s3, s71
    s_mov_b32 s26, s72
    s_mov_b32 s27, s73
    s_load_dwordx2 s[16:17], s[0:1], 8
    s_load_dwordx2 s[18:19], s[0:1], 16
    s_load_dwordx2 s[20:21], s[0:1], 24
    s_load_dwordx2 s[22:23], s[0:1], 32
    s_load_dwordx2 s[24:25], s[0:1], 40
    s_waitcnt lgkmcnt(0)
    v_lshrrev_b32 v15, 6, v0
    v_and_b32 v0, 63, v0
    v_readfirstlane_b32 s4, v15
    v_and_b32 v40, 15, v0
    v_lshrrev_b32 v41, 4, v0
    v_bfe_u32 v42, v0, 2, 2
    v_and_b32 v43, 3, v0
    v_and_b32 v44, 7, v0
    v_bfe_u32 v45, v0, 3, 1
    v_mov_b32 v46, 0x4444
    v_mov_b32 v47, 0xeeee
    v_and_b32 v48, 2, v0
    v_cmp_eq_u32 vcc, 0, v48
    s_nop 1
    v_cndmask_b32 v1, v47, v46, vcc
    v_lshrrev_b32 v46, 1, v41
    v_lshlrev_b32 v46, 4, v46
    v_and_b32 v47, 1, v41
    v_lshl_add_u32 v46, v47, 2, v46
    v_add_u32 v46, v46, v42
    v_lshlrev_b32 v46, 5, v46
    v_lshl_add_u32 v46, v43, 3, v46
    v_add_u32 v2, 147456, v46
    s_mul_i32 s46, s4, 36864
    v_lshlrev_b32 v46, 4, v0
    v_add_u32 v3, s46, v46
    s_lshl_b32 s46, s4, 9
    s_add_u32 s46, s46, 156672
    v_lshlrev_b32 v46, 4, v40
    v_lshl_add_u32 v46, v41, 2, v46
    v_add_u32 v4, s46, v46
    s_mul_i32 s36, s4, 768
    s_add_u32 s36, s36, 2048
    v_lshrrev_b32 v46, 1, v41
    v_lshlrev_b32 v46, 4, v46
    v_and_b32 v47, 1, v41
    v_lshl_add_u32 v46, v47, 2, v46
    v_add_u32 v46, v46, v42
    v_lshlrev_b32 v46, 4, v46
    v_and_b32 v47, 1, v43
    v_lshl_add_u32 v46, v47, 3, v46
    v_add_u32 v5, s46, v46
    s_mul_i32 s46, s4, 1280
    v_lshl_add_u32 v46, v41, 3, v44
    v_lshlrev_b32 v46, 4, v46
    v_lshl_add_u32 v46, v45, 9, v46
    v_add_u32 v6, 158720, v46
    s_mov_b32 s48, s46
    s_add_u32 s49, s46, 159744
    v_and_b32 v47, 1, v41
    v_lshrrev_b32 v46, 1, v41
    v_lshl_add_u32 v46, v46, 3, v44
    v_lshlrev_b32 v46, 4, v46
    v_lshl_add_u32 v47, v47, 1, v45
    v_lshl_add_u32 v46, v47, 2, v46
    v_add_u32 v7, 159744, v46
    s_lshl_b32 s46, s4, 2
    v_lshrrev_b32 v46, 1, v41
    v_add_u32 v46, s46, v46
    v_lshlrev_b32 v47, 1, v44
    v_xor_b32 v46, v46, v47
    v_lshlrev_b32 v46, 4, v46
    v_lshl_add_u32 v46, v44, 8, v46
    v_and_b32 v48, 1, v41
    v_lshl_add_u32 v46, v48, 3, v46
    v_add_u32 v8, 156672, v46
    v_and_b32 v47, 1, v0
    v_lshl_add_u32 v47, v42, 1, v47
    v_bfe_u32 v48, v0, 1, 1
    v_lshl_add_u32 v46, v41, 1, v48
    v_lshlrev_b32 v48, 1, v47
    v_xor_b32 v46, v46, v48
    v_lshlrev_b32 v46, 4, v46
    v_lshl_add_u32 v46, v47, 8, v46
    v_add_u32 v9, 156672, v46
    s_lshl_b32 s46, s4, 3
    v_lshrrev_b32 v46, 3, v0
    v_add_u32 v46, s46, v46
    v_mul_u32_u24 v46, 9216, v46
    v_lshl_add_u32 v10, v44, 4, v46
    s_mul_i32 s46, s3, 9216
    s_lshl_b32 s47, s4, 12
    s_add_u32 s46, s46, s47
    s_lshr_b32 s59, s3, 3
    s_mul_i32 s59, s59, 72
    s_and_b32 s60, s3, 7
    s_cmp_ge_u32 s4, 2
    s_cbranch_scc1 Lc2_1064
    v_lshl_add_u32 v46, v41, 1, v45
    v_lshlrev_b32 v46, 7, v46
    v_lshl_add_u32 v46, v44, 4, v46
    v_add_u32 v11, s46, v46
    s_lshl_b32 s60, s60, 3
    v_add_u32 v46, s60, v44
    s_lshl_b32 s47, s4, 5
    s_add_u32 s59, s59, s47
    v_and_b32 v48, 15, v46
    v_lshl_add_u32 v47, v41, 4, v48
    v_add_u32 v47, s59, v47
    v_lshlrev_b32 v47, 5, v47
    v_lshrrev_b32 v48, 4, v46
    v_lshl_add_u32 v12, v48, 3, v47
    s_mov_b32 s54, 0x00ff00ff
    s_branch Lce_1065
Lc2_1064:
    v_lshrrev_b32 v46, 1, v40
    v_lshl_add_u32 v46, v46, 2, v41
    v_lshlrev_b32 v46, 5, v46
    v_and_b32 v47, 1, v0
    v_lshl_add_u32 v46, v47, 4, v46
    v_add_u32 v11, s46, v46
    s_lshl_b32 s60, s60, 2
    v_lshl_add_u32 v47, v47, 1, v41
    v_add_u32 v47, s60, v47
    v_and_b32 v48, 7, v47
    s_add_u32 s59, s59, 64
    v_add_u32 v48, s59, v48
    v_lshlrev_b32 v48, 5, v48
    v_lshrrev_b32 v47, 3, v47
    v_lshl_add_u32 v12, v47, 3, v48
    s_mov_b32 s54, 0x00030003
Lce_1065:
    s_mul_i32 s46, s4, -33792
    s_add_u32 s50, s46, 147456
    s_lshl_b32 s46, s4, 11
    v_lshrrev_b32 v48, 1, v41
    v_lshlrev_b32 v48, 10, v48
    v_and_b32 v47, 1, v41
    v_lshl_add_u32 v48, v47, 4, v48
    v_add_u32 v48, s46, v48
    v_lshl_add_u32 v13, v40, 5, v48
    s_mov_b32 s32, 0x00ff00ff
    s_mov_b32 s33, 0x00ff00ff
    s_mov_b32 s34, 0xff00ff00
    s_mov_b32 s35, 0xff00ff00
    s_mov_b32 s55, 0
    s_mov_b32 s56, 0x3e0293ee
    s_mov_b32 s67, 0xfffffffe
    s_lshl_b32 s28, s3, 7
    s_add_u32 s28, s28, 58720256
    s_add_u32 s30, s28, 4096
    s_lshl_b32 s31, s3, 5
    s_add_u32 s31, s31, 58728448
    s_mov_b32 s29, 58720256
    s_mov_b32 s37, 59768832
    s_mov_b32 s38, 59785216
    s_mov_b32 s39, 59801600
    s_lshl_b32 s46, s3, 19
    s_add_u32 s40, s46, 16777216
    s_add_u32 s41, s46, 33554432
    s_lshl_b32 s46, s3, 11
    s_add_u32 s42, s46, 50331648
    s_add_u32 s43, s46, 54369280
    s_mov_b32 s45, 0
    s_mov_b32 s51, 60817408
    s_lshl_b32 s52, s3, 7
    s_add_u32 s52, s52, 60850176
    s_mov_b32 s44, 1
    s_mul_i32 s47, s4, 36864
    s_mul_i32 s59, s3, 147456
    s_mul_i32 s60, s4, 288
    s_add_u32 s59, s59, s60
    s_mov_b32 s12, s24
    s_mov_b32 s13, s25
    s_mov_b32 s14, 4718592
    s_mov_b32 s15, 0x20000
    s_mov_b32 s60, 3641
    v_add_u32 v46, 0, v0
    v_mul_u32_u24 v47, s60, v46
    v_lshrrev_b32 v47, 16, v47
    v_mul_u32_u24 v48, 18, v47
    v_sub_u32 v48, v46, v48
    v_mul_u32_u24 v47, 1152, v47
    v_lshl_add_u32 v47, v48, 4, v47
    s_add_u32 s46, s47, 0
    s_mov_b32 m0, s46
    s_nop 0
    buffer_load_dwordx4 v47, s[12:15], s59 offen lds
    v_add_u32 v46, 64, v0
    v_mul_u32_u24 v47, s60, v46
    v_lshrrev_b32 v47, 16, v47
    v_mul_u32_u24 v48, 18, v47
    v_sub_u32 v48, v46, v48
    v_mul_u32_u24 v47, 1152, v47
    v_lshl_add_u32 v47, v48, 4, v47
    s_add_u32 s46, s47, 1024
    s_mov_b32 m0, s46
    s_nop 0
    buffer_load_dwordx4 v47, s[12:15], s59 offen lds
    v_add_u32 v46, 128, v0
    v_mul_u32_u24 v47, s60, v46
    v_lshrrev_b32 v47, 16, v47
    v_mul_u32_u24 v48, 18, v47
    v_sub_u32 v48, v46, v48
    v_mul_u32_u24 v47, 1152, v47
    v_lshl_add_u32 v47, v48, 4, v47
    s_add_u32 s46, s47, 2048
    s_mov_b32 m0, s46
    s_nop 0
    buffer_load_dwordx4 v47, s[12:15], s59 offen lds
    v_add_u32 v46, 192, v0
    v_mul_u32_u24 v47, s60, v46
    v_lshrrev_b32 v47, 16, v47
    v_mul_u32_u24 v48, 18, v47
    v_sub_u32 v48, v46, v48
    v_mul_u32_u24 v47, 1152, v47
    v_lshl_add_u32 v47, v48, 4, v47
    s_add_u32 s46, s47, 3072
    s_mov_b32 m0, s46
    s_nop 0
    buffer_load_dwordx4 v47, s[12:15], s59 offen lds
    v_add_u32 v46, 256, v0
    v_mul_u32_u24 v47, s60, v46
    v_lshrrev_b32 v47, 16, v47
    v_mul_u32_u24 v48, 18, v47
    v_sub_u32 v48, v46, v48
    v_mul_u32_u24 v47, 1152, v47
    v_lshl_add_u32 v47, v48, 4, v47
    s_add_u32 s46, s47, 4096
    s_mov_b32 m0, s46
    s_nop 0
    buffer_load_dwordx4 v47, s[12:15], s59 offen lds
    v_add_u32 v46, 320, v0
    v_mul_u32_u24 v47, s60, v46
    v_lshrrev_b32 v47, 16, v47
    v_mul_u32_u24 v48, 18, v47
    v_sub_u32 v48, v46, v48
    v_mul_u32_u24 v47, 1152, v47
    v_lshl_add_u32 v47, v48, 4, v47
    s_add_u32 s46, s47, 5120
    s_mov_b32 m0, s46
    s_nop 0
    buffer_load_dwordx4 v47, s[12:15], s59 offen lds
    v_add_u32 v46, 384, v0
    v_mul_u32_u24 v47, s60, v46
    v_lshrrev_b32 v47, 16, v47
    v_mul_u32_u24 v48, 18, v47
    v_sub_u32 v48, v46, v48
    v_mul_u32_u24 v47, 1152, v47
    v_lshl_add_u32 v47, v48, 4, v47
    s_add_u32 s46, s47, 6144
    s_mov_b32 m0, s46
    s_nop 0
    buffer_load_dwordx4 v47, s[12:15], s59 offen lds
    v_add_u32 v46, 448, v0
    v_mul_u32_u24 v47, s60, v46
    v_lshrrev_b32 v47, 16, v47
    v_mul_u32_u24 v48, 18, v47
    v_sub_u32 v48, v46, v48
    v_mul_u32_u24 v47, 1152, v47
    v_lshl_add_u32 v47, v48, 4, v47
    s_add_u32 s46, s47, 7168
    s_mov_b32 m0, s46
    s_nop 0
    buffer_load_dwordx4 v47, s[12:15], s59 offen lds
    v_add_u32 v46, 512, v0
    v_mul_u32_u24 v47, s60, v46
    v_lshrrev_b32 v47, 16, v47
    v_mul_u32_u24 v48, 18, v47
    v_sub_u32 v48, v46, v48
    v_mul_u32_u24 v47, 1152, v47
    v_lshl_add_u32 v47, v48, 4, v47
    s_add_u32 s46, s47, 8192
    s_mov_b32 m0, s46
    s_nop 0
    buffer_load_dwordx4 v47, s[12:15], s59 offen lds
    v_add_u32 v46, 576, v0
    v_mul_u32_u24 v47, s60, v46
    v_lshrrev_b32 v47, 16, v47
    v_mul_u32_u24 v48, 18, v47
    v_sub_u32 v48, v46, v48
    v_mul_u32_u24 v47, 1152, v47
    v_lshl_add_u32 v47, v48, 4, v47
    s_add_u32 s46, s47, 9216
    s_mov_b32 m0, s46
    s_nop 0
    buffer_load_dwordx4 v47, s[12:15], s59 offen lds
    v_add_u32 v46, 640, v0
    v_mul_u32_u24 v47, s60, v46
    v_lshrrev_b32 v47, 16, v47
    v_mul_u32_u24 v48, 18, v47
    v_sub_u32 v48, v46, v48
    v_mul_u32_u24 v47, 1152, v47
    v_lshl_add_u32 v47, v48, 4, v47
    s_add_u32 s46, s47, 10240
    s_mov_b32 m0, s46
    s_nop 0
    buffer_load_dwordx4 v47, s[12:15], s59 offen lds
    v_add_u32 v46, 704, v0
    v_mul_u32_u24 v47, s60, v46
    v_lshrrev_b32 v47, 16, v47
    v_mul_u32_u24 v48, 18, v47
    v_sub_u32 v48, v46, v48
    v_mul_u32_u24 v47, 1152, v47
    v_lshl_add_u32 v47, v48, 4, v47
    s_add_u32 s46, s47, 11264
    s_mov_b32 m0, s46
    s_nop 0
    buffer_load_dwordx4 v47, s[12:15], s59 offen lds
    v_add_u32 v46, 768, v0
    v_mul_u32_u24 v47, s60, v46
    v_lshrrev_b32 v47, 16, v47
    v_mul_u32_u24 v48, 18, v47
    v_sub_u32 v48, v46, v48
    v_mul_u32_u24 v47, 1152, v47
    v_lshl_add_u32 v47, v48, 4, v47
    s_add_u32 s46, s47, 12288
    s_mov_b32 m0, s46
    s_nop 0
    buffer_load_dwordx4 v47, s[12:15], s59 offen lds
    v_add_u32 v46, 832, v0
    v_mul_u32_u24 v47, s60, v46
    v_lshrrev_b32 v47, 16, v47
    v_mul_u32_u24 v48, 18, v47
    v_sub_u32 v48, v46, v48
    v_mul_u32_u24 v47, 1152, v47
    v_lshl_add_u32 v47, v48, 4, v47
    s_add_u32 s46, s47, 13312
    s_mov_b32 m0, s46
    s_nop 0
    buffer_load_dwordx4 v47, s[12:15], s59 offen lds
    v_add_u32 v46, 896, v0
    v_mul_u32_u24 v47, s60, v46
    v_lshrrev_b32 v47, 16, v47
    v_mul_u32_u24 v48, 18, v47
    v_sub_u32 v48, v46, v48
    v_mul_u32_u24 v47, 1152, v47
    v_lshl_add_u32 v47, v48, 4, v47
    s_add_u32 s46, s47, 14336
    s_mov_b32 m0, s46
    s_nop 0
    buffer_load_dwordx4 v47, s[12:15], s59 offen lds
    v_add_u32 v46, 960, v0
    v_mul_u32_u24 v47, s60, v46
    v_lshrrev_b32 v47, 16, v47
    v_mul_u32_u24 v48, 18, v47
    v_sub_u32 v48, v46, v48
    v_mul_u32_u24 v47, 1152, v47
    v_lshl_add_u32 v47, v48, 4, v47
    s_add_u32 s46, s47, 15360
    s_mov_b32 m0, s46
    s_nop 0
    buffer_load_dwordx4 v47, s[12:15], s59 offen lds
    v_add_u32 v46, 1024, v0
    v_mul_u32_u24 v47, s60, v46
    v_lshrrev_b32 v47, 16, v47
    v_mul_u32_u24 v48, 18, v47
    v_sub_u32 v48, v46, v48
    v_mul_u32_u24 v47, 1152, v47
    v_lshl_add_u32 v47, v48, 4, v47
    s_add_u32 s46, s47, 16384
    s_mov_b32 m0, s46
    s_nop 0
    buffer_load_dwordx4 v47, s[12:15], s59 offen lds
    v_add_u32 v46, 1088, v0
    v_mul_u32_u24 v47, s60, v46
    v_lshrrev_b32 v47, 16, v47
    v_mul_u32_u24 v48, 18, v47
    v_sub_u32 v48, v46, v48
    v_mul_u32_u24 v47, 1152, v47
    v_lshl_add_u32 v47, v48, 4, v47
    s_add_u32 s46, s47, 17408
    s_mov_b32 m0, s46
    s_nop 0
    buffer_load_dwordx4 v47, s[12:15], s59 offen lds
    v_add_u32 v46, 1152, v0
    v_mul_u32_u24 v47, s60, v46
    v_lshrrev_b32 v47, 16, v47
    v_mul_u32_u24 v48, 18, v47
    v_sub_u32 v48, v46, v48
    v_mul_u32_u24 v47, 1152, v47
    v_lshl_add_u32 v47, v48, 4, v47
    s_add_u32 s46, s47, 18432
    s_mov_b32 m0, s46
    s_nop 0
    buffer_load_dwordx4 v47, s[12:15], s59 offen lds
    v_add_u32 v46, 1216, v0
    v_mul_u32_u24 v47, s60, v46
    v_lshrrev_b32 v47, 16, v47
    v_mul_u32_u24 v48, 18, v47
    v_sub_u32 v48, v46, v48
    v_mul_u32_u24 v47, 1152, v47
    v_lshl_add_u32 v47, v48, 4, v47
    s_add_u32 s46, s47, 19456
    s_mov_b32 m0, s46
    s_nop 0
    buffer_load_dwordx4 v47, s[12:15], s59 offen lds
    v_add_u32 v46, 1280, v0
    v_mul_u32_u24 v47, s60, v46
    v_lshrrev_b32 v47, 16, v47
    v_mul_u32_u24 v48, 18, v47
    v_sub_u32 v48, v46, v48
    v_mul_u32_u24 v47, 1152, v47
    v_lshl_add_u32 v47, v48, 4, v47
    s_add_u32 s46, s47, 20480
    s_mov_b32 m0, s46
    s_nop 0
    buffer_load_dwordx4 v47, s[12:15], s59 offen lds
    v_add_u32 v46, 1344, v0
    v_mul_u32_u24 v47, s60, v46
    v_lshrrev_b32 v47, 16, v47
    v_mul_u32_u24 v48, 18, v47
    v_sub_u32 v48, v46, v48
    v_mul_u32_u24 v47, 1152, v47
    v_lshl_add_u32 v47, v48, 4, v47
    s_add_u32 s46, s47, 21504
    s_mov_b32 m0, s46
    s_nop 0
    buffer_load_dwordx4 v47, s[12:15], s59 offen lds
    v_add_u32 v46, 1408, v0
    v_mul_u32_u24 v47, s60, v46
    v_lshrrev_b32 v47, 16, v47
    v_mul_u32_u24 v48, 18, v47
    v_sub_u32 v48, v46, v48
    v_mul_u32_u24 v47, 1152, v47
    v_lshl_add_u32 v47, v48, 4, v47
    s_add_u32 s46, s47, 22528
    s_mov_b32 m0, s46
    s_nop 0
    buffer_load_dwordx4 v47, s[12:15], s59 offen lds
    v_add_u32 v46, 1472, v0
    v_mul_u32_u24 v47, s60, v46
    v_lshrrev_b32 v47, 16, v47
    v_mul_u32_u24 v48, 18, v47
    v_sub_u32 v48, v46, v48
    v_mul_u32_u24 v47, 1152, v47
    v_lshl_add_u32 v47, v48, 4, v47
    s_add_u32 s46, s47, 23552
    s_mov_b32 m0, s46
    s_nop 0
    buffer_load_dwordx4 v47, s[12:15], s59 offen lds
    v_add_u32 v46, 1536, v0
    v_mul_u32_u24 v47, s60, v46
    v_lshrrev_b32 v47, 16, v47
    v_mul_u32_u24 v48, 18, v47
    v_sub_u32 v48, v46, v48
    v_mul_u32_u24 v47, 1152, v47
    v_lshl_add_u32 v47, v48, 4, v47
    s_add_u32 s46, s47, 24576
    s_mov_b32 m0, s46
    s_nop 0
    buffer_load_dwordx4 v47, s[12:15], s59 offen lds
    v_add_u32 v46, 1600, v0
    v_mul_u32_u24 v47, s60, v46
    v_lshrrev_b32 v47, 16, v47
    v_mul_u32_u24 v48, 18, v47
    v_sub_u32 v48, v46, v48
    v_mul_u32_u24 v47, 1152, v47
    v_lshl_add_u32 v47, v48, 4, v47
    s_add_u32 s46, s47, 25600
    s_mov_b32 m0, s46
    s_nop 0
    buffer_load_dwordx4 v47, s[12:15], s59 offen lds
    v_add_u32 v46, 1664, v0
    v_mul_u32_u24 v47, s60, v46
    v_lshrrev_b32 v47, 16, v47
    v_mul_u32_u24 v48, 18, v47
    v_sub_u32 v48, v46, v48
    v_mul_u32_u24 v47, 1152, v47
    v_lshl_add_u32 v47, v48, 4, v47
    s_add_u32 s46, s47, 26624
    s_mov_b32 m0, s46
    s_nop 0
    buffer_load_dwordx4 v47, s[12:15], s59 offen lds
    v_add_u32 v46, 1728, v0
    v_mul_u32_u24 v47, s60, v46
    v_lshrrev_b32 v47, 16, v47
    v_mul_u32_u24 v48, 18, v47
    v_sub_u32 v48, v46, v48
    v_mul_u32_u24 v47, 1152, v47
    v_lshl_add_u32 v47, v48, 4, v47
    s_add_u32 s46, s47, 27648
    s_mov_b32 m0, s46
    s_nop 0
    buffer_load_dwordx4 v47, s[12:15], s59 offen lds
    v_add_u32 v46, 1792, v0
    v_mul_u32_u24 v47, s60, v46
    v_lshrrev_b32 v47, 16, v47
    v_mul_u32_u24 v48, 18, v47
    v_sub_u32 v48, v46, v48
    v_mul_u32_u24 v47, 1152, v47
    v_lshl_add_u32 v47, v48, 4, v47
    s_add_u32 s46, s47, 28672
    s_mov_b32 m0, s46
    s_nop 0
    buffer_load_dwordx4 v47, s[12:15], s59 offen lds
    v_add_u32 v46, 1856, v0
    v_mul_u32_u24 v47, s60, v46
    v_lshrrev_b32 v47, 16, v47
    v_mul_u32_u24 v48, 18, v47
    v_sub_u32 v48, v46, v48
    v_mul_u32_u24 v47, 1152, v47
    v_lshl_add_u32 v47, v48, 4, v47
    s_add_u32 s46, s47, 29696
    s_mov_b32 m0, s46
    s_nop 0
    buffer_load_dwordx4 v47, s[12:15], s59 offen lds
    v_add_u32 v46, 1920, v0
    v_mul_u32_u24 v47, s60, v46
    v_lshrrev_b32 v47, 16, v47
    v_mul_u32_u24 v48, 18, v47
    v_sub_u32 v48, v46, v48
    v_mul_u32_u24 v47, 1152, v47
    v_lshl_add_u32 v47, v48, 4, v47
    s_add_u32 s46, s47, 30720
    s_mov_b32 m0, s46
    s_nop 0
    buffer_load_dwordx4 v47, s[12:15], s59 offen lds
    v_add_u32 v46, 1984, v0
    v_mul_u32_u24 v47, s60, v46
    v_lshrrev_b32 v47, 16, v47
    v_mul_u32_u24 v48, 18, v47
    v_sub_u32 v48, v46, v48
    v_mul_u32_u24 v47, 1152, v47
    v_lshl_add_u32 v47, v48, 4, v47
    s_add_u32 s46, s47, 31744
    s_mov_b32 m0, s46
    s_nop 0
    buffer_load_dwordx4 v47, s[12:15], s59 offen lds
    v_add_u32 v46, 2048, v0
    v_mul_u32_u24 v47, s60, v46
    v_lshrrev_b32 v47, 16, v47
    v_mul_u32_u24 v48, 18, v47
    v_sub_u32 v48, v46, v48
    v_mul_u32_u24 v47, 1152, v47
    v_lshl_add_u32 v47, v48, 4, v47
    s_add_u32 s46, s47, 32768
    s_mov_b32 m0, s46
    s_nop 0
    buffer_load_dwordx4 v47, s[12:15], s59 offen lds
    v_add_u32 v46, 2112, v0
    v_mul_u32_u24 v47, s60, v46
    v_lshrrev_b32 v47, 16, v47
    v_mul_u32_u24 v48, 18, v47
    v_sub_u32 v48, v46, v48
    v_mul_u32_u24 v47, 1152, v47
    v_lshl_add_u32 v47, v48, 4, v47
    s_add_u32 s46, s47, 33792
    s_mov_b32 m0, s46
    s_nop 0
    buffer_load_dwordx4 v47, s[12:15], s59 offen lds
    v_add_u32 v46, 2176, v0
    v_mul_u32_u24 v47, s60, v46
    v_lshrrev_b32 v47, 16, v47
    v_mul_u32_u24 v48, 18, v47
    v_sub_u32 v48, v46, v48
    v_mul_u32_u24 v47, 1152, v47
    v_lshl_add_u32 v47, v48, 4, v47
    s_add_u32 s46, s47, 34816
    s_mov_b32 m0, s46
    s_nop 0
    buffer_load_dwordx4 v47, s[12:15], s59 offen lds
    v_add_u32 v46, 2240, v0
    v_mul_u32_u24 v47, s60, v46
    v_lshrrev_b32 v47, 16, v47
    v_mul_u32_u24 v48, 18, v47
    v_sub_u32 v48, v46, v48
    v_mul_u32_u24 v47, 1152, v47
    v_lshl_add_u32 v47, v48, 4, v47
    s_add_u32 s46, s47, 35840
    s_mov_b32 m0, s46
    s_nop 0
    buffer_load_dwordx4 v47, s[12:15], s59 offen lds
    v_mov_b32 v28, 0
    v_mov_b32 v29, 0
    v_mov_b32 v30, 0
    v_mov_b32 v31, 0
    v_mov_b32 v32, -1
    v_mov_b32 v33, -1
    buffer_store_dwordx4 v[28:31], v10, s[8:11], s28 offen sc1
    buffer_store_dwordx4 v[28:31], v10, s[8:11], s30 offen sc1
    s_lshl_b32 s46, s4, 3
    v_lshrrev_b32 v34, 4, v0
    v_bfe_u32 v35, v0, 2, 1
    v_lshl_add_u32 v34, v34, 1, v35
    v_add_u32 v34, s46, v34
    v_mul_u32_u24 v34, 9216, v34
    v_and_b32 v35, 3, v0
    v_lshl_add_u32 v34, v35, 3, v34
    s_mov_b64 exec, s[32:33]
    buffer_store_dwordx2 v[28:29], v34, s[8:11], s31 offen sc1
    s_mov_b64 exec, -1
    s_cmp_eq_u32 s4, 3
    s_cbranch_scc1 Lfl_1067
    s_mov_b64 exec, s[54:55]
    buffer_store_dwordx2 v[32:33], v12, s[8:11], s38 offen sc1
    buffer_store_dwordx2 v[32:33], v12, s[8:11], s39 offen sc1
    s_mov_b64 exec, -1
    s_branch Lnopois_1066
Lfl_1067:
    v_lshlrev_b32 v34, 7, v0
    s_mov_b32 exec_hi, 0
    buffer_store_byte v28, v34, s[8:11], s51 offen sc1
    s_add_u32 s46, s3, 60817440
    buffer_store_byte v28, v34, s[8:11], s46 offen sc1
    s_add_u32 s46, s46, 32
    buffer_store_byte v28, v34, s[8:11], s46 offen sc1
    s_lshl_b32 s46, s3, 7
    s_add_u32 s46, s46, 60882944
    s_mov_b32 exec_lo, 1
    buffer_store_dword v28, v28, s[8:11], s46 offen sc1
    s_sub_u32 s46, s46, 32768
    buffer_store_dword v28, v28, s[8:11], s46 offen sc1
    s_and_b32 s46, s3, 7
    s_lshl_b32 s46, s46, 7
    s_add_u32 s46, s46, 60887040
    buffer_store_dword v28, v28, s[8:11], s46 offen sc1
    s_mov_b64 exec, -1
Lnopois_1066:
    s_mul_i32 s46, s4, 2304
    v_lshlrev_b32 v46, 1, v0
    v_add_u32 v46, s46, v46
    global_load_ushort v52, v46, s[16:17] offset:0
    global_load_ushort v53, v46, s[16:17] offset:128
    global_load_ushort v54, v46, s[16:17] offset:256
    global_load_ushort v55, v46, s[16:17] offset:384
    global_load_ushort v56, v46, s[16:17] offset:512
    global_load_ushort v57, v46, s[16:17] offset:640
    global_load_ushort v58, v46, s[16:17] offset:768
    global_load_ushort v59, v46, s[16:17] offset:896
    global_load_ushort v60, v46, s[16:17] offset:1024
    global_load_ushort v61, v46, s[16:17] offset:1152
    global_load_ushort v62, v46, s[16:17] offset:1280
    global_load_ushort v63, v46, s[16:17] offset:1408
    global_load_ushort v64, v46, s[16:17] offset:1536
    global_load_ushort v65, v46, s[16:17] offset:1664
    global_load_ushort v66, v46, s[16:17] offset:1792
    global_load_ushort v67, v46, s[16:17] offset:1920
    global_load_ushort v68, v46, s[16:17] offset:2048
    global_load_ushort v69, v46, s[16:17] offset:2176
    s_lshl_b32 s46, s4, 3
    s_add_u32 s46, s46, 147456
    s_mov_b32 s47, 7282
    v_add_u32 v46, 0, v0
    v_mul_u32_u24 v47, s47, v46
    v_lshrrev_b32 v47, 20, v47
    v_mul_u32_u24 v48, 144, v47
    v_sub_u32 v46, v46, v48
    v_mul_u32_u24 v47, 72, v47
    v_lshrrev_b32 v48, 5, v46
    v_lshlrev_b32 v48, 4, v48
    v_and_b32 v49, 15, v46
    v_add_u32 v48, v48, v49
    v_bfe_u32 v49, v46, 4, 1
    v_and_b32 v50, 7, v46
    v_add_u32 v50, 64, v50
    v_bfe_u32 v51, v46, 3, 1
    v_cmp_gt_u32 vcc, 128, v46
    s_nop 1
    v_cndmask_b32 v48, v50, v48, vcc
    v_cndmask_b32 v49, v51, v49, vcc
    v_add_u32 v48, v48, v47
    v_lshlrev_b32 v48, 5, v48
    v_lshl_add_u32 v48, v49, 2, v48
    v_add_u32 v28, s46, v48
    v_add_u32 v46, 64, v0
    v_mul_u32_u24 v47, s47, v46
    v_lshrrev_b32 v47, 20, v47
    v_mul_u32_u24 v48, 144, v47
    v_sub_u32 v46, v46, v48
    v_mul_u32_u24 v47, 72, v47
    v_lshrrev_b32 v48, 5, v46
    v_lshlrev_b32 v48, 4, v48
    v_and_b32 v49, 15, v46
    v_add_u32 v48, v48, v49
    v_bfe_u32 v49, v46, 4, 1
    v_and_b32 v50, 7, v46
    v_add_u32 v50, 64, v50
    v_bfe_u32 v51, v46, 3, 1
    v_cmp_gt_u32 vcc, 128, v46
    s_nop 1
    v_cndmask_b32 v48, v50, v48, vcc
    v_cndmask_b32 v49, v51, v49, vcc
    v_add_u32 v48, v48, v47
    v_lshlrev_b32 v48, 5, v48
    v_lshl_add_u32 v48, v49, 2, v48
    v_add_u32 v29, s46, v48
    v_add_u32 v46, 128, v0
    v_mul_u32_u24 v47, s47, v46
    v_lshrrev_b32 v47, 20, v47
    v_mul_u32_u24 v48, 144, v47
    v_sub_u32 v46, v46, v48
    v_mul_u32_u24 v47, 72, v47
    v_lshrrev_b32 v48, 5, v46
    v_lshlrev_b32 v48, 4, v48
    v_and_b32 v49, 15, v46
    v_add_u32 v48, v48, v49
    v_bfe_u32 v49, v46, 4, 1
    v_and_b32 v50, 7, v46
    v_add_u32 v50, 64, v50
    v_bfe_u32 v51, v46, 3, 1
    v_cmp_gt_u32 vcc, 128, v46
    s_nop 1
    v_cndmask_b32 v48, v50, v48, vcc
    v_cndmask_b32 v49, v51, v49, vcc
    v_add_u32 v48, v48, v47
    v_lshlrev_b32 v48, 5, v48
    v_lshl_add_u32 v48, v49, 2, v48
    v_add_u32 v30, s46, v48
    v_add_u32 v46, 192, v0
    v_mul_u32_u24 v47, s47, v46
    v_lshrrev_b32 v47, 20, v47
    v_mul_u32_u24 v48, 144, v47
    v_sub_u32 v46, v46, v48
    v_mul_u32_u24 v47, 72, v47
    v_lshrrev_b32 v48, 5, v46
    v_lshlrev_b32 v48, 4, v48
    v_and_b32 v49, 15, v46
    v_add_u32 v48, v48, v49
    v_bfe_u32 v49, v46, 4, 1
    v_and_b32 v50, 7, v46
    v_add_u32 v50, 64, v50
    v_bfe_u32 v51, v46, 3, 1
    v_cmp_gt_u32 vcc, 128, v46
    s_nop 1
    v_cndmask_b32 v48, v50, v48, vcc
    v_cndmask_b32 v49, v51, v49, vcc
    v_add_u32 v48, v48, v47
    v_lshlrev_b32 v48, 5, v48
    v_lshl_add_u32 v48, v49, 2, v48
    v_add_u32 v31, s46, v48
    v_add_u32 v46, 256, v0
    v_mul_u32_u24 v47, s47, v46
    v_lshrrev_b32 v47, 20, v47
    v_mul_u32_u24 v48, 144, v47
    v_sub_u32 v46, v46, v48
    v_mul_u32_u24 v47, 72, v47
    v_lshrrev_b32 v48, 5, v46
    v_lshlrev_b32 v48, 4, v48
    v_and_b32 v49, 15, v46
    v_add_u32 v48, v48, v49
    v_bfe_u32 v49, v46, 4, 1
    v_and_b32 v50, 7, v46
    v_add_u32 v50, 64, v50
    v_bfe_u32 v51, v46, 3, 1
    v_cmp_gt_u32 vcc, 128, v46
    s_nop 1
    v_cndmask_b32 v48, v50, v48, vcc
    v_cndmask_b32 v49, v51, v49, vcc
    v_add_u32 v48, v48, v47
    v_lshlrev_b32 v48, 5, v48
    v_lshl_add_u32 v48, v49, 2, v48
    v_add_u32 v32, s46, v48
    v_add_u32 v46, 320, v0
    v_mul_u32_u24 v47, s47, v46
    v_lshrrev_b32 v47, 20, v47
    v_mul_u32_u24 v48, 144, v47
    v_sub_u32 v46, v46, v48
    v_mul_u32_u24 v47, 72, v47
    v_lshrrev_b32 v48, 5, v46
    v_lshlrev_b32 v48, 4, v48
    v_and_b32 v49, 15, v46
    v_add_u32 v48, v48, v49
    v_bfe_u32 v49, v46, 4, 1
    v_and_b32 v50, 7, v46
    v_add_u32 v50, 64, v50
    v_bfe_u32 v51, v46, 3, 1
    v_cmp_gt_u32 vcc, 128, v46
    s_nop 1
    v_cndmask_b32 v48, v50, v48, vcc
    v_cndmask_b32 v49, v51, v49, vcc
    v_add_u32 v48, v48, v47
    v_lshlrev_b32 v48, 5, v48
    v_lshl_add_u32 v48, v49, 2, v48
    v_add_u32 v33, s46, v48
    v_add_u32 v46, 384, v0
    v_mul_u32_u24 v47, s47, v46
    v_lshrrev_b32 v47, 20, v47
    v_mul_u32_u24 v48, 144, v47
    v_sub_u32 v46, v46, v48
    v_mul_u32_u24 v47, 72, v47
    v_lshrrev_b32 v48, 5, v46
    v_lshlrev_b32 v48, 4, v48
    v_and_b32 v49, 15, v46
    v_add_u32 v48, v48, v49
    v_bfe_u32 v49, v46, 4, 1
    v_and_b32 v50, 7, v46
    v_add_u32 v50, 64, v50
    v_bfe_u32 v51, v46, 3, 1
    v_cmp_gt_u32 vcc, 128, v46
    s_nop 1
    v_cndmask_b32 v48, v50, v48, vcc
    v_cndmask_b32 v49, v51, v49, vcc
    v_add_u32 v48, v48, v47
    v_lshlrev_b32 v48, 5, v48
    v_lshl_add_u32 v48, v49, 2, v48
    v_add_u32 v34, s46, v48
    v_add_u32 v46, 448, v0
    v_mul_u32_u24 v47, s47, v46
    v_lshrrev_b32 v47, 20, v47
    v_mul_u32_u24 v48, 144, v47
    v_sub_u32 v46, v46, v48
    v_mul_u32_u24 v47, 72, v47
    v_lshrrev_b32 v48, 5, v46
    v_lshlrev_b32 v48, 4, v48
    v_and_b32 v49, 15, v46
    v_add_u32 v48, v48, v49
    v_bfe_u32 v49, v46, 4, 1
    v_and_b32 v50, 7, v46
    v_add_u32 v50, 64, v50
    v_bfe_u32 v51, v46, 3, 1
    v_cmp_gt_u32 vcc, 128, v46
    s_nop 1
    v_cndmask_b32 v48, v50, v48, vcc
    v_cndmask_b32 v49, v51, v49, vcc
    v_add_u32 v48, v48, v47
    v_lshlrev_b32 v48, 5, v48
    v_lshl_add_u32 v48, v49, 2, v48
    v_add_u32 v35, s46, v48
    v_add_u32 v46, 512, v0
    v_mul_u32_u24 v47, s47, v46
    v_lshrrev_b32 v47, 20, v47
    v_mul_u32_u24 v48, 144, v47
    v_sub_u32 v46, v46, v48
    v_mul_u32_u24 v47, 72, v47
    v_lshrrev_b32 v48, 5, v46
    v_lshlrev_b32 v48, 4, v48
    v_and_b32 v49, 15, v46
    v_add_u32 v48, v48, v49
    v_bfe_u32 v49, v46, 4, 1
    v_and_b32 v50, 7, v46
    v_add_u32 v50, 64, v50
    v_bfe_u32 v51, v46, 3, 1
    v_cmp_gt_u32 vcc, 128, v46
    s_nop 1
    v_cndmask_b32 v48, v50, v48, vcc
    v_cndmask_b32 v49, v51, v49, vcc
    v_add_u32 v48, v48, v47
    v_lshlrev_b32 v48, 5, v48
    v_lshl_add_u32 v48, v49, 2, v48
    v_add_u32 v36, s46, v48
    s_mul_i32 s47, s4, 36864
    v_lshrrev_b32 v46, 1, v41
    v_lshlrev_b32 v46, 4, v46
    v_lshrrev_b32 v47, 1, v42
    v_lshl_add_u32 v46, v47, 3, v46
    v_and_b32 v47, 1, v41
    v_lshl_add_u32 v46, v47, 2, v46
    v_and_b32 v47, 1, v42
    v_add_u32 v46, v46, v47
    v_mul_u32_u24 v46, 288, v46
    v_lshl_add_u32 v46, v43, 3, v46
    v_add_u32 v49, s47, v46
    v_and_b32 v46, 1, v41
    v_lshlrev_b32 v46, 4, v46
    v_lshrrev_b32 v47, 1, v42
    v_lshl_add_u32 v46, v47, 3, v46
    v_lshrrev_b32 v47, 1, v41
    v_lshl_add_u32 v46, v47, 2, v46
    v_and_b32 v47, 1, v42
    v_add_u32 v46, v46, v47
    v_lshlrev_b32 v46, 6, v46
    v_lshl_add_u32 v46, v43, 3, v46
    v_add_u32 v50, s47, v46
    s_lshl_b32 s59, s3, 8
    s_lshl_b32 s60, s4, 6
    s_add_u32 s59, s59, s60
    v_bfe_u32 v46, v0, 2, 3
    v_lshrrev_b32 v47, 5, v0
    v_lshl_add_u32 v48, v47, 3, v46
    v_lshl_add_u32 v46, v47, 4, v46
    v_lshlrev_b32 v46, 13, v46
    v_lshl_add_u32 v46, v43, 4, v46
    v_add_u32 v51, s59, v46
    v_lshlrev_b32 v48, 13, v48
    v_lshl_add_u32 v48, v43, 4, v48
    v_add_u32 v48, s59, v48
    s_lshl_b32 s46, s3, 2
    s_add_u32 s46, s46, s4
    s_lshl_b32 s46, s46, 12
    v_lshlrev_b32 v47, 6, v0
    v_add_u32 v47, s46, v47
    s_mov_b32 s78, 4718592
    s_mov_b32 s79, 0x20000
    s_waitcnt vmcnt(41)
    ds_read_b64_tr_b16 v[112:113], v49 offset:0
    ds_read_b64_tr_b16 v[114:115], v49 offset:576
    ds_read_b64_tr_b16 v[116:117], v49 offset:9216
    ds_read_b64_tr_b16 v[118:119], v49 offset:9792
    ds_read_b64_tr_b16 v[128:129], v49 offset:32
    ds_read_b64_tr_b16 v[130:131], v49 offset:608
    ds_read_b64_tr_b16 v[132:133], v49 offset:9248
    ds_read_b64_tr_b16 v[134:135], v49 offset:9824
    ds_read_b64_tr_b16 v[144:145], v49 offset:64
    ds_read_b64_tr_b16 v[146:147], v49 offset:640
    ds_read_b64_tr_b16 v[148:149], v49 offset:9280
    ds_read_b64_tr_b16 v[150:151], v49 offset:9856
    s_waitcnt lgkmcnt(0)
    ds_read_b64_tr_b16 v[160:161], v49 offset:96
    ds_read_b64_tr_b16 v[162:163], v49 offset:672
    ds_read_b64_tr_b16 v[164:165], v49 offset:9312
    ds_read_b64_tr_b16 v[166:167], v49 offset:9888
    ds_read_b64_tr_b16 v[176:177], v49 offset:128
    ds_read_b64_tr_b16 v[178:179], v49 offset:704
    ds_read_b64_tr_b16 v[180:181], v49 offset:9344
    ds_read_b64_tr_b16 v[182:183], v49 offset:9920
    ds_read_b64_tr_b16 v[192:193], v49 offset:160
    ds_read_b64_tr_b16 v[194:195], v49 offset:736
    ds_read_b64_tr_b16 v[196:197], v49 offset:9376
    ds_read_b64_tr_b16 v[198:199], v49 offset:9952
    s_waitcnt lgkmcnt(0)
    ds_read_b64_tr_b16 v[208:209], v49 offset:192
    ds_read_b64_tr_b16 v[210:211], v49 offset:768
    ds_read_b64_tr_b16 v[212:213], v49 offset:9408
    ds_read_b64_tr_b16 v[214:215], v49 offset:9984
    ds_read_b64_tr_b16 v[224:225], v49 offset:224
    ds_read_b64_tr_b16 v[226:227], v49 offset:800
    ds_read_b64_tr_b16 v[228:229], v49 offset:9440
    ds_read_b64_tr_b16 v[230:231], v49 offset:10016
    ds_read_b64_tr_b16 v[240:241], v49 offset:256
    ds_read_b64_tr_b16 v[242:243], v49 offset:832
    ds_read_b64_tr_b16 v[244:245], v49 offset:9472
    ds_read_b64_tr_b16 v[246:247], v49 offset:10048
    s_waitcnt lgkmcnt(0)
    s_mov_b32 s12, s18
    s_mov_b32 s13, s19
    s_mov_b32 s14, 4718592
    s_mov_b32 s15, 0x20000
    s_add_u32 s46, s47, 0
    s_mov_b32 m0, s46
    s_mov_b32 s59, 0
    buffer_load_dwordx4 v51, s[12:15], s59 offen lds
    s_add_u32 s46, s47, 1024
    s_mov_b32 m0, s46
    s_mov_b32 s59, 65536
    buffer_load_dwordx4 v51, s[12:15], s59 offen lds
    s_add_u32 s46, s47, 2048
    s_mov_b32 m0, s46
    s_mov_b32 s59, 262144
    buffer_load_dwordx4 v51, s[12:15], s59 offen lds
    s_add_u32 s46, s47, 3072
    s_mov_b32 m0, s46
    s_mov_b32 s59, 327680
    buffer_load_dwordx4 v51, s[12:15], s59 offen lds
    s_add_u32 s46, s47, 4096
    s_mov_b32 m0, s46
    s_mov_b32 s59, 524288
    buffer_load_dwordx4 v51, s[12:15], s59 offen lds
    s_add_u32 s46, s47, 5120
    s_mov_b32 m0, s46
    s_mov_b32 s59, 589824
    buffer_load_dwordx4 v51, s[12:15], s59 offen lds
    s_add_u32 s46, s47, 6144
    s_mov_b32 m0, s46
    s_mov_b32 s59, 786432
    buffer_load_dwordx4 v51, s[12:15], s59 offen lds
    s_add_u32 s46, s47, 7168
    s_mov_b32 m0, s46
    s_mov_b32 s59, 851968
    buffer_load_dwordx4 v51, s[12:15], s59 offen lds
    s_add_u32 s46, s47, 8192
    s_mov_b32 m0, s46
    s_mov_b32 s59, 1048576
    buffer_load_dwordx4 v48, s[12:15], s59 offen lds
    s_add_u32 s46, s47, 9216
    s_mov_b32 m0, s46
    s_mov_b32 s59, 1179648
    buffer_load_dwordx4 v51, s[12:15], s59 offen lds
    s_add_u32 s46, s47, 10240
    s_mov_b32 m0, s46
    s_mov_b32 s59, 1245184
    buffer_load_dwordx4 v51, s[12:15], s59 offen lds
    s_add_u32 s46, s47, 11264
    s_mov_b32 m0, s46
    s_mov_b32 s59, 1441792
    buffer_load_dwordx4 v51, s[12:15], s59 offen lds
    s_add_u32 s46, s47, 12288
    s_mov_b32 m0, s46
    s_mov_b32 s59, 1507328
    buffer_load_dwordx4 v51, s[12:15], s59 offen lds
    s_add_u32 s46, s47, 13312
    s_mov_b32 m0, s46
    s_mov_b32 s59, 1703936
    buffer_load_dwordx4 v51, s[12:15], s59 offen lds
    s_add_u32 s46, s47, 14336
    s_mov_b32 m0, s46
    s_mov_b32 s59, 1769472
    buffer_load_dwordx4 v51, s[12:15], s59 offen lds
    s_add_u32 s46, s47, 15360
    s_mov_b32 m0, s46
    s_mov_b32 s59, 1966080
    buffer_load_dwordx4 v51, s[12:15], s59 offen lds
    s_waitcnt vmcnt(39)
    ds_read_b64_tr_b16 v[120:121], v49 offset:18432
    ds_read_b64_tr_b16 v[122:123], v49 offset:19008
    ds_read_b64_tr_b16 v[124:125], v49 offset:27648
    ds_read_b64_tr_b16 v[126:127], v49 offset:28224
    ds_read_b64_tr_b16 v[136:137], v49 offset:18464
    ds_read_b64_tr_b16 v[138:139], v49 offset:19040
    ds_read_b64_tr_b16 v[140:141], v49 offset:27680
    ds_read_b64_tr_b16 v[142:143], v49 offset:28256
    ds_read_b64_tr_b16 v[152:153], v49 offset:18496
    ds_read_b64_tr_b16 v[154:155], v49 offset:19072
    ds_read_b64_tr_b16 v[156:157], v49 offset:27712
    ds_read_b64_tr_b16 v[158:159], v49 offset:28288
    s_waitcnt lgkmcnt(0)
    ds_read_b64_tr_b16 v[168:169], v49 offset:18528
    ds_read_b64_tr_b16 v[170:171], v49 offset:19104
    ds_read_b64_tr_b16 v[172:173], v49 offset:27744
    ds_read_b64_tr_b16 v[174:175], v49 offset:28320
    ds_read_b64_tr_b16 v[184:185], v49 offset:18560
    ds_read_b64_tr_b16 v[186:187], v49 offset:19136
    ds_read_b64_tr_b16 v[188:189], v49 offset:27776
    ds_read_b64_tr_b16 v[190:191], v49 offset:28352
    ds_read_b64_tr_b16 v[200:201], v49 offset:18592
    ds_read_b64_tr_b16 v[202:203], v49 offset:19168
    ds_read_b64_tr_b16 v[204:205], v49 offset:27808
    ds_read_b64_tr_b16 v[206:207], v49 offset:28384
    s_waitcnt lgkmcnt(0)
    ds_read_b64_tr_b16 v[216:217], v49 offset:18624
    ds_read_b64_tr_b16 v[218:219], v49 offset:19200
    ds_read_b64_tr_b16 v[220:221], v49 offset:27840
    ds_read_b64_tr_b16 v[222:223], v49 offset:28416
    ds_read_b64_tr_b16 v[232:233], v49 offset:18656
    ds_read_b64_tr_b16 v[234:235], v49 offset:19232
    ds_read_b64_tr_b16 v[236:237], v49 offset:27872
    ds_read_b64_tr_b16 v[238:239], v49 offset:28448
    ds_read_b64_tr_b16 v[248:249], v49 offset:18688
    ds_read_b64_tr_b16 v[250:251], v49 offset:19264
    ds_read_b64_tr_b16 v[252:253], v49 offset:27904
    ds_read_b64_tr_b16 v[254:255], v49 offset:28480
    s_waitcnt lgkmcnt(0)
    s_add_u32 s46, s47, 16384
    s_mov_b32 m0, s46
    s_mov_b32 s59, 2031616
    buffer_load_dwordx4 v51, s[12:15], s59 offen lds
    s_add_u32 s46, s47, 17408
    s_mov_b32 m0, s46
    s_mov_b32 s59, 2228224
    buffer_load_dwordx4 v48, s[12:15], s59 offen lds
    s_add_u32 s46, s47, 18432
    s_mov_b32 m0, s46
    s_mov_b32 s59, 2359296
    buffer_load_dwordx4 v51, s[12:15], s59 offen lds
    s_add_u32 s46, s47, 19456
    s_mov_b32 m0, s46
    s_mov_b32 s59, 2424832
    buffer_load_dwordx4 v51, s[12:15], s59 offen lds
    s_add_u32 s46, s47, 20480
    s_mov_b32 m0, s46
    s_mov_b32 s59, 2621440
    buffer_load_dwordx4 v51, s[12:15], s59 offen lds
    s_add_u32 s46, s47, 21504
    s_mov_b32 m0, s46
    s_mov_b32 s59, 2686976
    buffer_load_dwordx4 v51, s[12:15], s59 offen lds
    s_add_u32 s46, s47, 22528
    s_mov_b32 m0, s46
    s_mov_b32 s59, 2883584
    buffer_load_dwordx4 v51, s[12:15], s59 offen lds
    s_add_u32 s46, s47, 23552
    s_mov_b32 m0, s46
    s_mov_b32 s59, 2949120
    buffer_load_dwordx4 v51, s[12:15], s59 offen lds
    s_add_u32 s46, s47, 24576
    s_mov_b32 m0, s46
    s_mov_b32 s59, 3145728
    buffer_load_dwordx4 v51, s[12:15], s59 offen lds
    s_add_u32 s46, s47, 25600
    s_mov_b32 m0, s46
    s_mov_b32 s59, 3211264
    buffer_load_dwordx4 v51, s[12:15], s59 offen lds
    s_add_u32 s46, s47, 26624
    s_mov_b32 m0, s46
    s_mov_b32 s59, 3407872
    buffer_load_dwordx4 v48, s[12:15], s59 offen lds
    s_add_u32 s46, s47, 27648
    s_mov_b32 m0, s46
    s_mov_b32 s59, 3538944
    buffer_load_dwordx4 v51, s[12:15], s59 offen lds
    s_add_u32 s46, s47, 28672
    s_mov_b32 m0, s46
    s_mov_b32 s59, 3604480
    buffer_load_dwordx4 v51, s[12:15], s59 offen lds
    s_add_u32 s46, s47, 29696
    s_mov_b32 m0, s46
    s_mov_b32 s59, 3801088
    buffer_load_dwordx4 v51, s[12:15], s59 offen lds
    s_add_u32 s46, s47, 30720
    s_mov_b32 m0, s46
    s_mov_b32 s59, 3866624
    buffer_load_dwordx4 v51, s[12:15], s59 offen lds
    s_add_u32 s46, s47, 31744
    s_mov_b32 m0, s46
    s_mov_b32 s59, 4063232
    buffer_load_dwordx4 v51, s[12:15], s59 offen lds
    s_add_u32 s46, s47, 32768
    s_mov_b32 m0, s46
    s_mov_b32 s59, 4128768
    buffer_load_dwordx4 v51, s[12:15], s59 offen lds
    s_add_u32 s46, s47, 33792
    s_mov_b32 m0, s46
    s_mov_b32 s59, 4325376
    buffer_load_dwordx4 v51, s[12:15], s59 offen lds
    s_add_u32 s46, s47, 34816
    s_mov_b32 m0, s46
    s_mov_b32 s59, 4390912
    buffer_load_dwordx4 v51, s[12:15], s59 offen lds
    s_add_u32 s46, s47, 35840
    s_mov_b32 m0, s46
    s_mov_b32 s59, 4587520
    buffer_load_dwordx4 v48, s[12:15], s59 offen lds
    s_waitcnt vmcnt(32)
    ds_write_b16 v28, v52 offset:0
    ds_write_b16 v29, v53 offset:0
    ds_write_b16 v30, v54 offset:0
    ds_write_b16 v31, v55 offset:0
    ds_write_b16 v32, v56 offset:0
    ds_write_b16 v33, v57 offset:0
    ds_write_b16 v34, v58 offset:0
    ds_write_b16 v35, v59 offset:0
    ds_write_b16 v36, v60 offset:0
    ds_write_b16 v28, v61 offset:2
    ds_write_b16 v29, v62 offset:2
    ds_write_b16 v30, v63 offset:2
    ds_write_b16 v31, v64 offset:2
    ds_write_b16 v32, v65 offset:2
    ds_write_b16 v33, v66 offset:2
    ds_write_b16 v34, v67 offset:2
    ds_write_b16 v35, v68 offset:2
    ds_write_b16 v36, v69 offset:2
    s_barrier
    s_cmp_lg_u32 s4, 0
    s_cbranch_scc1 Lnoarr_1068
    s_mul_i32 s46, s57, 6
    s_mov_b64 s[62:63], 1
    s_lshl_b64 s[62:63], s[62:63], s46
    s_or_b32 s63, s63, 0x01000000
    v_mov_b32 v38, s62
    v_mov_b32 v39, s63
    v_mov_b32 v37, 0
    s_mov_b64 exec, 1
    global_atomic_add_x2 v37, v[38:39], s[26:27] offset:40 sc1
    s_mov_b64 exec, -1
Lnoarr_1068:
    ds_read_b64_tr_b16 a[0:1], v50 offset:0
    ds_read_b64_tr_b16 a[2:3], v50 offset:128
    ds_read_b64_tr_b16 a[4:5], v50 offset:2048
    ds_read_b64_tr_b16 a[6:7], v50 offset:2176
    ds_read_b64_tr_b16 a[8:9], v50 offset:32
    ds_read_b64_tr_b16 a[10:11], v50 offset:160
    ds_read_b64_tr_b16 a[12:13], v50 offset:2080
    ds_read_b64_tr_b16 a[14:15], v50 offset:2208
    s_waitcnt lgkmcnt(0)
    s_mov_b32 s12, s20
    s_mov_b32 s13, s21
    s_mov_b32 s14, 4718592
    s_mov_b32 s15, 0x20000
    s_add_u32 s46, s47, 0
    s_mov_b32 m0, s46
    s_mov_b32 s59, 0
    buffer_load_dwordx4 v51, s[12:15], s59 offen lds
    s_add_u32 s46, s47, 1024
    s_mov_b32 m0, s46
    s_mov_b32 s59, 65536
    buffer_load_dwordx4 v51, s[12:15], s59 offen lds
    s_add_u32 s46, s47, 2048
    s_mov_b32 m0, s46
    s_mov_b32 s59, 262144
    buffer_load_dwordx4 v51, s[12:15], s59 offen lds
    s_add_u32 s46, s47, 3072
    s_mov_b32 m0, s46
    s_mov_b32 s59, 327680
    buffer_load_dwordx4 v51, s[12:15], s59 offen lds
    s_waitcnt vmcnt(32)
    ds_read_b64_tr_b16 a[16:17], v50 offset:4096
    ds_read_b64_tr_b16 a[18:19], v50 offset:4224
    ds_read_b64_tr_b16 a[20:21], v50 offset:6144
    ds_read_b64_tr_b16 a[22:23], v50 offset:6272
    ds_read_b64_tr_b16 a[24:25], v50 offset:4128
    ds_read_b64_tr_b16 a[26:27], v50 offset:4256
    ds_read_b64_tr_b16 a[28:29], v50 offset:6176
    ds_read_b64_tr_b16 a[30:31], v50 offset:6304
    s_waitcnt lgkmcnt(0)
    s_add_u32 s46, s47, 4096
    s_mov_b32 m0, s46
    s_mov_b32 s59, 524288
    buffer_load_dwordx4 v51, s[12:15], s59 offen lds
    s_add_u32 s46, s47, 5120
    s_mov_b32 m0, s46
    s_mov_b32 s59, 589824
    buffer_load_dwordx4 v51, s[12:15], s59 offen lds
    s_add_u32 s46, s47, 6144
    s_mov_b32 m0, s46
    s_mov_b32 s59, 786432
    buffer_load_dwordx4 v51, s[12:15], s59 offen lds
    s_add_u32 s46, s47, 7168
    s_mov_b32 m0, s46
    s_mov_b32 s59, 851968
    buffer_load_dwordx4 v51, s[12:15], s59 offen lds
    s_waitcnt vmcnt(32)
    ds_read_b64_tr_b16 a[32:33], v50 offset:8192
    ds_read_b64_tr_b16 a[34:35], v50 offset:8320
    ds_read_b64_tr_b16 a[36:37], v50 offset:10240
    ds_read_b64_tr_b16 a[38:39], v50 offset:10368
    ds_read_b64_tr_b16 a[40:41], v50 offset:8224
    ds_read_b64_tr_b16 a[42:43], v50 offset:8352
    ds_read_b64_tr_b16 a[44:45], v50 offset:10272
    ds_read_b64_tr_b16 a[46:47], v50 offset:10400
    s_waitcnt lgkmcnt(0)
    s_add_u32 s46, s47, 8192
    s_mov_b32 m0, s46
    s_mov_b32 s59, 1048576
    buffer_load_dwordx4 v48, s[12:15], s59 offen lds
    s_add_u32 s46, s47, 9216
    s_mov_b32 m0, s46
    s_mov_b32 s59, 1179648
    buffer_load_dwordx4 v51, s[12:15], s59 offen lds
    s_add_u32 s46, s47, 10240
    s_mov_b32 m0, s46
    s_mov_b32 s59, 1245184
    buffer_load_dwordx4 v51, s[12:15], s59 offen lds
    s_add_u32 s46, s47, 11264
    s_mov_b32 m0, s46
    s_mov_b32 s59, 1441792
    buffer_load_dwordx4 v51, s[12:15], s59 offen lds
    s_waitcnt vmcnt(32)
    ds_read_b64_tr_b16 a[48:49], v50 offset:12288
    ds_read_b64_tr_b16 a[50:51], v50 offset:12416
    ds_read_b64_tr_b16 a[52:53], v50 offset:14336
    ds_read_b64_tr_b16 a[54:55], v50 offset:14464
    ds_read_b64_tr_b16 a[56:57], v50 offset:12320
    ds_read_b64_tr_b16 a[58:59], v50 offset:12448
    ds_read_b64_tr_b16 a[60:61], v50 offset:14368
    ds_read_b64_tr_b16 a[62:63], v50 offset:14496
    s_waitcnt lgkmcnt(0)
    s_add_u32 s46, s47, 12288
    s_mov_b32 m0, s46
    s_mov_b32 s59, 1507328
    buffer_load_dwordx4 v51, s[12:15], s59 offen lds
    s_add_u32 s46, s47, 13312
    s_mov_b32 m0, s46
    s_mov_b32 s59, 1703936
    buffer_load_dwordx4 v51, s[12:15], s59 offen lds
    s_add_u32 s46, s47, 14336
    s_mov_b32 m0, s46
    s_mov_b32 s59, 1769472
    buffer_load_dwordx4 v51, s[12:15], s59 offen lds
    s_add_u32 s46, s47, 15360
    s_mov_b32 m0, s46
    s_mov_b32 s59, 1966080
    buffer_load_dwordx4 v51, s[12:15], s59 offen lds
    s_waitcnt vmcnt(32)
    ds_read_b64_tr_b16 a[64:65], v50 offset:16384
    ds_read_b64_tr_b16 a[66:67], v50 offset:16512
    ds_read_b64_tr_b16 a[68:69], v50 offset:18432
    ds_read_b64_tr_b16 a[70:71], v50 offset:18560
    ds_read_b64_tr_b16 a[72:73], v50 offset:16416
    ds_read_b64_tr_b16 a[74:75], v50 offset:16544
    ds_read_b64_tr_b16 a[76:77], v50 offset:18464
    ds_read_b64_tr_b16 a[78:79], v50 offset:18592
    s_waitcnt lgkmcnt(0)
    s_add_u32 s46, s47, 16384
    s_mov_b32 m0, s46
    s_mov_b32 s59, 2031616
    buffer_load_dwordx4 v51, s[12:15], s59 offen lds
    s_add_u32 s46, s47, 17408
    s_mov_b32 m0, s46
    s_mov_b32 s59, 2228224
    buffer_load_dwordx4 v48, s[12:15], s59 offen lds
    s_add_u32 s46, s47, 18432
    s_mov_b32 m0, s46
    s_mov_b32 s59, 2359296
    buffer_load_dwordx4 v51, s[12:15], s59 offen lds
    s_add_u32 s46, s47, 19456
    s_mov_b32 m0, s46
    s_mov_b32 s59, 2424832
    buffer_load_dwordx4 v51, s[12:15], s59 offen lds
    s_waitcnt vmcnt(32)
    ds_read_b64_tr_b16 a[80:81], v50 offset:20480
    ds_read_b64_tr_b16 a[82:83], v50 offset:20608
    ds_read_b64_tr_b16 a[84:85], v50 offset:22528
    ds_read_b64_tr_b16 a[86:87], v50 offset:22656
    ds_read_b64_tr_b16 a[88:89], v50 offset:20512
    ds_read_b64_tr_b16 a[90:91], v50 offset:20640
    ds_read_b64_tr_b16 a[92:93], v50 offset:22560
    ds_read_b64_tr_b16 a[94:95], v50 offset:22688
    s_waitcnt lgkmcnt(0)
    s_add_u32 s46, s47, 20480
    s_mov_b32 m0, s46
    s_mov_b32 s59, 2621440
    buffer_load_dwordx4 v51, s[12:15], s59 offen lds
    s_add_u32 s46, s47, 21504
    s_mov_b32 m0, s46
    s_mov_b32 s59, 2686976
    buffer_load_dwordx4 v51, s[12:15], s59 offen lds
    s_add_u32 s46, s47, 22528
    s_mov_b32 m0, s46
    s_mov_b32 s59, 2883584
    buffer_load_dwordx4 v51, s[12:15], s59 offen lds
    s_add_u32 s46, s47, 23552
    s_mov_b32 m0, s46
    s_mov_b32 s59, 2949120
    buffer_load_dwordx4 v51, s[12:15], s59 offen lds
    s_waitcnt vmcnt(32)
    ds_read_b64_tr_b16 a[96:97], v50 offset:24576
    ds_read_b64_tr_b16 a[98:99], v50 offset:24704
    ds_read_b64_tr_b16 a[100:101], v50 offset:26624
    ds_read_b64_tr_b16 a[102:103], v50 offset:26752
    ds_read_b64_tr_b16 a[104:105], v50 offset:24608
    ds_read_b64_tr_b16 a[106:107], v50 offset:24736
    ds_read_b64_tr_b16 a[108:109], v50 offset:26656
    ds_read_b64_tr_b16 a[110:111], v50 offset:26784
    s_waitcnt lgkmcnt(0)
    s_add_u32 s46, s47, 24576
    s_mov_b32 m0, s46
    s_mov_b32 s59, 3145728
    buffer_load_dwordx4 v51, s[12:15], s59 offen lds
    s_add_u32 s46, s47, 25600
    s_mov_b32 m0, s46
    s_mov_b32 s59, 3211264
    buffer_load_dwordx4 v51, s[12:15], s59 offen lds
    s_add_u32 s46, s47, 26624
    s_mov_b32 m0, s46
    s_mov_b32 s59, 3407872
    buffer_load_dwordx4 v48, s[12:15], s59 offen lds
    s_add_u32 s46, s47, 27648
    s_mov_b32 m0, s46
    s_mov_b32 s59, 3538944
    buffer_load_dwordx4 v51, s[12:15], s59 offen lds
    s_waitcnt vmcnt(32)
    ds_read_b64_tr_b16 a[112:113], v50 offset:28672
    ds_read_b64_tr_b16 a[114:115], v50 offset:28800
    ds_read_b64_tr_b16 a[116:117], v50 offset:30720
    ds_read_b64_tr_b16 a[118:119], v50 offset:30848
    ds_read_b64_tr_b16 a[120:121], v50 offset:28704
    ds_read_b64_tr_b16 a[122:123], v50 offset:28832
    ds_read_b64_tr_b16 a[124:125], v50 offset:30752
    ds_read_b64_tr_b16 a[126:127], v50 offset:30880
    s_waitcnt lgkmcnt(0)
    s_add_u32 s46, s47, 28672
    s_mov_b32 m0, s46
    s_mov_b32 s59, 3604480
    buffer_load_dwordx4 v51, s[12:15], s59 offen lds
    s_add_u32 s46, s47, 29696
    s_mov_b32 m0, s46
    s_mov_b32 s59, 3801088
    buffer_load_dwordx4 v51, s[12:15], s59 offen lds
    s_add_u32 s46, s47, 30720
    s_mov_b32 m0, s46
    s_mov_b32 s59, 3866624
    buffer_load_dwordx4 v51, s[12:15], s59 offen lds
    s_add_u32 s46, s47, 31744
    s_mov_b32 m0, s46
    s_mov_b32 s59, 4063232
    buffer_load_dwordx4 v51, s[12:15], s59 offen lds
    s_waitcnt vmcnt(32)
    ds_read_b64_tr_b16 a[128:129], v50 offset:32768
    ds_read_b64_tr_b16 a[130:131], v50 offset:32896
    ds_read_b64_tr_b16 a[132:133], v50 offset:34816
    ds_read_b64_tr_b16 a[134:135], v50 offset:34944
    ds_read_b64_tr_b16 a[136:137], v50 offset:32800
    ds_read_b64_tr_b16 a[138:139], v50 offset:32928
    ds_read_b64_tr_b16 a[140:141], v50 offset:34848
    ds_read_b64_tr_b16 a[142:143], v50 offset:34976
    s_waitcnt lgkmcnt(0)
    s_add_u32 s46, s47, 32768
    s_mov_b32 m0, s46
    s_mov_b32 s59, 4128768
    buffer_load_dwordx4 v51, s[12:15], s59 offen lds
    s_add_u32 s46, s47, 33792
    s_mov_b32 m0, s46
    s_mov_b32 s59, 4325376
    buffer_load_dwordx4 v51, s[12:15], s59 offen lds
    s_add_u32 s46, s47, 34816
    s_mov_b32 m0, s46
    s_mov_b32 s59, 4390912
    buffer_load_dwordx4 v51, s[12:15], s59 offen lds
    s_add_u32 s46, s47, 35840
    s_mov_b32 m0, s46
    s_mov_b32 s59, 4587520
    buffer_load_dwordx4 v48, s[12:15], s59 offen lds
    s_waitcnt vmcnt(32)
    ds_read_b64_tr_b16 a[144:145], v50 offset:0
    ds_read_b64_tr_b16 a[146:147], v50 offset:128
    ds_read_b64_tr_b16 a[148:149], v50 offset:2048
    ds_read_b64_tr_b16 a[150:151], v50 offset:2176
    ds_read_b64_tr_b16 a[152:153], v50 offset:32
    ds_read_b64_tr_b16 a[154:155], v50 offset:160
    ds_read_b64_tr_b16 a[156:157], v50 offset:2080
    ds_read_b64_tr_b16 a[158:159], v50 offset:2208
    s_waitcnt lgkmcnt(0)
    s_mov_b32 s12, s22
    s_mov_b32 s13, s23
    s_mov_b32 s14, 4718592
    s_mov_b32 s15, 0x20000
    s_add_u32 s46, s47, 0
    s_mov_b32 m0, s46
    s_mov_b32 s59, 0
    buffer_load_dwordx4 v51, s[12:15], s59 offen lds
    s_add_u32 s46, s47, 1024
    s_mov_b32 m0, s46
    s_mov_b32 s59, 65536
    buffer_load_dwordx4 v51, s[12:15], s59 offen lds
    s_add_u32 s46, s47, 2048
    s_mov_b32 m0, s46
    s_mov_b32 s59, 262144
    buffer_load_dwordx4 v51, s[12:15], s59 offen lds
    s_add_u32 s46, s47, 3072
    s_mov_b32 m0, s46
    s_mov_b32 s59, 327680
    buffer_load_dwordx4 v51, s[12:15], s59 offen lds
    s_waitcnt vmcnt(32)
    ds_read_b64_tr_b16 a[160:161], v50 offset:4096
    ds_read_b64_tr_b16 a[162:163], v50 offset:4224
    ds_read_b64_tr_b16 a[164:165], v50 offset:6144
    ds_read_b64_tr_b16 a[166:167], v50 offset:6272
    ds_read_b64_tr_b16 a[168:169], v50 offset:4128
    ds_read_b64_tr_b16 a[170:171], v50 offset:4256
    ds_read_b64_tr_b16 a[172:173], v50 offset:6176
    ds_read_b64_tr_b16 a[174:175], v50 offset:6304
    s_waitcnt lgkmcnt(0)
    s_add_u32 s46, s47, 4096
    s_mov_b32 m0, s46
    s_mov_b32 s59, 524288
    buffer_load_dwordx4 v51, s[12:15], s59 offen lds
    s_add_u32 s46, s47, 5120
    s_mov_b32 m0, s46
    s_mov_b32 s59, 589824
    buffer_load_dwordx4 v51, s[12:15], s59 offen lds
    s_add_u32 s46, s47, 6144
    s_mov_b32 m0, s46
    s_mov_b32 s59, 786432
    buffer_load_dwordx4 v51, s[12:15], s59 offen lds
    s_add_u32 s46, s47, 7168
    s_mov_b32 m0, s46
    s_mov_b32 s59, 851968
    buffer_load_dwordx4 v51, s[12:15], s59 offen lds
    s_waitcnt vmcnt(32)
    ds_read_b64_tr_b16 a[176:177], v50 offset:8192
    ds_read_b64_tr_b16 a[178:179], v50 offset:8320
    ds_read_b64_tr_b16 a[180:181], v50 offset:10240
    ds_read_b64_tr_b16 a[182:183], v50 offset:10368
    ds_read_b64_tr_b16 a[184:185], v50 offset:8224
    ds_read_b64_tr_b16 a[186:187], v50 offset:8352
    ds_read_b64_tr_b16 a[188:189], v50 offset:10272
    ds_read_b64_tr_b16 a[190:191], v50 offset:10400
    s_waitcnt lgkmcnt(0)
    s_add_u32 s46, s47, 8192
    s_mov_b32 m0, s46
    s_mov_b32 s59, 1048576
    buffer_load_dwordx4 v48, s[12:15], s59 offen lds
    s_add_u32 s46, s47, 9216
    s_mov_b32 m0, s46
    s_mov_b32 s59, 1179648
    buffer_load_dwordx4 v51, s[12:15], s59 offen lds
    s_add_u32 s46, s47, 10240
    s_mov_b32 m0, s46
    s_mov_b32 s59, 1245184
    buffer_load_dwordx4 v51, s[12:15], s59 offen lds
    s_add_u32 s46, s47, 11264
    s_mov_b32 m0, s46
    s_mov_b32 s59, 1441792
    buffer_load_dwordx4 v51, s[12:15], s59 offen lds
    s_waitcnt vmcnt(32)
    ds_read_b64_tr_b16 a[192:193], v50 offset:12288
    ds_read_b64_tr_b16 a[194:195], v50 offset:12416
    ds_read_b64_tr_b16 a[196:197], v50 offset:14336
    ds_read_b64_tr_b16 a[198:199], v50 offset:14464
    ds_read_b64_tr_b16 a[200:201], v50 offset:12320
    ds_read_b64_tr_b16 a[202:203], v50 offset:12448
    ds_read_b64_tr_b16 a[204:205], v50 offset:14368
    ds_read_b64_tr_b16 a[206:207], v50 offset:14496
    s_waitcnt lgkmcnt(0)
    s_add_u32 s46, s47, 12288
    s_mov_b32 m0, s46
    s_mov_b32 s59, 1507328
    buffer_load_dwordx4 v51, s[12:15], s59 offen lds
    s_add_u32 s46, s47, 13312
    s_mov_b32 m0, s46
    s_mov_b32 s59, 1703936
    buffer_load_dwordx4 v51, s[12:15], s59 offen lds
    s_add_u32 s46, s47, 14336
    s_mov_b32 m0, s46
    s_mov_b32 s59, 1769472
    buffer_load_dwordx4 v51, s[12:15], s59 offen lds
    s_add_u32 s46, s47, 15360
    s_mov_b32 m0, s46
    s_mov_b32 s59, 1966080
    buffer_load_dwordx4 v51, s[12:15], s59 offen lds
    s_waitcnt vmcnt(32)
    ds_read_b64_tr_b16 a[208:209], v50 offset:16384
    ds_read_b64_tr_b16 a[210:211], v50 offset:16512
    ds_read_b64_tr_b16 a[212:213], v50 offset:18432
    ds_read_b64_tr_b16 a[214:215], v50 offset:18560
    ds_read_b64_tr_b16 a[216:217], v50 offset:16416
    ds_read_b64_tr_b16 a[218:219], v50 offset:16544
    ds_read_b64_tr_b16 a[220:221], v50 offset:18464
    ds_read_b64_tr_b16 a[222:223], v50 offset:18592
    s_waitcnt lgkmcnt(0)
    s_add_u32 s46, s47, 16384
    s_mov_b32 m0, s46
    s_mov_b32 s59, 2031616
    buffer_load_dwordx4 v51, s[12:15], s59 offen lds
    s_add_u32 s46, s47, 17408
    s_mov_b32 m0, s46
    s_mov_b32 s59, 2228224
    buffer_load_dwordx4 v48, s[12:15], s59 offen lds
    s_add_u32 s46, s47, 18432
    s_mov_b32 m0, s46
    s_mov_b32 s59, 2359296
    buffer_load_dwordx4 v51, s[12:15], s59 offen lds
    s_add_u32 s46, s47, 19456
    s_mov_b32 m0, s46
    s_mov_b32 s59, 2424832
    buffer_load_dwordx4 v51, s[12:15], s59 offen lds
    s_waitcnt vmcnt(32)
    ds_read_b64_tr_b16 a[224:225], v50 offset:20480
    ds_read_b64_tr_b16 a[226:227], v50 offset:20608
    ds_read_b64_tr_b16 a[228:229], v50 offset:22528
    ds_read_b64_tr_b16 a[230:231], v50 offset:22656
    ds_read_b64_tr_b16 a[232:233], v50 offset:20512
    ds_read_b64_tr_b16 a[234:235], v50 offset:20640
    ds_read_b64_tr_b16 a[236:237], v50 offset:22560
    ds_read_b64_tr_b16 a[238:239], v50 offset:22688
    s_waitcnt lgkmcnt(0)
    s_add_u32 s46, s47, 20480
    s_mov_b32 m0, s46
    s_mov_b32 s59, 2621440
    buffer_load_dwordx4 v51, s[12:15], s59 offen lds
    s_add_u32 s46, s47, 21504
    s_mov_b32 m0, s46
    s_mov_b32 s59, 2686976
    buffer_load_dwordx4 v51, s[12:15], s59 offen lds
    s_add_u32 s46, s47, 22528
    s_mov_b32 m0, s46
    s_mov_b32 s59, 2883584
    buffer_load_dwordx4 v51, s[12:15], s59 offen lds
    s_add_u32 s46, s47, 23552
    s_mov_b32 m0, s46
    s_mov_b32 s59, 2949120
    buffer_load_dwordx4 v51, s[12:15], s59 offen lds
    s_waitcnt vmcnt(32)
    ds_read_b64_tr_b16 a[240:241], v50 offset:24576
    ds_read_b64_tr_b16 a[242:243], v50 offset:24704
    ds_read_b64_tr_b16 a[244:245], v50 offset:26624
    ds_read_b64_tr_b16 a[246:247], v50 offset:26752
    ds_read_b64_tr_b16 a[248:249], v50 offset:24608
    ds_read_b64_tr_b16 a[250:251], v50 offset:24736
    ds_read_b64_tr_b16 a[252:253], v50 offset:26656
    ds_read_b64_tr_b16 a[254:255], v50 offset:26784
    s_waitcnt lgkmcnt(0)
    s_add_u32 s46, s47, 24576
    s_mov_b32 m0, s46
    s_mov_b32 s59, 3145728
    buffer_load_dwordx4 v51, s[12:15], s59 offen lds
    s_add_u32 s46, s47, 25600
    s_mov_b32 m0, s46
    s_mov_b32 s59, 3211264
    buffer_load_dwordx4 v51, s[12:15], s59 offen lds
    s_add_u32 s46, s47, 26624
    s_mov_b32 m0, s46
    s_mov_b32 s59, 3407872
    buffer_load_dwordx4 v48, s[12:15], s59 offen lds
    s_add_u32 s46, s47, 27648
    s_mov_b32 m0, s46
    s_mov_b32 s59, 3538944
    buffer_load_dwordx4 v51, s[12:15], s59 offen lds
    s_waitcnt vmcnt(32)
    ds_read_b64_tr_b16 v[80:81], v50 offset:28672
    ds_read_b64_tr_b16 v[82:83], v50 offset:28800
    ds_read_b64_tr_b16 v[84:85], v50 offset:30720
    ds_read_b64_tr_b16 v[86:87], v50 offset:30848
    ds_read_b64_tr_b16 v[88:89], v50 offset:28704
    ds_read_b64_tr_b16 v[90:91], v50 offset:28832
    ds_read_b64_tr_b16 v[92:93], v50 offset:30752
    ds_read_b64_tr_b16 v[94:95], v50 offset:30880
    s_waitcnt lgkmcnt(0)
    s_add_u32 s46, s47, 28672
    s_mov_b32 m0, s46
    s_mov_b32 s59, 3604480
    buffer_load_dwordx4 v51, s[12:15], s59 offen lds
    s_add_u32 s46, s47, 29696
    s_mov_b32 m0, s46
    s_mov_b32 s59, 3801088
    buffer_load_dwordx4 v51, s[12:15], s59 offen lds
    s_add_u32 s46, s47, 30720
    s_mov_b32 m0, s46
    s_mov_b32 s59, 3866624
    buffer_load_dwordx4 v51, s[12:15], s59 offen lds
    s_add_u32 s46, s47, 31744
    s_mov_b32 m0, s46
    s_mov_b32 s59, 4063232
    buffer_load_dwordx4 v51, s[12:15], s59 offen lds
    s_waitcnt vmcnt(32)
    ds_read_b64_tr_b16 v[96:97], v50 offset:32768
    ds_read_b64_tr_b16 v[98:99], v50 offset:32896
    ds_read_b64_tr_b16 v[100:101], v50 offset:34816
    ds_read_b64_tr_b16 v[102:103], v50 offset:34944
    ds_read_b64_tr_b16 v[104:105], v50 offset:32800
    ds_read_b64_tr_b16 v[106:107], v50 offset:32928
    ds_read_b64_tr_b16 v[108:109], v50 offset:34848
    ds_read_b64_tr_b16 v[110:111], v50 offset:34976
    s_waitcnt lgkmcnt(0)
    s_add_u32 s46, s47, 32768
    s_mov_b32 m0, s46
    s_mov_b32 s59, 4128768
    buffer_load_dwordx4 v51, s[12:15], s59 offen lds
    s_add_u32 s46, s47, 33792
    s_mov_b32 m0, s46
    s_mov_b32 s59, 4325376
    buffer_load_dwordx4 v51, s[12:15], s59 offen lds
    s_add_u32 s46, s47, 34816
    s_mov_b32 m0, s46
    s_mov_b32 s59, 4390912
    buffer_load_dwordx4 v51, s[12:15], s59 offen lds
    s_add_u32 s46, s47, 35840
    s_mov_b32 m0, s46
    s_mov_b32 s59, 4587520
    buffer_load_dwordx4 v48, s[12:15], s59 offen lds
    s_waitcnt vmcnt(32)
    ds_read_b64_tr_b16 v[52:53], v50 offset:0
    ds_read_b64_tr_b16 v[54:55], v50 offset:128
    ds_read_b64_tr_b16 v[56:57], v50 offset:2048
    ds_read_b64_tr_b16 v[58:59], v50 offset:2176
    ds_read_b64_tr_b16 v[60:61], v50 offset:32
    ds_read_b64_tr_b16 v[62:63], v50 offset:160
    ds_read_b64_tr_b16 v[64:65], v50 offset:2080
    ds_read_b64_tr_b16 v[66:67], v50 offset:2208
    s_waitcnt lgkmcnt(0)
    ds_write_b128 v3, v[52:55] offset:0
    ds_write_b128 v3, v[56:59] offset:1024
    ds_write_b128 v3, v[60:63] offset:2048
    ds_write_b128 v3, v[64:67] offset:3072
    s_waitcnt lgkmcnt(0)
    s_waitcnt vmcnt(28)
    ds_read_b64_tr_b16 v[52:53], v50 offset:4096
    ds_read_b64_tr_b16 v[54:55], v50 offset:4224
    ds_read_b64_tr_b16 v[56:57], v50 offset:6144
    ds_read_b64_tr_b16 v[58:59], v50 offset:6272
    ds_read_b64_tr_b16 v[60:61], v50 offset:4128
    ds_read_b64_tr_b16 v[62:63], v50 offset:4256
    ds_read_b64_tr_b16 v[64:65], v50 offset:6176
    ds_read_b64_tr_b16 v[66:67], v50 offset:6304
    s_waitcnt lgkmcnt(0)
    ds_write_b128 v3, v[52:55] offset:4096
    ds_write_b128 v3, v[56:59] offset:5120
    ds_write_b128 v3, v[60:63] offset:6144
    ds_write_b128 v3, v[64:67] offset:7168
    s_waitcnt lgkmcnt(0)
    s_waitcnt vmcnt(24)
    ds_read_b64_tr_b16 v[52:53], v50 offset:8192
    ds_read_b64_tr_b16 v[54:55], v50 offset:8320
    ds_read_b64_tr_b16 v[56:57], v50 offset:10240
    ds_read_b64_tr_b16 v[58:59], v50 offset:10368
    ds_read_b64_tr_b16 v[60:61], v50 offset:8224
    ds_read_b64_tr_b16 v[62:63], v50 offset:8352
    ds_read_b64_tr_b16 v[64:65], v50 offset:10272
    ds_read_b64_tr_b16 v[66:67], v50 offset:10400
    s_waitcnt lgkmcnt(0)
    ds_write_b128 v3, v[52:55] offset:8192
    ds_write_b128 v3, v[56:59] offset:9216
    ds_write_b128 v3, v[60:63] offset:10240
    ds_write_b128 v3, v[64:67] offset:11264
    s_waitcnt lgkmcnt(0)
    s_waitcnt vmcnt(20)
    ds_read_b64_tr_b16 v[52:53], v50 offset:12288
    ds_read_b64_tr_b16 v[54:55], v50 offset:12416
    ds_read_b64_tr_b16 v[56:57], v50 offset:14336
    ds_read_b64_tr_b16 v[58:59], v50 offset:14464
    ds_read_b64_tr_b16 v[60:61], v50 offset:12320
    ds_read_b64_tr_b16 v[62:63], v50 offset:12448
    ds_read_b64_tr_b16 v[64:65], v50 offset:14368
    ds_read_b64_tr_b16 v[66:67], v50 offset:14496
    s_waitcnt lgkmcnt(0)
    ds_write_b128 v3, v[52:55] offset:12288
    ds_write_b128 v3, v[56:59] offset:13312
    ds_write_b128 v3, v[60:63] offset:14336
    ds_write_b128 v3, v[64:67] offset:15360
    s_waitcnt lgkmcnt(0)
    s_waitcnt vmcnt(16)
    ds_read_b64_tr_b16 v[52:53], v50 offset:16384
    ds_read_b64_tr_b16 v[54:55], v50 offset:16512
    ds_read_b64_tr_b16 v[56:57], v50 offset:18432
    ds_read_b64_tr_b16 v[58:59], v50 offset:18560
    ds_read_b64_tr_b16 v[60:61], v50 offset:16416
    ds_read_b64_tr_b16 v[62:63], v50 offset:16544
    ds_read_b64_tr_b16 v[64:65], v50 offset:18464
    ds_read_b64_tr_b16 v[66:67], v50 offset:18592
    s_waitcnt lgkmcnt(0)
    ds_write_b128 v3, v[52:55] offset:16384
    ds_write_b128 v3, v[56:59] offset:17408
    ds_write_b128 v3, v[60:63] offset:18432
    ds_write_b128 v3, v[64:67] offset:19456
    s_waitcnt lgkmcnt(0)
    s_waitcnt vmcnt(12)
    ds_read_b64_tr_b16 v[52:53], v50 offset:20480
    ds_read_b64_tr_b16 v[54:55], v50 offset:20608
    ds_read_b64_tr_b16 v[56:57], v50 offset:22528
    ds_read_b64_tr_b16 v[58:59], v50 offset:22656
    ds_read_b64_tr_b16 v[60:61], v50 offset:20512
    ds_read_b64_tr_b16 v[62:63], v50 offset:20640
    ds_read_b64_tr_b16 v[64:65], v50 offset:22560
    ds_read_b64_tr_b16 v[66:67], v50 offset:22688
    s_waitcnt lgkmcnt(0)
    ds_write_b128 v3, v[52:55] offset:20480
    ds_write_b128 v3, v[56:59] offset:21504
    ds_write_b128 v3, v[60:63] offset:22528
    ds_write_b128 v3, v[64:67] offset:23552
    s_waitcnt lgkmcnt(0)
    s_waitcnt vmcnt(8)
    ds_read_b64_tr_b16 v[52:53], v50 offset:24576
    ds_read_b64_tr_b16 v[54:55], v50 offset:24704
    ds_read_b64_tr_b16 v[56:57], v50 offset:26624
    ds_read_b64_tr_b16 v[58:59], v50 offset:26752
    ds_read_b64_tr_b16 v[60:61], v50 offset:24608
    ds_read_b64_tr_b16 v[62:63], v50 offset:24736
    ds_read_b64_tr_b16 v[64:65], v50 offset:26656
    ds_read_b64_tr_b16 v[66:67], v50 offset:26784
    s_waitcnt lgkmcnt(0)
    ds_write_b128 v3, v[52:55] offset:24576
    ds_write_b128 v3, v[56:59] offset:25600
    ds_write_b128 v3, v[60:63] offset:26624
    ds_write_b128 v3, v[64:67] offset:27648
    s_waitcnt lgkmcnt(0)
    s_waitcnt vmcnt(4)
    ds_read_b64_tr_b16 v[52:53], v50 offset:28672
    ds_read_b64_tr_b16 v[54:55], v50 offset:28800
    ds_read_b64_tr_b16 v[56:57], v50 offset:30720
    ds_read_b64_tr_b16 v[58:59], v50 offset:30848
    ds_read_b64_tr_b16 v[60:61], v50 offset:28704
    ds_read_b64_tr_b16 v[62:63], v50 offset:28832
    ds_read_b64_tr_b16 v[64:65], v50 offset:30752
    ds_read_b64_tr_b16 v[66:67], v50 offset:30880
    s_waitcnt lgkmcnt(0)
    ds_write_b128 v3, v[52:55] offset:28672
    ds_write_b128 v3, v[56:59] offset:29696
    ds_write_b128 v3, v[60:63] offset:30720
    ds_write_b128 v3, v[64:67] offset:31744
    s_waitcnt lgkmcnt(0)
    s_waitcnt vmcnt(0)
    ds_read_b64_tr_b16 v[52:53], v50 offset:32768
    ds_read_b64_tr_b16 v[54:55], v50 offset:32896
    ds_read_b64_tr_b16 v[56:57], v50 offset:34816
    ds_read_b64_tr_b16 v[58:59], v50 offset:34944
    ds_read_b64_tr_b16 v[60:61], v50 offset:32800
    ds_read_b64_tr_b16 v[62:63], v50 offset:32928
    ds_read_b64_tr_b16 v[64:65], v50 offset:34848
    ds_read_b64_tr_b16 v[66:67], v50 offset:34976
    s_waitcnt lgkmcnt(0)
    ds_write_b128 v3, v[52:55] offset:32768
    ds_write_b128 v3, v[56:59] offset:33792
    ds_write_b128 v3, v[60:63] offset:34816
    ds_write_b128 v3, v[64:67] offset:35840
    s_waitcnt lgkmcnt(0)
    v_mov_b32 v30, 0
    s_mov_b32 s66, 0
Lhs_1069:
    global_load_dwordx2 v[28:29], v30, s[26:27] offset:40 sc1
    s_add_u32 s66, s66, 1
    s_cmp_gt_u32 s66, 0x400000
    s_cbranch_scc1 Lexit
    s_waitcnt vmcnt(0)
    v_readfirstlane_b32 s62, v28
    v_readfirstlane_b32 s63, v29
    s_nop 0
    s_lshr_b32 s46, s63, 24
    s_cmp_lt_u32 s46, 32
    s_cbranch_scc1 Lhs_1069
    s_mul_i32 s46, s57, 6
    s_lshr_b64 s[62:63], s[62:63], s46
    s_and_b32 s62, s62, 63
    s_cmp_eq_u32 s62, 32
    s_cbranch_scc1 Lr_fast
    s_branch Lr_slow
Lr_fast:
    s_add_u32 s46, s45, 0
    s_and_b32 s47, s46, 3
    s_cmp_lg_u32 s47, 0
    s_cbranch_scc1 Lkvs_1073
    s_cmp_gt_u32 s46, 63
    s_cbranch_scc1 Lkvs_1073
    v_mov_b32 v52, s46
    s_mov_b32 s66, 0
Lkvp_1072:
    global_load_dword v53, v52, s[26:27] offset:128 sc1
    s_add_u32 s66, s66, 1
    s_cmp_gt_u32 s66, 0x200000
    s_cbranch_scc1 Lexit
    s_waitcnt vmcnt(0)
    v_readfirstlane_b32 s47, v53
    s_nop 0
    s_and_b32 s47, s47, 0xffff
    s_cmp_lt_u32 s47, 128
    s_cbranch_scc0 Lkvs_1073
    s_sleep 8
    s_branch Lkvp_1072
Lkvs_1073:
    v_bfe_u32 v15, v0, 3, 1
    v_lshl_add_u32 v15, v15, 8, v13
    buffer_load_dwordx4 v[20:23], v15, s[8:11], s40 offen sc1
    buffer_load_dwordx4 v[24:27], v15, s[8:11], s40 offen offset:256 sc1
    buffer_load_dwordx4 v[76:79], v13, s[8:11], s41 offen sc1
    buffer_load_dwordx4 v[16:19], v13, s[8:11], s41 offen offset:512 sc1
    v_mov_b64 v[28:29], 0
    v_mov_b64 v[30:31], 0
    v_mov_b64 v[32:33], 0
    v_mov_b64 v[34:35], 0
    v_mov_b64 v[36:37], 0
    v_mov_b64 v[38:39], 0
    v_mov_b64 v[40:41], 0
    v_mov_b64 v[42:43], 0
    v_mov_b64 v[44:45], 0
    v_mov_b64 v[46:47], 0
    v_mov_b64 v[48:49], 0
    v_mov_b64 v[50:51], 0
    ds_read_b128 v[60:63], v3 offset:0
    ds_read_b128 v[64:67], v3 offset:1024
    ds_read_b128 v[68:71], v3 offset:2048
    ds_read_b128 v[72:75], v3 offset:3072
    v_mov_b32 v14, 128
    s_waitcnt vmcnt(0)
    s_branch Lnog_1071
Lstep_1070:
    s_cmp_eq_u32 s4, 3
    s_cbranch_scc1 Lw3_1075
    s_sub_u32 s58, s37, 147456
    s_mov_b32 s66, 0
    v_add_u32 v14, s50, v3
    ds_read_b128 v[60:63], v3 offset:0
    ds_read_b128 v[64:67], v3 offset:1024
    v_mov_b64 v[28:29], 0
    v_mov_b64 v[30:31], 0
    v_mov_b64 v[32:33], 0
    v_mov_b64 v[34:35], 0
    v_mov_b64 v[36:37], 0
    v_mov_b64 v[38:39], 0
    v_mov_b64 v[40:41], 0
    v_mov_b64 v[42:43], 0
    v_mov_b64 v[44:45], 0
    v_mov_b64 v[46:47], 0
    v_mov_b64 v[48:49], 0
    v_mov_b64 v[50:51], 0
    s_cmp_lg_u32 s4, 2
    s_cbranch_scc1 Lgather_1074
    s_nop 15
    s_nop 15
    s_nop 15
    s_nop 15
    s_nop 15
    s_nop 15
    s_nop 15
Lgather_1074:
    buffer_load_dwordx4 v[52:55], v14, s[8:11], s58 offen offset:0 sc1
    buffer_load_dwordx4 v[56:59], v14, s[8:11], s58 offen offset:1024 sc1
    buffer_load_dwordx4 v[72:75], v14, s[8:11], s58 offen offset:2048 sc1
    s_add_u32 s66, s66, 1
    s_cmp_gt_u32 s66, 0x100000
    s_cbranch_scc1 Lexit
    s_waitcnt vmcnt(0)
    v_max3_u32 v15, v52, v54, v56
    v_max3_u32 v15, v15, v58, v72
    v_max_u32 v15, v15, v74
    v_cmp_eq_u32 vcc, -1, v15
    s_nop 0
    s_and_b64 exec, exec, vcc
    s_cbranch_scc1 Lgather_1074
    s_mov_b64 exec, -1
    ds_write_b128 v14, v[52:55] offset:0
    ds_write_b128 v14, v[56:59] offset:1024
    ds_write_b128 v14, v[72:75] offset:2048
    ds_read_b128 v[68:71], v3 offset:2048
    ds_read_b128 v[72:75], v3 offset:3072
    s_branch Lnog_1071
Lw3_1075:
    ds_read_b128 v[60:63], v3 offset:0
    ds_read_b128 v[64:67], v3 offset:1024
    ds_read_b128 v[68:71], v3 offset:2048
    ds_read_b128 v[72:75], v3 offset:3072
    v_mov_b64 v[28:29], 0
    v_mov_b64 v[30:31], 0
    v_mov_b64 v[32:33], 0
    v_mov_b64 v[34:35], 0
    v_mov_b64 v[36:37], 0
    v_mov_b64 v[38:39], 0
    v_mov_b64 v[40:41], 0
    v_mov_b64 v[42:43], 0
    v_mov_b64 v[44:45], 0
    v_mov_b64 v[46:47], 0
    v_mov_b64 v[48:49], 0
    v_mov_b64 v[50:51], 0
    s_waitcnt vmcnt(3)
    v_readfirstlane_b32 s46, v14
    s_nop 0
    s_and_b32 s46, s46, 0xffff
    s_cmp_ge_u32 s46, 128
    s_cbranch_scc1 Lkvok_1076
    s_add_u32 s46, s45, 1
    s_and_b32 s47, s46, 3
    s_cmp_lg_u32 s47, 0
    s_cbranch_scc1 Lkvs_1078
    s_cmp_gt_u32 s46, 63
    s_cbranch_scc1 Lkvs_1078
    v_mov_b32 v52, s46
    s_mov_b32 s66, 0
Lkvp_1077:
    global_load_dword v53, v52, s[26:27] offset:128 sc1
    s_add_u32 s66, s66, 1
    s_cmp_gt_u32 s66, 0x200000
    s_cbranch_scc1 Lexit
    s_waitcnt vmcnt(0)
    v_readfirstlane_b32 s47, v53
    s_nop 0
    s_and_b32 s47, s47, 0xffff
    s_cmp_lt_u32 s47, 128
    s_cbranch_scc0 Lkvs_1078
    s_sleep 8
    s_branch Lkvp_1077
Lkvs_1078:
Lkvok_1076:
Lnog_1071:
    s_cmp_lt_u32 s45, 63
    s_cselect_b32 s60, 8192, 0
    s_add_u32 s59, s40, s60
    s_add_u32 s60, s41, s60
    s_add_u32 s46, s45, 2
    s_min_u32 s46, s46, 63
    s_and_b32 s46, s46, 0x3c
    s_waitcnt lgkmcnt(2)
    s_barrier
    ds_read_b64_tr_b16 v[52:53], v2 offset:0
    ds_read_b64_tr_b16 v[54:55], v2 offset:256
    s_cmp_lg_u32 s4, 3
    s_cbranch_scc1 Lnopf_1079
    v_lshlrev_b32 v56, 7, v0
    v_mov_b32 v57, s46
    s_sub_u32 s46, s45, 1
    s_max_i32 s46, s46, 0
    v_mov_b32 v59, s46
    buffer_load_dword v14, v56, s[8:11], s59 offen
    buffer_load_dword v14, v56, s[8:11], s60 offen
    global_load_dword v14, v57, s[26:27] offset:128 sc1
Lnopf_1079_a:
    v_mov_b32 v58, s45
    s_mov_b64 exec, 1
    buffer_store_dword v58, v56, s[8:11], s52 offen sc1
    s_mov_b64 exec, -1
Lnopf_1079_b:
    s_cmp_lg_u32 s3, 0
    s_cbranch_scc1 Lnopf_1079
    s_mov_b32 exec_hi, 0
    buffer_store_byte v59, v56, s[8:11], s51 offen sc1
    s_mov_b64 exec, -1
Lnopf_1079:
    ds_read_b64_tr_b16 v[56:57], v2 offset:1024
    ds_read_b64_tr_b16 v[58:59], v2 offset:1280
    s_waitcnt lgkmcnt(2)
    v_smfmac_f32_16x16x64_bf16 v[28:31], v[52:55], a[0:7], v1
    v_smfmac_f32_16x16x64_bf16 v[44:47], v[52:55], v[60:67], v1
    ds_read_b128 v[60:63], v3 offset:4096
    ds_read_b128 v[64:67], v3 offset:5120
    v_smfmac_f32_16x16x64_bf16 v[32:35], v[52:55], a[8:15], v1
    v_smfmac_f32_16x16x64_bf16 v[36:39], v[52:55], a[144:151], v1
    v_smfmac_f32_16x16x64_bf16 v[48:51], v[52:55], v[68:75], v1
    ds_read_b128 v[68:71], v3 offset:6144
    ds_read_b128 v[72:75], v3 offset:7168
    v_smfmac_f32_16x16x64_bf16 v[40:43], v[52:55], a[152:159], v1
    ds_read_b64_tr_b16 v[52:53], v2 offset:2048
    ds_read_b64_tr_b16 v[54:55], v2 offset:2304
    s_waitcnt lgkmcnt(6)
    v_smfmac_f32_16x16x64_bf16 v[28:31], v[56:59], a[16:23], v1
    s_waitcnt lgkmcnt(4)
    v_smfmac_f32_16x16x64_bf16 v[44:47], v[56:59], v[60:67], v1
    ds_read_b128 v[60:63], v3 offset:8192
    ds_read_b128 v[64:67], v3 offset:9216
    v_smfmac_f32_16x16x64_bf16 v[32:35], v[56:59], a[24:31], v1
    v_smfmac_f32_16x16x64_bf16 v[36:39], v[56:59], a[160:167], v1
    s_waitcnt lgkmcnt(4)
    v_smfmac_f32_16x16x64_bf16 v[48:51], v[56:59], v[68:75], v1
    ds_read_b128 v[68:71], v3 offset:10240
    ds_read_b128 v[72:75], v3 offset:11264
    v_smfmac_f32_16x16x64_bf16 v[40:43], v[56:59], a[168:175], v1
    ds_read_b64_tr_b16 v[56:57], v2 offset:3072
    ds_read_b64_tr_b16 v[58:59], v2 offset:3328
    s_waitcnt lgkmcnt(6)
    v_smfmac_f32_16x16x64_bf16 v[28:31], v[52:55], a[32:39], v1
    s_waitcnt lgkmcnt(4)
    v_smfmac_f32_16x16x64_bf16 v[44:47], v[52:55], v[60:67], v1
    ds_read_b128 v[60:63], v3 offset:12288
    ds_read_b128 v[64:67], v3 offset:13312
    v_smfmac_f32_16x16x64_bf16 v[32:35], v[52:55], a[40:47], v1
    v_smfmac_f32_16x16x64_bf16 v[36:39], v[52:55], a[176:183], v1
    s_waitcnt lgkmcnt(4)
    v_smfmac_f32_16x16x64_bf16 v[48:51], v[52:55], v[68:75], v1
    ds_read_b128 v[68:71], v3 offset:14336
    ds_read_b128 v[72:75], v3 offset:15360
    v_smfmac_f32_16x16x64_bf16 v[40:43], v[52:55], a[184:191], v1
    ds_read_b64_tr_b16 v[52:53], v2 offset:4096
    ds_read_b64_tr_b16 v[54:55], v2 offset:4352
    s_waitcnt lgkmcnt(6)
    v_smfmac_f32_16x16x64_bf16 v[28:31], v[56:59], a[48:55], v1
    s_waitcnt lgkmcnt(4)
    v_smfmac_f32_16x16x64_bf16 v[44:47], v[56:59], v[60:67], v1
    ds_read_b128 v[60:63], v3 offset:16384
    ds_read_b128 v[64:67], v3 offset:17408
    v_smfmac_f32_16x16x64_bf16 v[32:35], v[56:59], a[56:63], v1
    v_smfmac_f32_16x16x64_bf16 v[36:39], v[56:59], a[192:199], v1
    s_waitcnt lgkmcnt(4)
    v_smfmac_f32_16x16x64_bf16 v[48:51], v[56:59], v[68:75], v1
    ds_read_b128 v[68:71], v3 offset:18432
    ds_read_b128 v[72:75], v3 offset:19456
    v_smfmac_f32_16x16x64_bf16 v[40:43], v[56:59], a[200:207], v1
    ds_read_b64_tr_b16 v[56:57], v2 offset:5120
    ds_read_b64_tr_b16 v[58:59], v2 offset:5376
    s_waitcnt lgkmcnt(6)
    v_smfmac_f32_16x16x64_bf16 v[28:31], v[52:55], a[64:71], v1
    s_waitcnt lgkmcnt(4)
    v_smfmac_f32_16x16x64_bf16 v[44:47], v[52:55], v[60:67], v1
    ds_read_b128 v[60:63], v3 offset:20480
    ds_read_b128 v[64:67], v3 offset:21504
    v_smfmac_f32_16x16x64_bf16 v[32:35], v[52:55], a[72:79], v1
    v_smfmac_f32_16x16x64_bf16 v[36:39], v[52:55], a[208:215], v1
    s_waitcnt lgkmcnt(4)
    v_smfmac_f32_16x16x64_bf16 v[48:51], v[52:55], v[68:75], v1
    ds_read_b128 v[68:71], v3 offset:22528
    ds_read_b128 v[72:75], v3 offset:23552
    v_smfmac_f32_16x16x64_bf16 v[40:43], v[52:55], a[216:223], v1
    ds_read_b64_tr_b16 v[52:53], v2 offset:6144
    ds_read_b64_tr_b16 v[54:55], v2 offset:6400
    s_waitcnt lgkmcnt(6)
    v_smfmac_f32_16x16x64_bf16 v[28:31], v[56:59], a[80:87], v1
    s_waitcnt lgkmcnt(4)
    v_smfmac_f32_16x16x64_bf16 v[44:47], v[56:59], v[60:67], v1
    ds_read_b128 v[60:63], v3 offset:24576
    ds_read_b128 v[64:67], v3 offset:25600
    v_smfmac_f32_16x16x64_bf16 v[32:35], v[56:59], a[88:95], v1
    v_smfmac_f32_16x16x64_bf16 v[36:39], v[56:59], a[224:231], v1
    s_waitcnt lgkmcnt(4)
    v_smfmac_f32_16x16x64_bf16 v[48:51], v[56:59], v[68:75], v1
    ds_read_b128 v[68:71], v3 offset:26624
    ds_read_b128 v[72:75], v3 offset:27648
    v_smfmac_f32_16x16x64_bf16 v[40:43], v[56:59], a[232:239], v1
    ds_read_b64_tr_b16 v[56:57], v2 offset:7168
    ds_read_b64_tr_b16 v[58:59], v2 offset:7424
    s_waitcnt lgkmcnt(6)
    v_smfmac_f32_16x16x64_bf16 v[28:31], v[52:55], a[96:103], v1
    s_waitcnt lgkmcnt(4)
    v_smfmac_f32_16x16x64_bf16 v[44:47], v[52:55], v[60:67], v1
    ds_read_b128 v[60:63], v3 offset:28672
    ds_read_b128 v[64:67], v3 offset:29696
    v_smfmac_f32_16x16x64_bf16 v[32:35], v[52:55], a[104:111], v1
    v_smfmac_f32_16x16x64_bf16 v[36:39], v[52:55], a[240:247], v1
    s_waitcnt lgkmcnt(4)
    v_smfmac_f32_16x16x64_bf16 v[48:51], v[52:55], v[68:75], v1
    ds_read_b128 v[68:71], v3 offset:30720
    ds_read_b128 v[72:75], v3 offset:31744
    v_smfmac_f32_16x16x64_bf16 v[40:43], v[52:55], a[248:255], v1
    ds_read_b64_tr_b16 v[52:53], v2 offset:8192
    ds_read_b64_tr_b16 v[54:55], v2 offset:8448
    s_waitcnt lgkmcnt(6)
    v_smfmac_f32_16x16x64_bf16 v[28:31], v[56:59], a[112:119], v1
    s_waitcnt lgkmcnt(4)
    v_smfmac_f32_16x16x64_bf16 v[44:47], v[56:59], v[60:67], v1
    ds_read_b128 v[60:63], v3 offset:32768
    ds_read_b128 v[64:67], v3 offset:33792
    v_smfmac_f32_16x16x64_bf16 v[32:35], v[56:59], a[120:127], v1
    v_smfmac_f32_16x16x64_bf16 v[36:39], v[56:59], v[80:87], v1
    s_waitcnt lgkmcnt(4)
    v_smfmac_f32_16x16x64_bf16 v[48:51], v[56:59], v[68:75], v1
    ds_read_b128 v[68:71], v3 offset:34816
    ds_read_b128 v[72:75], v3 offset:35840
    v_smfmac_f32_16x16x64_bf16 v[40:43], v[56:59], v[88:95], v1
    s_waitcnt lgkmcnt(4)
    v_smfmac_f32_16x16x64_bf16 v[28:31], v[52:55], a[128:135], v1
    v_smfmac_f32_16x16x64_bf16 v[32:35], v[52:55], a[136:143], v1
    v_smfmac_f32_16x16x64_bf16 v[36:39], v[52:55], v[96:103], v1
    v_smfmac_f32_16x16x64_bf16 v[40:43], v[52:55], v[104:111], v1
    s_waitcnt lgkmcnt(2)
    v_smfmac_f32_16x16x64_bf16 v[44:47], v[52:55], v[60:67], v1
    s_waitcnt lgkmcnt(0)
    v_smfmac_f32_16x16x64_bf16 v[48:51], v[52:55], v[68:75], v1
    s_nop 0
    v_pk_add_f32 v[28:29], v[28:29], v[30:31]
    v_cvt_pk_bf16_f32 v28, v28, v29
    v_pk_add_f32 v[32:33], v[32:33], v[34:35]
    v_cvt_pk_bf16_f32 v32, v32, v33
    ds_write2_b32 v4, v28, v32 offset0:0 offset1:64
    v_add_u32 v15, s36, v4
    v_add_u32 v60, s36, v5
    ds_read_b64_tr_b16 v[52:53], v5
    ds_read_b64_tr_b16 v[54:55], v5 offset:128
    v_pk_add_f32 v[36:37], v[36:37], v[38:39]
    v_cvt_pk_bf16_f32 v36, v36, v37
    v_pk_add_f32 v[40:41], v[40:41], v[42:43]
    v_cvt_pk_bf16_f32 v40, v40, v41
    ds_write2_b32 v15, v36, v40 offset0:0 offset1:64
    ds_read_b64_tr_b16 v[56:57], v60
    ds_read_b64_tr_b16 v[58:59], v60 offset:128
    v_add_u32 v72, s48, v6
    v_and_b32 v73, 0xff, v6
    v_add_u32 v73, s49, v73
    v_pk_add_f32 v[44:45], v[44:45], v[46:47]
    v_cvt_pk_bf16_f32 v44, v44, v45
    v_pk_add_f32 v[48:49], v[48:49], v[50:51]
    v_cvt_pk_bf16_f32 v48, v48, v49
    s_waitcnt lgkmcnt(3)
    v_mfma_f32_16x16x32_bf16 v[60:63], v[20:23], v[52:55], 0
    v_mfma_f32_16x16x32_bf16 v[64:67], v[24:27], v[52:55], 0
    v_lshrrev_b32 v29, 10, v13
    v_and_b32 v30, 0xf0, v13
    s_waitcnt lgkmcnt(0)
    v_mfma_f32_16x16x32_bf16 v[68:71], v[56:59], v[52:55], 0
    v_lshl_or_b32 v29, v29, 8, v30
    buffer_store_dword v44, v4, s[8:11], s43 offen sc1
    buffer_store_dword v48, v4, s[8:11], s43 offen offset:256 sc1
    buffer_store_dwordx4 v[56:59], v29, s[8:11], s42 offen sc1
    s_cmp_eq_u32 s45, 63
    s_cbranch_scc1 Lr_done
    v_cndmask_b32 v60, v60, v64, s[34:35]
    v_cndmask_b32 v61, v61, v65, s[34:35]
    v_cndmask_b32 v62, v62, v66, s[34:35]
    v_cndmask_b32 v63, v63, v67, s[34:35]
    ds_write_b128 v72, v[60:63]
    ds_write_b128 v73, v[68:71]
    v_mov_b32 v64, 0x3f803f80
    v_mov_b32 v65, 0x3f803f80
    v_mov_b32 v66, 0x3f803f80
    v_mov_b32 v67, 0x3f803f80
    v_mov_b32 v45, 0
    v_mov_b32 v49, 0
    v_mov_b64 v[46:47], 0
    v_mov_b64 v[50:51], 0
    s_waitcnt lgkmcnt(0)
    s_barrier
    ds_read_b128 v[28:31], v6 offset:0
    ds_read_b128 v[32:35], v6 offset:1280
    ds_read_b128 v[36:39], v6 offset:2560
    ds_read_b128 v[40:43], v6 offset:3840
    ds_read_b32 v52, v7 offset:0
    ds_read_b32 v53, v7 offset:1280
    ds_read_b32 v54, v7 offset:2560
    ds_read_b32 v55, v7 offset:3840
    s_add_u32 s40, s40, 8192
    s_add_u32 s41, s41, 8192
    s_add_u32 s42, s42, 65536
    s_add_u32 s43, s43, 65536
    v_bfe_u32 v15, v0, 3, 1
    v_lshl_add_u32 v15, v15, 8, v13
    buffer_load_dwordx4 v[20:23], v15, s[8:11], s40 offen sc1
    buffer_load_dwordx4 v[24:27], v15, s[8:11], s40 offen offset:256 sc1
    s_waitcnt lgkmcnt(6)
    v_pk_add_f32 v[28:29], v[28:29], v[32:33]
    v_pk_add_f32 v[30:31], v[30:31], v[34:35]
    s_waitcnt lgkmcnt(4)
    v_pk_add_f32 v[36:37], v[36:37], v[40:41]
    v_pk_add_f32 v[38:39], v[38:39], v[42:43]
    s_waitcnt lgkmcnt(0)
    v_pk_add_f32 v[52:53], v[52:53], v[54:55]
    v_pk_add_f32 v[28:29], v[28:29], v[36:37]
    v_pk_add_f32 v[30:31], v[30:31], v[38:39]
    v_add_f32 v52, v52, v53
    v_max3_f32 v60, v28, v29, v30
    v_max3_f32 v60, v60, v31, v52
    v_mov_b64 v[32:33], 0
    v_mov_b64 v[34:35], 0
    v_max_f32_dpp v60, v60, v60 row_ror:8 row_mask:0xf bank_mask:0xf
    v_mov_b32 v61, v60
    v_mov_b64 v[36:37], 0
    v_mov_b64 v[38:39], 0
    v_permlane16_swap_b32 v60, v61
    v_max_f32 v60, v60, v61
    v_mov_b32 v61, v60
    s_nop 1
    v_permlane32_swap_b32 v60, v61
    v_max_f32 v60, v60, v61
    v_mul_f32 v60, s56, v60
    v_fma_f32 v52, v52, s56, -v60
    v_fma_f32 v28, v28, s56, -v60
    v_fma_f32 v29, v29, s56, -v60
    v_fma_f32 v30, v30, s56, -v60
    v_fma_f32 v31, v31, s56, -v60
    v_exp_f32 v52, v52
    v_exp_f32 v28, v28
    v_exp_f32 v29, v29
    v_exp_f32 v30, v30
    v_exp_f32 v31, v31
    v_mov_b32_dpp v53, v52 row_ror:8 row_mask:0xf bank_mask:0xf
    v_cvt_pk_bf16_f32 v60, v28, v29
    v_cvt_pk_bf16_f32 v61, v30, v31
    v_cvt_pk_bf16_f32 v52, v52, v53
    v_mov_b32 v53, 0
    v_mov_b64 v[54:55], 0
    v_mov_b32_dpp v62, v60 row_ror:8 row_mask:0xf bank_mask:0xf
    v_mov_b32_dpp v63, v61 row_ror:8 row_mask:0xf bank_mask:0xf
    v_mfma_f32_16x16x32_bf16 v[40:43], v[64:67], v[52:55], 0
    s_nop 0
    v_mfma_f32_16x16x32_bf16 v[40:43], v[64:67], v[60:63], v[40:43]
    v_mfma_f32_16x16x32_bf16 v[68:71], v[44:47], v[52:55], 0
    v_mfma_f32_16x16x32_bf16 v[68:71], v[76:79], v[60:63], v[68:71]
    v_mfma_f32_16x16x32_bf16 v[56:59], v[48:51], v[52:55], 0
    v_mfma_f32_16x16x32_bf16 v[56:59], v[16:19], v[60:63], v[56:59]
    v_mov_b64 v[28:29], 0
    v_mov_b64 v[30:31], 0
    s_nop 1
    v_rcp_f32 v40, v40
    v_xor_b32 v15, 32, v8
    v_pk_mul_f32 v[68:69], v[68:69], v[40:41] op_sel_hi:[1,0]
    v_pk_mul_f32 v[70:71], v[70:71], v[40:41] op_sel_hi:[1,0]
    v_cvt_pk_bf16_f32 v68, v68, v69
    v_cvt_pk_bf16_f32 v69, v70, v71
    v_pk_mul_f32 v[56:57], v[56:57], v[40:41] op_sel_hi:[1,0]
    v_pk_mul_f32 v[58:59], v[58:59], v[40:41] op_sel_hi:[1,0]
    v_cvt_pk_bf16_f32 v56, v56, v57
    v_cvt_pk_bf16_f32 v57, v58, v59
    s_mov_b64 exec, s[32:33]
    ds_write_b64 v8, v[68:69]
    ds_write_b64 v15, v[56:57]
    s_mov_b64 exec, -1
    v_xor_b32 v15, 128, v9
    buffer_load_dwordx4 v[76:79], v13, s[8:11], s41 offen sc1
    buffer_load_dwordx4 v[16:19], v13, s[8:11], s41 offen offset:512 sc1
    v_mov_b64 v[40:41], 0
    v_mov_b64 v[42:43], 0
    v_mov_b64 v[44:45], 0
    v_mov_b64 v[48:49], 0
    v_mov_b64 v[52:53], 0
    v_mov_b64 v[54:55], 0
    s_lshl_b32 s46, s4, 3
    v_lshrrev_b32 v72, 4, v0
    v_bfe_u32 v73, v0, 2, 1
    v_lshl_add_u32 v72, v72, 1, v73
    v_add_u32 v72, s46, v72
    v_mul_u32_u24 v72, 9216, v72
    v_and_b32 v73, 3, v0
    v_lshl_add_u32 v72, v73, 3, v72
    s_waitcnt lgkmcnt(0)
    s_barrier
    ds_read_b128 v[64:67], v9
    ds_read_b128 v[68:71], v15
    v_mov_b64 v[56:57], 0
    v_mov_b64 v[58:59], 0
    v_mov_b64 v[60:61], 0
    v_mov_b64 v[62:63], 0
    s_waitcnt lgkmcnt(1)
    s_nop 0
    v_smfmac_f32_16x16x64_bf16 v[60:63], v[64:67], v[240:247], v1
    v_smfmac_f32_16x16x64_bf16 v[28:31], v[64:67], v[112:119], v1
    v_smfmac_f32_16x16x64_bf16 v[32:35], v[64:67], v[128:135], v1
    s_waitcnt lgkmcnt(0)
    v_smfmac_f32_16x16x64_bf16 v[60:63], v[68:71], v[248:255], v1
    v_smfmac_f32_16x16x64_bf16 v[28:31], v[68:71], v[120:127], v1
    v_smfmac_f32_16x16x64_bf16 v[32:35], v[68:71], v[136:143], v1
    s_nop 5
    v_add_f32 v60, v60, v62
    v_add_f32 v61, v61, v63
    v_smfmac_f32_16x16x64_bf16 v[36:39], v[64:67], v[144:151], v1
    v_cvt_pk_bf16_f32 v60, v60, v61
    s_nop 1
    v_mov_b32_dpp v61, v60 row_ror:8 row_mask:0xf bank_mask:0xf
    v_smfmac_f32_16x16x64_bf16 v[36:39], v[68:71], v[152:159], v1
    v_bfi_b32 v60, 1, s44, v60
    s_mov_b64 exec, s[32:33]
    buffer_store_dwordx2 v[60:61], v72, s[8:11], s31 offen
    s_mov_b64 exec, -1
    v_smfmac_f32_16x16x64_bf16 v[40:43], v[64:67], v[160:167], v1
    v_smfmac_f32_16x16x64_bf16 v[40:43], v[68:71], v[168:175], v1
    v_smfmac_f32_16x16x64_bf16 v[44:47], v[64:67], v[176:183], v1
    v_smfmac_f32_16x16x64_bf16 v[44:47], v[68:71], v[184:191], v1
    v_add_f32 v28, v28, v30
    v_add_f32 v29, v29, v31
    v_smfmac_f32_16x16x64_bf16 v[48:51], v[64:67], v[192:199], v1
    v_cvt_pk_bf16_f32 v72, v28, v29
    v_add_f32 v32, v32, v34
    v_smfmac_f32_16x16x64_bf16 v[48:51], v[68:71], v[200:207], v1
    v_add_f32 v33, v33, v35
    v_cvt_pk_bf16_f32 v73, v32, v33
    v_smfmac_f32_16x16x64_bf16 v[52:55], v[64:67], v[208:215], v1
    v_add_f32 v36, v36, v38
    v_add_f32 v37, v37, v39
    v_smfmac_f32_16x16x64_bf16 v[52:55], v[68:71], v[216:223], v1
    v_cvt_pk_bf16_f32 v74, v36, v37
    v_add_f32 v40, v40, v42
    v_smfmac_f32_16x16x64_bf16 v[56:59], v[64:67], v[224:231], v1
    v_add_f32 v41, v41, v43
    v_cvt_pk_bf16_f32 v75, v40, v41
    v_smfmac_f32_16x16x64_bf16 v[56:59], v[68:71], v[232:239], v1
    v_bfi_b32 v72, 1, s44, v72
    buffer_store_dwordx4 v[72:75], v10, s[8:11], s28 offen
    v_add_f32 v44, v44, v46
    v_add_f32 v45, v45, v47
    v_cvt_pk_bf16_f32 v28, v44, v45
    v_add_f32 v48, v48, v50
    v_add_f32 v49, v49, v51
    v_cvt_pk_bf16_f32 v29, v48, v49
    v_pk_add_f32 v[52:53], v[52:53], v[54:55]
    v_cvt_pk_bf16_f32 v30, v52, v53
    v_pk_add_f32 v[56:57], v[56:57], v[58:59]
    v_cvt_pk_bf16_f32 v31, v56, v57
    v_bfi_b32 v28, 1, s44, v28
    buffer_store_dwordx4 v[28:31], v10, s[8:11], s30 offen
    s_cmp_eq_u32 s4, 3
    s_cbranch_scc1 Lnored_1080
    v_and_b32 v15, 1, v0
    v_lshlrev_b32 v15, 4, v15
    v_mov_b32 v70, 0x3f80
    v_lshlrev_b32 v70, v15, v70
    v_bfe_u32 v15, v0, 1, 3
    v_cmp_eq_u32 vcc, 0, v15
    s_nop 1
    v_cndmask_b32 v64, 0, v70, vcc
    v_cmp_eq_u32 vcc, 1, v15
    s_nop 1
    v_cndmask_b32 v65, 0, v70, vcc
    v_cmp_eq_u32 vcc, 2, v15
    s_nop 1
    v_cndmask_b32 v66, 0, v70, vcc
    v_cmp_eq_u32 vcc, 3, v15
    s_nop 1
    v_cndmask_b32 v67, 0, v70, vcc
    s_mov_b32 s66, 0
    s_sub_u32 s46, s44, 1
    s_cmp_eq_u32 s4, 2
    s_cbranch_scc1 Lw2_1084
    v_mov_b32 v68, -1
    v_mov_b32 v69, -1
    s_nop 15
    s_nop 15
    s_nop 15
    s_nop 15
Lred_1081:
    buffer_load_dwordx4 v[28:31], v11, s[8:11], s29 offen offset:0 sc1
    buffer_load_dwordx4 v[32:35], v11, s[8:11], s29 offen offset:1024 sc1
    buffer_load_dwordx4 v[36:39], v11, s[8:11], s29 offen offset:2048 sc1
    buffer_load_dwordx4 v[40:43], v11, s[8:11], s29 offen offset:3072 sc1
    s_add_u32 s66, s66, 1
    s_cmp_gt_u32 s66, 0x100000
    s_cbranch_scc1 Lexit
    s_waitcnt vmcnt(0)
    v_bitop3_b32 v60, v28, v32, s46 bitop3:0x42
    v_bitop3_b32 v61, v36, v40, s46 bitop3:0x42
    v_bitop3_b32 v60, v60, v61, 1 bitop3:0x80
    v_cmp_eq_u32 vcc, 0, v60
    s_nop 0
    s_and_b64 exec, exec, vcc
    s_cbranch_scc1 Lred_1081
    s_mov_b64 exec, -1
    v_mfma_f32_16x16x32_bf16 v[60:63], v[64:67], v[28:31], 0
    v_mfma_f32_16x16x32_bf16 v[44:47], v[64:67], v[32:35], 0
    v_mfma_f32_16x16x32_bf16 v[60:63], v[64:67], v[36:39], v[60:63]
    v_mfma_f32_16x16x32_bf16 v[60:63], v[64:67], v[40:43], v[60:63]
    s_nop 7
    v_pk_add_f32 v[60:61], v[60:61], v[44:45]
    v_pk_add_f32 v[62:63], v[62:63], v[46:47]
    s_nop 0
    v_add_f32_dpp v60, v60, v60 row_ror:8 row_mask:0xf bank_mask:0xf
    v_add_f32_dpp v61, v61, v61 row_ror:8 row_mask:0xf bank_mask:0xf
    v_add_f32_dpp v62, v62, v62 row_ror:8 row_mask:0xf bank_mask:0xf
    v_add_f32_dpp v63, v63, v63 row_ror:8 row_mask:0xf bank_mask:0xf
    s_branch Lpub_1083
Lw2_1084:
    v_mov_b32 v68, -1
    v_mov_b32 v69, -1
Lred2_1082:
    buffer_load_dwordx4 v[28:31], v11, s[8:11], s29 offen offset:0 sc1
    s_add_u32 s66, s66, 1
    s_cmp_gt_u32 s66, 0x100000
    s_cbranch_scc1 Lexit
    s_waitcnt vmcnt(0)
    v_bitop3_b32 v60, v28, v30, s46 bitop3:0x42
    v_and_b32 v60, 1, v60
    v_cmp_eq_u32 vcc, 0, v60
    s_nop 0
    s_and_b64 exec, exec, vcc
    s_cbranch_scc1 Lred2_1082
    s_mov_b64 exec, -1
    v_mfma_f32_16x16x32_bf16 v[60:63], v[64:67], v[28:31], 0
    s_nop 7
    v_add_f32_dpp v60, v60, v60 row_ror:2 row_mask:0xf bank_mask:0xf
    v_add_f32_dpp v61, v61, v61 row_ror:2 row_mask:0xf bank_mask:0xf
    v_add_f32_dpp v62, v62, v62 row_ror:2 row_mask:0xf bank_mask:0xf
    v_add_f32_dpp v63, v63, v63 row_ror:2 row_mask:0xf bank_mask:0xf
    v_add_f32_dpp v60, v60, v60 row_ror:4 row_mask:0xf bank_mask:0xf
    v_add_f32_dpp v61, v61, v61 row_ror:4 row_mask:0xf bank_mask:0xf
    v_add_f32_dpp v62, v62, v62 row_ror:4 row_mask:0xf bank_mask:0xf
    v_add_f32_dpp v63, v63, v63 row_ror:4 row_mask:0xf bank_mask:0xf
    v_add_f32_dpp v60, v60, v60 row_ror:8 row_mask:0xf bank_mask:0xf
    v_add_f32_dpp v61, v61, v61 row_ror:8 row_mask:0xf bank_mask:0xf
    v_add_f32_dpp v62, v62, v62 row_ror:8 row_mask:0xf bank_mask:0xf
    v_add_f32_dpp v63, v63, v63 row_ror:8 row_mask:0xf bank_mask:0xf
Lpub_1083:
    v_cvt_pk_bf16_f32 v60, v60, v61
    v_cvt_pk_bf16_f32 v61, v62, v63
    v_min_u32 v60, s67, v60
    s_mov_b64 exec, s[54:55]
    buffer_store_dwordx2 v[60:61], v12, s[8:11], s38 offen
    buffer_store_dwordx2 v[68:69], v12, s[8:11], s37 offen
    s_mov_b64 exec, -1
Lnored_1080:
    s_mov_b32 s46, s37
    s_mov_b32 s37, s38
    s_mov_b32 s38, s39
    s_mov_b32 s39, s46
    s_xor_b32 s44, s44, 1
    s_add_u32 s45, s45, 1
    s_branch Lstep_1070
Lr_slow:
    s_add_u32 s46, s45, 0
    s_and_b32 s47, s46, 3
    s_cmp_lg_u32 s47, 0
    s_cbranch_scc1 Lkvs_1088
    s_cmp_gt_u32 s46, 63
    s_cbranch_scc1 Lkvs_1088
    v_mov_b32 v52, s46
    s_mov_b32 s66, 0
Lkvp_1087:
    global_load_dword v53, v52, s[26:27] offset:128 sc1
    s_add_u32 s66, s66, 1
    s_cmp_gt_u32 s66, 0x200000
    s_cbranch_scc1 Lexit
    s_waitcnt vmcnt(0)
    v_readfirstlane_b32 s47, v53
    s_nop 0
    s_and_b32 s47, s47, 0xffff
    s_cmp_lt_u32 s47, 128
    s_cbranch_scc0 Lkvs_1088
    s_sleep 8
    s_branch Lkvp_1087
Lkvs_1088:
    v_bfe_u32 v15, v0, 3, 1
    v_lshl_add_u32 v15, v15, 8, v13
    buffer_load_dwordx4 v[20:23], v15, s[8:11], s40 offen sc1
    buffer_load_dwordx4 v[24:27], v15, s[8:11], s40 offen offset:256 sc1
    buffer_load_dwordx4 v[76:79], v13, s[8:11], s41 offen sc1
    buffer_load_dwordx4 v[16:19], v13, s[8:11], s41 offen offset:512 sc1
    v_mov_b64 v[28:29], 0
    v_mov_b64 v[30:31], 0
    v_mov_b64 v[32:33], 0
    v_mov_b64 v[34:35], 0
    v_mov_b64 v[36:37], 0
    v_mov_b64 v[38:39], 0
    v_mov_b64 v[40:41], 0
    v_mov_b64 v[42:43], 0
    v_mov_b64 v[44:45], 0
    v_mov_b64 v[46:47], 0
    v_mov_b64 v[48:49], 0
    v_mov_b64 v[50:51], 0
    ds_read_b128 v[60:63], v3 offset:0
    ds_read_b128 v[64:67], v3 offset:1024
    ds_read_b128 v[68:71], v3 offset:2048
    ds_read_b128 v[72:75], v3 offset:3072
    v_mov_b32 v14, 128
    s_waitcnt vmcnt(0)
    s_branch Lnog_1086
Lstep_1085:
    s_cmp_eq_u32 s4, 3
    s_cbranch_scc1 Lw3_1090
    s_sub_u32 s58, s37, 147456
    s_mov_b32 s66, 0
    v_add_u32 v14, s50, v3
    ds_read_b128 v[60:63], v3 offset:0
    ds_read_b128 v[64:67], v3 offset:1024
    v_mov_b64 v[28:29], 0
    v_mov_b64 v[30:31], 0
    v_mov_b64 v[32:33], 0
    v_mov_b64 v[34:35], 0
    v_mov_b64 v[36:37], 0
    v_mov_b64 v[38:39], 0
    v_mov_b64 v[40:41], 0
    v_mov_b64 v[42:43], 0
    v_mov_b64 v[44:45], 0
    v_mov_b64 v[46:47], 0
    v_mov_b64 v[48:49], 0
    v_mov_b64 v[50:51], 0
    s_cmp_lg_u32 s4, 2
    s_cbranch_scc1 Lgather_1089
    s_nop 15
    s_nop 15
    s_nop 15
    s_nop 15
    s_nop 15
    s_nop 15
    s_nop 15
Lgather_1089:
    buffer_load_dwordx4 v[52:55], v14, s[8:11], s58 offen offset:0 sc1
    buffer_load_dwordx4 v[56:59], v14, s[8:11], s58 offen offset:1024 sc1
    buffer_load_dwordx4 v[72:75], v14, s[8:11], s58 offen offset:2048 sc1
    s_add_u32 s66, s66, 1
    s_cmp_gt_u32 s66, 0x100000
    s_cbranch_scc1 Lexit
    s_waitcnt vmcnt(0)
    v_max3_u32 v15, v52, v54, v56
    v_max3_u32 v15, v15, v58, v72
    v_max_u32 v15, v15, v74
    v_cmp_eq_u32 vcc, -1, v15
    s_nop 0
    s_and_b64 exec, exec, vcc
    s_cbranch_scc1 Lgather_1089
    s_mov_b64 exec, -1
    ds_write_b128 v14, v[52:55] offset:0
    ds_write_b128 v14, v[56:59] offset:1024
    ds_write_b128 v14, v[72:75] offset:2048
    ds_read_b128 v[68:71], v3 offset:2048
    ds_read_b128 v[72:75], v3 offset:3072
    s_branch Lnog_1086
Lw3_1090:
    ds_read_b128 v[60:63], v3 offset:0
    ds_read_b128 v[64:67], v3 offset:1024
    ds_read_b128 v[68:71], v3 offset:2048
    ds_read_b128 v[72:75], v3 offset:3072
    v_mov_b64 v[28:29], 0
    v_mov_b64 v[30:31], 0
    v_mov_b64 v[32:33], 0
    v_mov_b64 v[34:35], 0
    v_mov_b64 v[36:37], 0
    v_mov_b64 v[38:39], 0
    v_mov_b64 v[40:41], 0
    v_mov_b64 v[42:43], 0
    v_mov_b64 v[44:45], 0
    v_mov_b64 v[46:47], 0
    v_mov_b64 v[48:49], 0
    v_mov_b64 v[50:51], 0
    s_waitcnt vmcnt(3)
    v_readfirstlane_b32 s46, v14
    s_nop 0
    s_and_b32 s46, s46, 0xffff
    s_cmp_ge_u32 s46, 128
    s_cbranch_scc1 Lkvok_1091
    s_add_u32 s46, s45, 1
    s_and_b32 s47, s46, 3
    s_cmp_lg_u32 s47, 0
    s_cbranch_scc1 Lkvs_1093
    s_cmp_gt_u32 s46, 63
    s_cbranch_scc1 Lkvs_1093
    v_mov_b32 v52, s46
    s_mov_b32 s66, 0
Lkvp_1092:
    global_load_dword v53, v52, s[26:27] offset:128 sc1
    s_add_u32 s66, s66, 1
    s_cmp_gt_u32 s66, 0x200000
    s_cbranch_scc1 Lexit
    s_waitcnt vmcnt(0)
    v_readfirstlane_b32 s47, v53
    s_nop 0
    s_and_b32 s47, s47, 0xffff
    s_cmp_lt_u32 s47, 128
    s_cbranch_scc0 Lkvs_1093
    s_sleep 8
    s_branch Lkvp_1092
Lkvs_1093:
Lkvok_1091:
Lnog_1086:
    s_cmp_lt_u32 s45, 63
    s_cselect_b32 s60, 8192, 0
    s_add_u32 s59, s40, s60
    s_add_u32 s60, s41, s60
    s_add_u32 s46, s45, 2
    s_min_u32 s46, s46, 63
    s_and_b32 s46, s46, 0x3c
    s_waitcnt lgkmcnt(2)
    s_barrier
    ds_read_b64_tr_b16 v[52:53], v2 offset:0
    ds_read_b64_tr_b16 v[54:55], v2 offset:256
    s_cmp_lg_u32 s4, 3
    s_cbranch_scc1 Lnopf_1094
    v_lshlrev_b32 v56, 7, v0
    v_mov_b32 v57, s46
    s_sub_u32 s46, s45, 1
    s_max_i32 s46, s46, 0
    v_mov_b32 v59, s46
    buffer_load_dword v14, v56, s[8:11], s59 offen
    buffer_load_dword v14, v56, s[8:11], s60 offen
    global_load_dword v14, v57, s[26:27] offset:128 sc1
Lnopf_1094_a:
    v_mov_b32 v58, s45
    s_mov_b64 exec, 1
    buffer_store_dword v58, v56, s[8:11], s52 offen sc1
    s_mov_b64 exec, -1
Lnopf_1094_b:
    s_cmp_lg_u32 s3, 0
    s_cbranch_scc1 Lnopf_1094
    s_mov_b32 exec_hi, 0
    buffer_store_byte v59, v56, s[8:11], s51 offen sc1
    s_mov_b64 exec, -1
Lnopf_1094:
    ds_read_b64_tr_b16 v[56:57], v2 offset:1024
    ds_read_b64_tr_b16 v[58:59], v2 offset:1280
    s_waitcnt lgkmcnt(2)
    v_smfmac_f32_16x16x64_bf16 v[28:31], v[52:55], a[0:7], v1
    v_smfmac_f32_16x16x64_bf16 v[44:47], v[52:55], v[60:67], v1
    ds_read_b128 v[60:63], v3 offset:4096
    ds_read_b128 v[64:67], v3 offset:5120
    v_smfmac_f32_16x16x64_bf16 v[32:35], v[52:55], a[8:15], v1
    v_smfmac_f32_16x16x64_bf16 v[36:39], v[52:55], a[144:151], v1
    v_smfmac_f32_16x16x64_bf16 v[48:51], v[52:55], v[68:75], v1
    ds_read_b128 v[68:71], v3 offset:6144
    ds_read_b128 v[72:75], v3 offset:7168
    v_smfmac_f32_16x16x64_bf16 v[40:43], v[52:55], a[152:159], v1
    ds_read_b64_tr_b16 v[52:53], v2 offset:2048
    ds_read_b64_tr_b16 v[54:55], v2 offset:2304
    s_waitcnt lgkmcnt(6)
    v_smfmac_f32_16x16x64_bf16 v[28:31], v[56:59], a[16:23], v1
    s_waitcnt lgkmcnt(4)
    v_smfmac_f32_16x16x64_bf16 v[44:47], v[56:59], v[60:67], v1
    ds_read_b128 v[60:63], v3 offset:8192
    ds_read_b128 v[64:67], v3 offset:9216
    v_smfmac_f32_16x16x64_bf16 v[32:35], v[56:59], a[24:31], v1
    v_smfmac_f32_16x16x64_bf16 v[36:39], v[56:59], a[160:167], v1
    s_waitcnt lgkmcnt(4)
    v_smfmac_f32_16x16x64_bf16 v[48:51], v[56:59], v[68:75], v1
    ds_read_b128 v[68:71], v3 offset:10240
    ds_read_b128 v[72:75], v3 offset:11264
    v_smfmac_f32_16x16x64_bf16 v[40:43], v[56:59], a[168:175], v1
    ds_read_b64_tr_b16 v[56:57], v2 offset:3072
    ds_read_b64_tr_b16 v[58:59], v2 offset:3328
    s_waitcnt lgkmcnt(6)
    v_smfmac_f32_16x16x64_bf16 v[28:31], v[52:55], a[32:39], v1
    s_waitcnt lgkmcnt(4)
    v_smfmac_f32_16x16x64_bf16 v[44:47], v[52:55], v[60:67], v1
    ds_read_b128 v[60:63], v3 offset:12288
    ds_read_b128 v[64:67], v3 offset:13312
    v_smfmac_f32_16x16x64_bf16 v[32:35], v[52:55], a[40:47], v1
    v_smfmac_f32_16x16x64_bf16 v[36:39], v[52:55], a[176:183], v1
    s_waitcnt lgkmcnt(4)
    v_smfmac_f32_16x16x64_bf16 v[48:51], v[52:55], v[68:75], v1
    ds_read_b128 v[68:71], v3 offset:14336
    ds_read_b128 v[72:75], v3 offset:15360
    v_smfmac_f32_16x16x64_bf16 v[40:43], v[52:55], a[184:191], v1
    ds_read_b64_tr_b16 v[52:53], v2 offset:4096
    ds_read_b64_tr_b16 v[54:55], v2 offset:4352
    s_waitcnt lgkmcnt(6)
    v_smfmac_f32_16x16x64_bf16 v[28:31], v[56:59], a[48:55], v1
    s_waitcnt lgkmcnt(4)
    v_smfmac_f32_16x16x64_bf16 v[44:47], v[56:59], v[60:67], v1
    ds_read_b128 v[60:63], v3 offset:16384
    ds_read_b128 v[64:67], v3 offset:17408
    v_smfmac_f32_16x16x64_bf16 v[32:35], v[56:59], a[56:63], v1
    v_smfmac_f32_16x16x64_bf16 v[36:39], v[56:59], a[192:199], v1
    s_waitcnt lgkmcnt(4)
    v_smfmac_f32_16x16x64_bf16 v[48:51], v[56:59], v[68:75], v1
    ds_read_b128 v[68:71], v3 offset:18432
    ds_read_b128 v[72:75], v3 offset:19456
    v_smfmac_f32_16x16x64_bf16 v[40:43], v[56:59], a[200:207], v1
    ds_read_b64_tr_b16 v[56:57], v2 offset:5120
    ds_read_b64_tr_b16 v[58:59], v2 offset:5376
    s_waitcnt lgkmcnt(6)
    v_smfmac_f32_16x16x64_bf16 v[28:31], v[52:55], a[64:71], v1
    s_waitcnt lgkmcnt(4)
    v_smfmac_f32_16x16x64_bf16 v[44:47], v[52:55], v[60:67], v1
    ds_read_b128 v[60:63], v3 offset:20480
    ds_read_b128 v[64:67], v3 offset:21504
    v_smfmac_f32_16x16x64_bf16 v[32:35], v[52:55], a[72:79], v1
    v_smfmac_f32_16x16x64_bf16 v[36:39], v[52:55], a[208:215], v1
    s_waitcnt lgkmcnt(4)
    v_smfmac_f32_16x16x64_bf16 v[48:51], v[52:55], v[68:75], v1
    ds_read_b128 v[68:71], v3 offset:22528
    ds_read_b128 v[72:75], v3 offset:23552
    v_smfmac_f32_16x16x64_bf16 v[40:43], v[52:55], a[216:223], v1
    ds_read_b64_tr_b16 v[52:53], v2 offset:6144
    ds_read_b64_tr_b16 v[54:55], v2 offset:6400
    s_waitcnt lgkmcnt(6)
    v_smfmac_f32_16x16x64_bf16 v[28:31], v[56:59], a[80:87], v1
    s_waitcnt lgkmcnt(4)
    v_smfmac_f32_16x16x64_bf16 v[44:47], v[56:59], v[60:67], v1
    ds_read_b128 v[60:63], v3 offset:24576
    ds_read_b128 v[64:67], v3 offset:25600
    v_smfmac_f32_16x16x64_bf16 v[32:35], v[56:59], a[88:95], v1
    v_smfmac_f32_16x16x64_bf16 v[36:39], v[56:59], a[224:231], v1
    s_waitcnt lgkmcnt(4)
    v_smfmac_f32_16x16x64_bf16 v[48:51], v[56:59], v[68:75], v1
    ds_read_b128 v[68:71], v3 offset:26624
    ds_read_b128 v[72:75], v3 offset:27648
    v_smfmac_f32_16x16x64_bf16 v[40:43], v[56:59], a[232:239], v1
    ds_read_b64_tr_b16 v[56:57], v2 offset:7168
    ds_read_b64_tr_b16 v[58:59], v2 offset:7424
    s_waitcnt lgkmcnt(6)
    v_smfmac_f32_16x16x64_bf16 v[28:31], v[52:55], a[96:103], v1
    s_waitcnt lgkmcnt(4)
    v_smfmac_f32_16x16x64_bf16 v[44:47], v[52:55], v[60:67], v1
    ds_read_b128 v[60:63], v3 offset:28672
    ds_read_b128 v[64:67], v3 offset:29696
    v_smfmac_f32_16x16x64_bf16 v[32:35], v[52:55], a[104:111], v1
    v_smfmac_f32_16x16x64_bf16 v[36:39], v[52:55], a[240:247], v1
    s_waitcnt lgkmcnt(4)
    v_smfmac_f32_16x16x64_bf16 v[48:51], v[52:55], v[68:75], v1
    ds_read_b128 v[68:71], v3 offset:30720
    ds_read_b128 v[72:75], v3 offset:31744
    v_smfmac_f32_16x16x64_bf16 v[40:43], v[52:55], a[248:255], v1
    ds_read_b64_tr_b16 v[52:53], v2 offset:8192
    ds_read_b64_tr_b16 v[54:55], v2 offset:8448
    s_waitcnt lgkmcnt(6)
    v_smfmac_f32_16x16x64_bf16 v[28:31], v[56:59], a[112:119], v1
    s_waitcnt lgkmcnt(4)
    v_smfmac_f32_16x16x64_bf16 v[44:47], v[56:59], v[60:67], v1
    ds_read_b128 v[60:63], v3 offset:32768
    ds_read_b128 v[64:67], v3 offset:33792
    v_smfmac_f32_16x16x64_bf16 v[32:35], v[56:59], a[120:127], v1
    v_smfmac_f32_16x16x64_bf16 v[36:39], v[56:59], v[80:87], v1
    s_waitcnt lgkmcnt(4)
    v_smfmac_f32_16x16x64_bf16 v[48:51], v[56:59], v[68:75], v1
    ds_read_b128 v[68:71], v3 offset:34816
    ds_read_b128 v[72:75], v3 offset:35840
    v_smfmac_f32_16x16x64_bf16 v[40:43], v[56:59], v[88:95], v1
    s_waitcnt lgkmcnt(4)
    v_smfmac_f32_16x16x64_bf16 v[28:31], v[52:55], a[128:135], v1
    v_smfmac_f32_16x16x64_bf16 v[32:35], v[52:55], a[136:143], v1
    v_smfmac_f32_16x16x64_bf16 v[36:39], v[52:55], v[96:103], v1
    v_smfmac_f32_16x16x64_bf16 v[40:43], v[52:55], v[104:111], v1
    s_waitcnt lgkmcnt(2)
    v_smfmac_f32_16x16x64_bf16 v[44:47], v[52:55], v[60:67], v1
    s_waitcnt lgkmcnt(0)
    v_smfmac_f32_16x16x64_bf16 v[48:51], v[52:55], v[68:75], v1
    s_nop 0
    v_pk_add_f32 v[28:29], v[28:29], v[30:31]
    v_cvt_pk_bf16_f32 v28, v28, v29
    v_pk_add_f32 v[32:33], v[32:33], v[34:35]
    v_cvt_pk_bf16_f32 v32, v32, v33
    ds_write2_b32 v4, v28, v32 offset0:0 offset1:64
    v_add_u32 v15, s36, v4
    v_add_u32 v60, s36, v5
    ds_read_b64_tr_b16 v[52:53], v5
    ds_read_b64_tr_b16 v[54:55], v5 offset:128
    v_pk_add_f32 v[36:37], v[36:37], v[38:39]
    v_cvt_pk_bf16_f32 v36, v36, v37
    v_pk_add_f32 v[40:41], v[40:41], v[42:43]
    v_cvt_pk_bf16_f32 v40, v40, v41
    ds_write2_b32 v15, v36, v40 offset0:0 offset1:64
    ds_read_b64_tr_b16 v[56:57], v60
    ds_read_b64_tr_b16 v[58:59], v60 offset:128
    v_add_u32 v72, s48, v6
    v_and_b32 v73, 0xff, v6
    v_add_u32 v73, s49, v73
    v_pk_add_f32 v[44:45], v[44:45], v[46:47]
    v_cvt_pk_bf16_f32 v44, v44, v45
    v_pk_add_f32 v[48:49], v[48:49], v[50:51]
    v_cvt_pk_bf16_f32 v48, v48, v49
    s_waitcnt lgkmcnt(3)
    v_mfma_f32_16x16x32_bf16 v[60:63], v[20:23], v[52:55], 0
    v_mfma_f32_16x16x32_bf16 v[64:67], v[24:27], v[52:55], 0
    v_lshrrev_b32 v29, 10, v13
    v_and_b32 v30, 0xf0, v13
    s_waitcnt lgkmcnt(0)
    v_mfma_f32_16x16x32_bf16 v[68:71], v[56:59], v[52:55], 0
    v_lshl_or_b32 v29, v29, 8, v30
    buffer_store_dword v44, v4, s[8:11], s43 offen sc1
    buffer_store_dword v48, v4, s[8:11], s43 offen offset:256 sc1
    buffer_store_dwordx4 v[56:59], v29, s[8:11], s42 offen sc1
    s_cmp_eq_u32 s45, 63
    s_cbranch_scc1 Lr_done
    v_cndmask_b32 v60, v60, v64, s[34:35]
    v_cndmask_b32 v61, v61, v65, s[34:35]
    v_cndmask_b32 v62, v62, v66, s[34:35]
    v_cndmask_b32 v63, v63, v67, s[34:35]
    ds_write_b128 v72, v[60:63]
    ds_write_b128 v73, v[68:71]
    v_mov_b32 v64, 0x3f803f80
    v_mov_b32 v65, 0x3f803f80
    v_mov_b32 v66, 0x3f803f80
    v_mov_b32 v67, 0x3f803f80
    v_mov_b32 v45, 0
    v_mov_b32 v49, 0
    v_mov_b64 v[46:47], 0
    v_mov_b64 v[50:51], 0
    s_waitcnt lgkmcnt(0)
    s_barrier
    ds_read_b128 v[28:31], v6 offset:0
    ds_read_b128 v[32:35], v6 offset:1280
    ds_read_b128 v[36:39], v6 offset:2560
    ds_read_b128 v[40:43], v6 offset:3840
    ds_read_b32 v52, v7 offset:0
    ds_read_b32 v53, v7 offset:1280
    ds_read_b32 v54, v7 offset:2560
    ds_read_b32 v55, v7 offset:3840
    s_add_u32 s40, s40, 8192
    s_add_u32 s41, s41, 8192
    s_add_u32 s42, s42, 65536
    s_add_u32 s43, s43, 65536
    v_bfe_u32 v15, v0, 3, 1
    v_lshl_add_u32 v15, v15, 8, v13
    buffer_load_dwordx4 v[20:23], v15, s[8:11], s40 offen sc1
    buffer_load_dwordx4 v[24:27], v15, s[8:11], s40 offen offset:256 sc1
    s_waitcnt lgkmcnt(6)
    v_pk_add_f32 v[28:29], v[28:29], v[32:33]
    v_pk_add_f32 v[30:31], v[30:31], v[34:35]
    s_waitcnt lgkmcnt(4)
    v_pk_add_f32 v[36:37], v[36:37], v[40:41]
    v_pk_add_f32 v[38:39], v[38:39], v[42:43]
    s_waitcnt lgkmcnt(0)
    v_pk_add_f32 v[52:53], v[52:53], v[54:55]
    v_pk_add_f32 v[28:29], v[28:29], v[36:37]
    v_pk_add_f32 v[30:31], v[30:31], v[38:39]
    v_add_f32 v52, v52, v53
    v_max3_f32 v60, v28, v29, v30
    v_max3_f32 v60, v60, v31, v52
    v_mov_b64 v[32:33], 0
    v_mov_b64 v[34:35], 0
    v_max_f32_dpp v60, v60, v60 row_ror:8 row_mask:0xf bank_mask:0xf
    v_mov_b32 v61, v60
    v_mov_b64 v[36:37], 0
    v_mov_b64 v[38:39], 0
    v_permlane16_swap_b32 v60, v61
    v_max_f32 v60, v60, v61
    v_mov_b32 v61, v60
    s_nop 1
    v_permlane32_swap_b32 v60, v61
    v_max_f32 v60, v60, v61
    v_mul_f32 v60, s56, v60
    v_fma_f32 v52, v52, s56, -v60
    v_fma_f32 v28, v28, s56, -v60
    v_fma_f32 v29, v29, s56, -v60
    v_fma_f32 v30, v30, s56, -v60
    v_fma_f32 v31, v31, s56, -v60
    v_exp_f32 v52, v52
    v_exp_f32 v28, v28
    v_exp_f32 v29, v29
    v_exp_f32 v30, v30
    v_exp_f32 v31, v31
    v_mov_b32_dpp v53, v52 row_ror:8 row_mask:0xf bank_mask:0xf
    v_cvt_pk_bf16_f32 v60, v28, v29
    v_cvt_pk_bf16_f32 v61, v30, v31
    v_cvt_pk_bf16_f32 v52, v52, v53
    v_mov_b32 v53, 0
    v_mov_b64 v[54:55], 0
    v_mov_b32_dpp v62, v60 row_ror:8 row_mask:0xf bank_mask:0xf
    v_mov_b32_dpp v63, v61 row_ror:8 row_mask:0xf bank_mask:0xf
    v_mfma_f32_16x16x32_bf16 v[40:43], v[64:67], v[52:55], 0
    s_nop 0
    v_mfma_f32_16x16x32_bf16 v[40:43], v[64:67], v[60:63], v[40:43]
    v_mfma_f32_16x16x32_bf16 v[68:71], v[44:47], v[52:55], 0
    v_mfma_f32_16x16x32_bf16 v[68:71], v[76:79], v[60:63], v[68:71]
    v_mfma_f32_16x16x32_bf16 v[56:59], v[48:51], v[52:55], 0
    v_mfma_f32_16x16x32_bf16 v[56:59], v[16:19], v[60:63], v[56:59]
    v_mov_b64 v[28:29], 0
    v_mov_b64 v[30:31], 0
    s_nop 1
    v_rcp_f32 v40, v40
    v_xor_b32 v15, 32, v8
    v_pk_mul_f32 v[68:69], v[68:69], v[40:41] op_sel_hi:[1,0]
    v_pk_mul_f32 v[70:71], v[70:71], v[40:41] op_sel_hi:[1,0]
    v_cvt_pk_bf16_f32 v68, v68, v69
    v_cvt_pk_bf16_f32 v69, v70, v71
    v_pk_mul_f32 v[56:57], v[56:57], v[40:41] op_sel_hi:[1,0]
    v_pk_mul_f32 v[58:59], v[58:59], v[40:41] op_sel_hi:[1,0]
    v_cvt_pk_bf16_f32 v56, v56, v57
    v_cvt_pk_bf16_f32 v57, v58, v59
    s_mov_b64 exec, s[32:33]
    ds_write_b64 v8, v[68:69]
    ds_write_b64 v15, v[56:57]
    s_mov_b64 exec, -1
    v_xor_b32 v15, 128, v9
    buffer_load_dwordx4 v[76:79], v13, s[8:11], s41 offen sc1
    buffer_load_dwordx4 v[16:19], v13, s[8:11], s41 offen offset:512 sc1
    v_mov_b64 v[40:41], 0
    v_mov_b64 v[42:43], 0
    v_mov_b64 v[44:45], 0
    v_mov_b64 v[48:49], 0
    v_mov_b64 v[52:53], 0
    v_mov_b64 v[54:55], 0
    s_lshl_b32 s46, s4, 3
    v_lshrrev_b32 v72, 4, v0
    v_bfe_u32 v73, v0, 2, 1
    v_lshl_add_u32 v72, v72, 1, v73
    v_add_u32 v72, s46, v72
    v_mul_u32_u24 v72, 9216, v72
    v_and_b32 v73, 3, v0
    v_lshl_add_u32 v72, v73, 3, v72
    s_waitcnt lgkmcnt(0)
    s_barrier
    ds_read_b128 v[64:67], v9
    ds_read_b128 v[68:71], v15
    v_mov_b64 v[56:57], 0
    v_mov_b64 v[58:59], 0
    v_mov_b64 v[60:61], 0
    v_mov_b64 v[62:63], 0
    s_waitcnt lgkmcnt(1)
    s_nop 0
    v_smfmac_f32_16x16x64_bf16 v[60:63], v[64:67], v[240:247], v1
    v_smfmac_f32_16x16x64_bf16 v[28:31], v[64:67], v[112:119], v1
    v_smfmac_f32_16x16x64_bf16 v[32:35], v[64:67], v[128:135], v1
    s_waitcnt lgkmcnt(0)
    v_smfmac_f32_16x16x64_bf16 v[60:63], v[68:71], v[248:255], v1
    v_smfmac_f32_16x16x64_bf16 v[28:31], v[68:71], v[120:127], v1
    v_smfmac_f32_16x16x64_bf16 v[32:35], v[68:71], v[136:143], v1
    s_nop 5
    v_add_f32 v60, v60, v62
    v_add_f32 v61, v61, v63
    v_smfmac_f32_16x16x64_bf16 v[36:39], v[64:67], v[144:151], v1
    v_cvt_pk_bf16_f32 v60, v60, v61
    s_nop 1
    v_mov_b32_dpp v61, v60 row_ror:8 row_mask:0xf bank_mask:0xf
    v_smfmac_f32_16x16x64_bf16 v[36:39], v[68:71], v[152:159], v1
    v_bfi_b32 v60, 1, s44, v60
    s_mov_b64 exec, s[32:33]
    buffer_store_dwordx2 v[60:61], v72, s[8:11], s31 offen sc1
    s_mov_b64 exec, -1
    v_smfmac_f32_16x16x64_bf16 v[40:43], v[64:67], v[160:167], v1
    v_smfmac_f32_16x16x64_bf16 v[40:43], v[68:71], v[168:175], v1
    v_smfmac_f32_16x16x64_bf16 v[44:47], v[64:67], v[176:183], v1
    v_smfmac_f32_16x16x64_bf16 v[44:47], v[68:71], v[184:191], v1
    v_add_f32 v28, v28, v30
    v_add_f32 v29, v29, v31
    v_smfmac_f32_16x16x64_bf16 v[48:51], v[64:67], v[192:199], v1
    v_cvt_pk_bf16_f32 v72, v28, v29
    v_add_f32 v32, v32, v34
    v_smfmac_f32_16x16x64_bf16 v[48:51], v[68:71], v[200:207], v1
    v_add_f32 v33, v33, v35
    v_cvt_pk_bf16_f32 v73, v32, v33
    v_smfmac_f32_16x16x64_bf16 v[52:55], v[64:67], v[208:215], v1
    v_add_f32 v36, v36, v38
    v_add_f32 v37, v37, v39
    v_smfmac_f32_16x16x64_bf16 v[52:55], v[68:71], v[216:223], v1
    v_cvt_pk_bf16_f32 v74, v36, v37
    v_add_f32 v40, v40, v42
    v_smfmac_f32_16x16x64_bf16 v[56:59], v[64:67], v[224:231], v1
    v_add_f32 v41, v41, v43
    v_cvt_pk_bf16_f32 v75, v40, v41
    v_smfmac_f32_16x16x64_bf16 v[56:59], v[68:71], v[232:239], v1
    v_bfi_b32 v72, 1, s44, v72
    buffer_store_dwordx4 v[72:75], v10, s[8:11], s28 offen sc1
    v_add_f32 v44, v44, v46
    v_add_f32 v45, v45, v47
    v_cvt_pk_bf16_f32 v28, v44, v45
    v_add_f32 v48, v48, v50
    v_add_f32 v49, v49, v51
    v_cvt_pk_bf16_f32 v29, v48, v49
    v_pk_add_f32 v[52:53], v[52:53], v[54:55]
    v_cvt_pk_bf16_f32 v30, v52, v53
    v_pk_add_f32 v[56:57], v[56:57], v[58:59]
    v_cvt_pk_bf16_f32 v31, v56, v57
    v_bfi_b32 v28, 1, s44, v28
    buffer_store_dwordx4 v[28:31], v10, s[8:11], s30 offen sc1
    s_cmp_eq_u32 s4, 3
    s_cbranch_scc1 Lnored_1095
    v_and_b32 v15, 1, v0
    v_lshlrev_b32 v15, 4, v15
    v_mov_b32 v70, 0x3f80
    v_lshlrev_b32 v70, v15, v70
    v_bfe_u32 v15, v0, 1, 3
    v_cmp_eq_u32 vcc, 0, v15
    s_nop 1
    v_cndmask_b32 v64, 0, v70, vcc
    v_cmp_eq_u32 vcc, 1, v15
    s_nop 1
    v_cndmask_b32 v65, 0, v70, vcc
    v_cmp_eq_u32 vcc, 2, v15
    s_nop 1
    v_cndmask_b32 v66, 0, v70, vcc
    v_cmp_eq_u32 vcc, 3, v15
    s_nop 1
    v_cndmask_b32 v67, 0, v70, vcc
    s_mov_b32 s66, 0
    s_sub_u32 s46, s44, 1
    s_cmp_eq_u32 s4, 2
    s_cbranch_scc1 Lw2_1099
    v_mov_b32 v68, -1
    v_mov_b32 v69, -1
    s_nop 15
    s_nop 15
    s_nop 15
    s_nop 15
Lred_1096:
    buffer_load_dwordx4 v[28:31], v11, s[8:11], s29 offen offset:0 sc1
    buffer_load_dwordx4 v[32:35], v11, s[8:11], s29 offen offset:1024 sc1
    buffer_load_dwordx4 v[36:39], v11, s[8:11], s29 offen offset:2048 sc1
    buffer_load_dwordx4 v[40:43], v11, s[8:11], s29 offen offset:3072 sc1
    s_add_u32 s66, s66, 1
    s_cmp_gt_u32 s66, 0x100000
    s_cbranch_scc1 Lexit
    s_waitcnt vmcnt(0)
    v_bitop3_b32 v60, v28, v32, s46 bitop3:0x42
    v_bitop3_b32 v61, v36, v40, s46 bitop3:0x42
    v_bitop3_b32 v60, v60, v61, 1 bitop3:0x80
    v_cmp_eq_u32 vcc, 0, v60
    s_nop 0
    s_and_b64 exec, exec, vcc
    s_cbranch_scc1 Lred_1096
    s_mov_b64 exec, -1
    v_mfma_f32_16x16x32_bf16 v[60:63], v[64:67], v[28:31], 0
    v_mfma_f32_16x16x32_bf16 v[44:47], v[64:67], v[32:35], 0
    v_mfma_f32_16x16x32_bf16 v[60:63], v[64:67], v[36:39], v[60:63]
    v_mfma_f32_16x16x32_bf16 v[60:63], v[64:67], v[40:43], v[60:63]
    s_nop 7
    v_pk_add_f32 v[60:61], v[60:61], v[44:45]
    v_pk_add_f32 v[62:63], v[62:63], v[46:47]
    s_nop 0
    v_add_f32_dpp v60, v60, v60 row_ror:8 row_mask:0xf bank_mask:0xf
    v_add_f32_dpp v61, v61, v61 row_ror:8 row_mask:0xf bank_mask:0xf
    v_add_f32_dpp v62, v62, v62 row_ror:8 row_mask:0xf bank_mask:0xf
    v_add_f32_dpp v63, v63, v63 row_ror:8 row_mask:0xf bank_mask:0xf
    s_branch Lpub_1098
Lw2_1099:
    v_mov_b32 v68, -1
    v_mov_b32 v69, -1
Lred2_1097:
    buffer_load_dwordx4 v[28:31], v11, s[8:11], s29 offen offset:0 sc1
    s_add_u32 s66, s66, 1
    s_cmp_gt_u32 s66, 0x100000
    s_cbranch_scc1 Lexit
    s_waitcnt vmcnt(0)
    v_bitop3_b32 v60, v28, v30, s46 bitop3:0x42
    v_and_b32 v60, 1, v60
    v_cmp_eq_u32 vcc, 0, v60
    s_nop 0
    s_and_b64 exec, exec, vcc
    s_cbranch_scc1 Lred2_1097
    s_mov_b64 exec, -1
    v_mfma_f32_16x16x32_bf16 v[60:63], v[64:67], v[28:31], 0
    s_nop 7
    v_add_f32_dpp v60, v60, v60 row_ror:2 row_mask:0xf bank_mask:0xf
    v_add_f32_dpp v61, v61, v61 row_ror:2 row_mask:0xf bank_mask:0xf
    v_add_f32_dpp v62, v62, v62 row_ror:2 row_mask:0xf bank_mask:0xf
    v_add_f32_dpp v63, v63, v63 row_ror:2 row_mask:0xf bank_mask:0xf
    v_add_f32_dpp v60, v60, v60 row_ror:4 row_mask:0xf bank_mask:0xf
    v_add_f32_dpp v61, v61, v61 row_ror:4 row_mask:0xf bank_mask:0xf
    v_add_f32_dpp v62, v62, v62 row_ror:4 row_mask:0xf bank_mask:0xf
    v_add_f32_dpp v63, v63, v63 row_ror:4 row_mask:0xf bank_mask:0xf
    v_add_f32_dpp v60, v60, v60 row_ror:8 row_mask:0xf bank_mask:0xf
    v_add_f32_dpp v61, v61, v61 row_ror:8 row_mask:0xf bank_mask:0xf
    v_add_f32_dpp v62, v62, v62 row_ror:8 row_mask:0xf bank_mask:0xf
    v_add_f32_dpp v63, v63, v63 row_ror:8 row_mask:0xf bank_mask:0xf
Lpub_1098:
    v_cvt_pk_bf16_f32 v60, v60, v61
    v_cvt_pk_bf16_f32 v61, v62, v63
    v_min_u32 v60, s67, v60
    s_mov_b64 exec, s[54:55]
    buffer_store_dwordx2 v[60:61], v12, s[8:11], s38 offen sc1
    buffer_store_dwordx2 v[68:69], v12, s[8:11], s37 offen sc1
    s_mov_b64 exec, -1
Lnored_1095:
    s_mov_b32 s46, s37
    s_mov_b32 s37, s38
    s_mov_b32 s38, s39
    s_mov_b32 s39, s46
    s_xor_b32 s44, s44, 1
    s_add_u32 s45, s45, 1
    s_branch Lstep_1085
Lr_done:
    s_waitcnt vmcnt(0)
    s_barrier
    s_cmp_lg_u32 s4, 3
    s_cbranch_scc1 Lfin_1100
    v_mov_b32 v52, 0
    v_mov_b32 v53, 1
    s_mov_b32 s46, 60887552
    v_mov_b32 v54, 64
    s_mov_b64 exec, 1
    buffer_store_dword v54, v52, s[8:11], s52 offen sc1
    buffer_atomic_add v53, v52, s[8:11], s46 offen sc0 sc1
    v_lshlrev_b32 v52, 7, v0
    s_waitcnt vmcnt(0)
    v_readfirstlane_b32 s46, v53
    s_mov_b64 exec, -1
    v_lshlrev_b32 v52, 7, v0
    v_mov_b32 v15, 64
    s_cmp_lg_u32 s46, 31
    s_cbranch_scc1 Lfin_1100
    s_mov_b32 exec_hi, 0
    buffer_store_byte v15, v52, s[8:11], s51 offen sc1
    s_mov_b64 exec, -1
    s_waitcnt vmcnt(0)
Lfin_1100:
    s_waitcnt vmcnt(0)
Lexit:
    s_endpgm
.section .rodata,"a"
.p2align 6
.amdhsa_kernel parallel_sum__memory_aug_recurrent_mem_tr__geglu_ffn__prompt_kernel
  .amdhsa_next_free_vgpr 512
  .amdhsa_next_free_sgpr 102
  .amdhsa_accum_offset 256
  .amdhsa_group_segment_fixed_size 0
  .amdhsa_kernarg_size 112
  .amdhsa_user_sgpr_count 2
  .amdhsa_user_sgpr_kernarg_segment_ptr 1
  .amdhsa_system_sgpr_workgroup_id_x 1
.end_amdhsa_kernel
.p2align 4
.type queue_table,@object
queue_table:
.long 9, 60884992, 0, 36
.long 13, 60885120, 36, 36
.long 17, 60885248, 72, 36
.long 21, 60885376, 108, 36
.long 25, 60885504, 144, 36
.long 29, 60885632, 180, 36
.long 33, 60885760, 216, 36
.long 37, 60885888, 252, 36
.long 41, 60886016, 288, 36
.long 45, 60886144, 324, 36
.long 47, 60887040, 360, 48
.long 49, 60886272, 408, 36
.long 51, 60887168, 444, 48
.long 53, 60886400, 492, 18
.long 54, 60886528, 510, 18
.long 55, 60887296, 528, 96
.long 58, 60886656, 624, 18
.long 59, 60887424, 642, 96
.long 60, 60886784, 738, 36
.long 64, 60886912, 774, 36
.long 0x80000001
.long 0x80000101
.long 0x80010001
.long 0x80010101
.long 0x80020001
.long 0x80020101
.long 0x80030001
.long 0x80030101
.long 0x80040001
.long 0x80040101
.long 0x80050001
.long 0x80050101
.long 0x80060001
.long 0x80060101
.long 0x80070001
.long 0x80070101
.long 0x80080001
.long 0x80080101
.long 0x80090001
.long 0x80090101
.long 0x800a0001
.long 0x800a0101
.long 0x800b0001
.long 0x800b0101
.long 0x800c0001
.long 0x800c0101
.long 0x800d0001
.long 0x800d0101
.long 0x800e0001
.long 0x800e0101
.long 0x800f0001
.long 0x800f0101
.long 0x80100001
.long 0x80100101
.long 0x80110001
.long 0x80110101
.long 0x81000001
.long 0x81000101
.long 0x81010001
.long 0x81010101
.long 0x81020001
.long 0x81020101
.long 0x81030001
.long 0x81030101
.long 0x81040001
.long 0x81040101
.long 0x81050001
.long 0x81050101
.long 0x81060001
.long 0x81060101
.long 0x81070001
.long 0x81070101
.long 0x81080001
.long 0x81080101
.long 0x81090001
.long 0x81090101
.long 0x810a0001
.long 0x810a0101
.long 0x810b0001
.long 0x810b0101
.long 0x810c0001
.long 0x810c0101
.long 0x810d0001
.long 0x810d0101
.long 0x810e0001
.long 0x810e0101
.long 0x810f0001
.long 0x810f0101
.long 0x81100001
.long 0x81100101
.long 0x81110001
.long 0x81110101
.long 0x82000001
.long 0x82000101
.long 0x82010001
.long 0x82010101
.long 0x82020001
.long 0x82020101
.long 0x82030001
.long 0x82030101
.long 0x82040001
.long 0x82040101
.long 0x82050001
.long 0x82050101
.long 0x82060001
.long 0x82060101
.long 0x82070001
.long 0x82070101
.long 0x82080001
.long 0x82080101
.long 0x82090001
.long 0x82090101
.long 0x820a0001
.long 0x820a0101
.long 0x820b0001
.long 0x820b0101
.long 0x820c0001
.long 0x820c0101
.long 0x820d0001
.long 0x820d0101
.long 0x820e0001
.long 0x820e0101
.long 0x820f0001
.long 0x820f0101
.long 0x82100001
.long 0x82100101
.long 0x82110001
.long 0x82110101
.long 0x83000001
.long 0x83000101
.long 0x83010001
.long 0x83010101
.long 0x83020001
.long 0x83020101
.long 0x83030001
.long 0x83030101
.long 0x83040001
.long 0x83040101
.long 0x83050001
.long 0x83050101
.long 0x83060001
.long 0x83060101
.long 0x83070001
.long 0x83070101
.long 0x83080001
.long 0x83080101
.long 0x83090001
.long 0x83090101
.long 0x830a0001
.long 0x830a0101
.long 0x830b0001
.long 0x830b0101
.long 0x830c0001
.long 0x830c0101
.long 0x830d0001
.long 0x830d0101
.long 0x830e0001
.long 0x830e0101
.long 0x830f0001
.long 0x830f0101
.long 0x83100001
.long 0x83100101
.long 0x83110001
.long 0x83110101
.long 0x84000001
.long 0x84000101
.long 0x84010001
.long 0x84010101
.long 0x84020001
.long 0x84020101
.long 0x84030001
.long 0x84030101
.long 0x84040001
.long 0x84040101
.long 0x84050001
.long 0x84050101
.long 0x84060001
.long 0x84060101
.long 0x84070001
.long 0x84070101
.long 0x84080001
.long 0x84080101
.long 0x84090001
.long 0x84090101
.long 0x840a0001
.long 0x840a0101
.long 0x840b0001
.long 0x840b0101
.long 0x840c0001
.long 0x840c0101
.long 0x840d0001
.long 0x840d0101
.long 0x840e0001
.long 0x840e0101
.long 0x840f0001
.long 0x840f0101
.long 0x84100001
.long 0x84100101
.long 0x84110001
.long 0x84110101
.long 0x85000001
.long 0x85000101
.long 0x85010001
.long 0x85010101
.long 0x85020001
.long 0x85020101
.long 0x85030001
.long 0x85030101
.long 0x85040001
.long 0x85040101
.long 0x85050001
.long 0x85050101
.long 0x85060001
.long 0x85060101
.long 0x85070001
.long 0x85070101
.long 0x85080001
.long 0x85080101
.long 0x85090001
.long 0x85090101
.long 0x850a0001
.long 0x850a0101
.long 0x850b0001
.long 0x850b0101
.long 0x850c0001
.long 0x850c0101
.long 0x850d0001
.long 0x850d0101
.long 0x850e0001
.long 0x850e0101
.long 0x850f0001
.long 0x850f0101
.long 0x85100001
.long 0x85100101
.long 0x85110001
.long 0x85110101
.long 0x86000001
.long 0x86000101
.long 0x86010001
.long 0x86010101
.long 0x86020001
.long 0x86020101
.long 0x86030001
.long 0x86030101
.long 0x86040001
.long 0x86040101
.long 0x86050001
.long 0x86050101
.long 0x86060001
.long 0x86060101
.long 0x86070001
.long 0x86070101
.long 0x86080001
.long 0x86080101
.long 0x86090001
.long 0x86090101
.long 0x860a0001
.long 0x860a0101
.long 0x860b0001
.long 0x860b0101
.long 0x860c0001
.long 0x860c0101
.long 0x860d0001
.long 0x860d0101
.long 0x860e0001
.long 0x860e0101
.long 0x860f0001
.long 0x860f0101
.long 0x86100001
.long 0x86100101
.long 0x86110001
.long 0x86110101
.long 0x87000001
.long 0x87000101
.long 0x87010001
.long 0x87010101
.long 0x87020001
.long 0x87020101
.long 0x87030001
.long 0x87030101
.long 0x87040001
.long 0x87040101
.long 0x87050001
.long 0x87050101
.long 0x87060001
.long 0x87060101
.long 0x87070001
.long 0x87070101
.long 0x87080001
.long 0x87080101
.long 0x87090001
.long 0x87090101
.long 0x870a0001
.long 0x870a0101
.long 0x870b0001
.long 0x870b0101
.long 0x870c0001
.long 0x870c0101
.long 0x870d0001
.long 0x870d0101
.long 0x870e0001
.long 0x870e0101
.long 0x870f0001
.long 0x870f0101
.long 0x87100001
.long 0x87100101
.long 0x87110001
.long 0x87110101
.long 0x88000001
.long 0x88000101
.long 0x88010001
.long 0x88010101
.long 0x88020001
.long 0x88020101
.long 0x88030001
.long 0x88030101
.long 0x88040001
.long 0x88040101
.long 0x88050001
.long 0x88050101
.long 0x88060001
.long 0x88060101
.long 0x88070001
.long 0x88070101
.long 0x88080001
.long 0x88080101
.long 0x88090001
.long 0x88090101
.long 0x880a0001
.long 0x880a0101
.long 0x880b0001
.long 0x880b0101
.long 0x880c0001
.long 0x880c0101
.long 0x880d0001
.long 0x880d0101
.long 0x880e0001
.long 0x880e0101
.long 0x880f0001
.long 0x880f0101
.long 0x88100001
.long 0x88100101
.long 0x88110001
.long 0x88110101
.long 0x89000001
.long 0x89000101
.long 0x89010001
.long 0x89010101
.long 0x89020001
.long 0x89020101
.long 0x89030001
.long 0x89030101
.long 0x89040001
.long 0x89040101
.long 0x89050001
.long 0x89050101
.long 0x89060001
.long 0x89060101
.long 0x89070001
.long 0x89070101
.long 0x89080001
.long 0x89080101
.long 0x89090001
.long 0x89090101
.long 0x890a0001
.long 0x890a0101
.long 0x890b0001
.long 0x890b0101
.long 0x890c0001
.long 0x890c0101
.long 0x890d0001
.long 0x890d0101
.long 0x890e0001
.long 0x890e0101
.long 0x890f0001
.long 0x890f0101
.long 0x89100001
.long 0x89100101
.long 0x89110001
.long 0x89110101
.long 0xc000238
.long 0xc000239
.long 0xc00023a
.long 0xc02023c
.long 0xc02023d
.long 0xc02023e
.long 0xc040240
.long 0xc040241
.long 0xc040242
.long 0xc060244
.long 0xc060245
.long 0xc060246
.long 0xc080248
.long 0xc080249
.long 0xc08024a
.long 0xc0a024c
.long 0xc0a024d
.long 0xc0a024e
.long 0xc0c0250
.long 0xc0c0251
.long 0xc0c0252
.long 0xc0e0254
.long 0xc0e0255
.long 0xc0e0256
.long 0xc100258
.long 0xc100259
.long 0xc10025a
.long 0xc12025c
.long 0xc12025d
.long 0xc12025e
.long 0xc140260
.long 0xc140261
.long 0xc140262
.long 0xc160264
.long 0xc160265
.long 0xc160266
.long 0xc180268
.long 0xc180269
.long 0xc18026a
.long 0xc1a026c
.long 0xc1a026d
.long 0xc1a026e
.long 0xc1c0270
.long 0xc1c0271
.long 0xc1c0272
.long 0xc1e0274
.long 0xc1e0275
.long 0xc1e0276
.long 0x8a000001
.long 0x8a000101
.long 0x8a010001
.long 0x8a010101
.long 0x8a020001
.long 0x8a020101
.long 0x8a030001
.long 0x8a030101
.long 0x8a040001
.long 0x8a040101
.long 0x8a050001
.long 0x8a050101
.long 0x8a060001
.long 0x8a060101
.long 0x8a070001
.long 0x8a070101
.long 0x8a080001
.long 0x8a080101
.long 0x8a090001
.long 0x8a090101
.long 0x8a0a0001
.long 0x8a0a0101
.long 0x8a0b0001
.long 0x8a0b0101
.long 0x8a0c0001
.long 0x8a0c0101
.long 0x8a0d0001
.long 0x8a0d0101
.long 0x8a0e0001
.long 0x8a0e0101
.long 0x8a0f0001
.long 0x8a0f0101
.long 0x8a100001
.long 0x8a100101
.long 0x8a110001
.long 0x8a110101
.long 0xd000238
.long 0xd000239
.long 0xd00023a
.long 0xd02023c
.long 0xd02023d
.long 0xd02023e
.long 0xd040240
.long 0xd040241
.long 0xd040242
.long 0xd060244
.long 0xd060245
.long 0xd060246
.long 0xd080248
.long 0xd080249
.long 0xd08024a
.long 0xd0a024c
.long 0xd0a024d
.long 0xd0a024e
.long 0xd0c0250
.long 0xd0c0251
.long 0xd0c0252
.long 0xd0e0254
.long 0xd0e0255
.long 0xd0e0256
.long 0xd100258
.long 0xd100259
.long 0xd10025a
.long 0xd12025c
.long 0xd12025d
.long 0xd12025e
.long 0xd140260
.long 0xd140261
.long 0xd140262
.long 0xd160264
.long 0xd160265
.long 0xd160266
.long 0xd180268
.long 0xd180269
.long 0xd18026a
.long 0xd1a026c
.long 0xd1a026d
.long 0xd1a026e
.long 0xd1c0270
.long 0xd1c0271
.long 0xd1c0272
.long 0xd1e0274
.long 0xd1e0275
.long 0xd1e0276
.long 0x8b000002
.long 0x8b010002
.long 0x8b020002
.long 0x8b030002
.long 0x8b040002
.long 0x8b050002
.long 0x8b060002
.long 0x8b070002
.long 0x8b080002
.long 0x8b090002
.long 0x8b0a0002
.long 0x8b0b0002
.long 0x8b0c0002
.long 0x8b0d0002
.long 0x8b0e0002
.long 0x8b0f0002
.long 0x8b100002
.long 0x8b110002
.long 0x8c000002
.long 0x8c010002
.long 0x8c020002
.long 0x8c030002
.long 0x8c040002
.long 0x8c050002
.long 0x8c060002
.long 0x8c070002
.long 0x8c080002
.long 0x8c090002
.long 0x8c0a0002
.long 0x8c0b0002
.long 0x8c0c0002
.long 0x8c0d0002
.long 0x8c0e0002
.long 0x8c0f0002
.long 0x8c100002
.long 0x8c110002
.long 0xe000138
.long 0xe000139
.long 0xe00013a
.long 0xe01013c
.long 0xe01013d
.long 0xe01013e
.long 0xe020140
.long 0xe020141
.long 0xe020142
.long 0xe030144
.long 0xe030145
.long 0xe030146
.long 0xe040148
.long 0xe040149
.long 0xe04014a
.long 0xe05014c
.long 0xe05014d
.long 0xe05014e
.long 0xe060150
.long 0xe060151
.long 0xe060152
.long 0xe070154
.long 0xe070155
.long 0xe070156
.long 0xe080158
.long 0xe080159
.long 0xe08015a
.long 0xe09015c
.long 0xe09015d
.long 0xe09015e
.long 0xe0a0160
.long 0xe0a0161
.long 0xe0a0162
.long 0xe0b0164
.long 0xe0b0165
.long 0xe0b0166
.long 0xe0c0168
.long 0xe0c0169
.long 0xe0c016a
.long 0xe0d016c
.long 0xe0d016d
.long 0xe0d016e
.long 0xe0e0170
.long 0xe0e0171
.long 0xe0e0172
.long 0xe0f0174
.long 0xe0f0175
.long 0xe0f0176
.long 0xe100178
.long 0xe100179
.long 0xe10017a
.long 0xe11017c
.long 0xe11017d
.long 0xe11017e
.long 0xe120180
.long 0xe120181
.long 0xe120182
.long 0xe130184
.long 0xe130185
.long 0xe130186
.long 0xe140188
.long 0xe140189
.long 0xe14018a
.long 0xe15018c
.long 0xe15018d
.long 0xe15018e
.long 0xe160190
.long 0xe160191
.long 0xe160192
.long 0xe170194
.long 0xe170195
.long 0xe170196
.long 0xe180198
.long 0xe180199
.long 0xe18019a
.long 0xe19019c
.long 0xe19019d
.long 0xe19019e
.long 0xe1a01a0
.long 0xe1a01a1
.long 0xe1a01a2
.long 0xe1b01a4
.long 0xe1b01a5
.long 0xe1b01a6
.long 0xe1c01a8
.long 0xe1c01a9
.long 0xe1c01aa
.long 0xe1d01ac
.long 0xe1d01ad
.long 0xe1d01ae
.long 0xe1e01b0
.long 0xe1e01b1
.long 0xe1e01b2
.long 0xe1f01b4
.long 0xe1f01b5
.long 0xe1f01b6
.long 0x8d000002
.long 0x8d010002
.long 0x8d020002
.long 0x8d030002
.long 0x8d040002
.long 0x8d050002
.long 0x8d060002
.long 0x8d070002
.long 0x8d080002
.long 0x8d090002
.long 0x8d0a0002
.long 0x8d0b0002
.long 0x8d0c0002
.long 0x8d0d0002
.long 0x8d0e0002
.long 0x8d0f0002
.long 0x8d100002
.long 0x8d110002
.long 0xf000138
.long 0xf000139
.long 0xf00013a
.long 0xf01013c
.long 0xf01013d
.long 0xf01013e
.long 0xf020140
.long 0xf020141
.long 0xf020142
.long 0xf030144
.long 0xf030145
.long 0xf030146
.long 0xf040148
.long 0xf040149
.long 0xf04014a
.long 0xf05014c
.long 0xf05014d
.long 0xf05014e
.long 0xf060150
.long 0xf060151
.long 0xf060152
.long 0xf070154
.long 0xf070155
.long 0xf070156
.long 0xf080158
.long 0xf080159
.long 0xf08015a
.long 0xf09015c
.long 0xf09015d
.long 0xf09015e
.long 0xf0a0160
.long 0xf0a0161
.long 0xf0a0162
.long 0xf0b0164
.long 0xf0b0165
.long 0xf0b0166
.long 0xf0c0168
.long 0xf0c0169
.long 0xf0c016a
.long 0xf0d016c
.long 0xf0d016d
.long 0xf0d016e
.long 0xf0e0170
.long 0xf0e0171
.long 0xf0e0172
.long 0xf0f0174
.long 0xf0f0175
.long 0xf0f0176
.long 0xf100178
.long 0xf100179
.long 0xf10017a
.long 0xf11017c
.long 0xf11017d
.long 0xf11017e
.long 0xf120180
.long 0xf120181
.long 0xf120182
.long 0xf130184
.long 0xf130185
.long 0xf130186
.long 0xf140188
.long 0xf140189
.long 0xf14018a
.long 0xf15018c
.long 0xf15018d
.long 0xf15018e
.long 0xf160190
.long 0xf160191
.long 0xf160192
.long 0xf170194
.long 0xf170195
.long 0xf170196
.long 0xf180198
.long 0xf180199
.long 0xf18019a
.long 0xf19019c
.long 0xf19019d
.long 0xf19019e
.long 0xf1a01a0
.long 0xf1a01a1
.long 0xf1a01a2
.long 0xf1b01a4
.long 0xf1b01a5
.long 0xf1b01a6
.long 0xf1c01a8
.long 0xf1c01a9
.long 0xf1c01aa
.long 0xf1d01ac
.long 0xf1d01ad
.long 0xf1d01ae
.long 0xf1e01b0
.long 0xf1e01b1
.long 0xf1e01b2
.long 0xf1f01b4
.long 0xf1f01b5
.long 0xf1f01b6
.long 0x8e000001
.long 0x8e000101
.long 0x8e010001
.long 0x8e010101
.long 0x8e020001
.long 0x8e020101
.long 0x8e030001
.long 0x8e030101
.long 0x8e040001
.long 0x8e040101
.long 0x8e050001
.long 0x8e050101
.long 0x8e060001
.long 0x8e060101
.long 0x8e070001
.long 0x8e070101
.long 0x8e080001
.long 0x8e080101
.long 0x8e090001
.long 0x8e090101
.long 0x8e0a0001
.long 0x8e0a0101
.long 0x8e0b0001
.long 0x8e0b0101
.long 0x8e0c0001
.long 0x8e0c0101
.long 0x8e0d0001
.long 0x8e0d0101
.long 0x8e0e0001
.long 0x8e0e0101
.long 0x8e0f0001
.long 0x8e0f0101
.long 0x8e100001
.long 0x8e100101
.long 0x8e110001
.long 0x8e110101
.long 0x8f000001
.long 0x8f000101
.long 0x8f010001
.long 0x8f010101
.long 0x8f020001
.long 0x8f020101
.long 0x8f030001
.long 0x8f030101
.long 0x8f040001
.long 0x8f040101
.long 0x8f050001
.long 0x8f050101
.long 0x8f060001
.long 0x8f060101
.long 0x8f070001
.long 0x8f070101
.long 0x8f080001
.long 0x8f080101
.long 0x8f090001
.long 0x8f090101
.long 0x8f0a0001
.long 0x8f0a0101
.long 0x8f0b0001
.long 0x8f0b0101
.long 0x8f0c0001
.long 0x8f0c0101
.long 0x8f0d0001
.long 0x8f0d0101
.long 0x8f0e0001
.long 0x8f0e0101
.long 0x8f0f0001
.long 0x8f0f0101
.long 0x8f100001
.long 0x8f100101
.long 0x8f110001
.long 0x8f110101
.size queue_table, 3560
```
